```python
import torch

def _softmax(x, axis=-1):
    return torch.softmax(x, dim=axis)
def _gelu(x):
    return torch.nn.functional.gelu(x, approximate="tanh")
def _silu(x):
    return torch.nn.functional.silu(x)
def _sigmoid(x):
    return torch.sigmoid(x)
def _layernorm(x, axis=-1, eps=1e-5):
    m = x.mean(dim=axis, keepdim=True)
    v = x.var(dim=axis, keepdim=True, unbiased=False)
    return (x - m) / torch.sqrt(v + eps)
def _scatter_add(tgt, idx, src, axis=0):
    return tgt.clone().index_add_(axis, idx, src)
def _segment_sum(src, seg, n):
    out = torch.zeros((n,) + src.shape[1:], dtype=src.dtype)
    return out.index_add_(0, seg, src)
def _pad(x, pw):
    flat = tuple(v for pair in reversed(pw) for v in pair)
    return torch.nn.functional.pad(x, flat)

kernel_name = 'standalone__gated_linear_recurrence__prompt'

def setup_inputs():

    _w = (lambda a: (lambda t: t.to(torch.bfloat16) if t.is_floating_point() else t)(torch.as_tensor(a)))
    B, H, T, D = 1, 32, 2048, 128
    return {
        "q": _w((lambda *s: torch.randn(*s, dtype=torch.bfloat16) * 0.05)(B, H, T, D)),
        "k": _w((lambda *s: torch.randn(*s, dtype=torch.bfloat16) * 0.05)(B, H, T, D)),
        "v": _w((lambda *s: torch.randn(*s, dtype=torch.bfloat16) * 0.05)(B, H, T, D)),
        "g": _w((lambda *s: torch.randn(*s, dtype=torch.bfloat16) * 0.8)(B, H, T, D)),
    }

def reference(q, k, v, g):
    B, H, T, D = q.shape
    scale = D ** -0.5
    a = _sigmoid(g)
    S = k[:, :, 0, :, None] * v[:, :, 0, None, :] * 0.0
    outs = []
    for t in range(T):
        S = a[:, :, t, :, None] * S + k[:, :, t, :, None] * v[:, :, t, None, :]
        ot = torch.einsum("bhd,bhde->bhe", q[:, :, t, :], S) * scale
        outs.append(ot)
    return torch.stack(outs, 2)
```

```asm
; @launch grid=(256,1,1) block=(512,1,1) lds=160512
.amdgcn_target "amdgcn-amd-amdhsa--gfx950"
.text
.globl standalone__gated_linear_recurrence__prompt_kernel
.p2align 8
.type standalone__gated_linear_recurrence__prompt_kernel,@function
standalone__gated_linear_recurrence__prompt_kernel:
    s_cmp_ge_u32 s2, 256
    s_cbranch_scc1 L_end
    s_load_dwordx8 s[40:47], s[0:1], 0
    s_load_dwordx4 s[48:51], s[0:1], 32
    s_load_dwordx2 s[52:53], s[0:1], 48
    v_lshrrev_b32 v8, 6, v0
    v_and_b32 v7, 63, v0
    v_readfirstlane_b32 s34, v8
    s_and_b32 s32, s2, 31
    s_lshr_b32 s33, s2, 5
    s_sub_u32 s35, 11, s34
    s_cmp_lt_u32 s34, 4
    s_cselect_b32 s35, s34, s35
    s_lshl_b32 s36, s32, 19
    s_lshl_b32 s38, s33, 16
    s_add_u32 s36, s36, s38
    s_lshl_b32 s38, s35, 13
    s_add_u32 s36, s36, s38
    v_and_b32 v9, 15, v7
    v_lshrrev_b32 v10, 4, v7
    v_lshlrev_b32 v11, 4, v10
    v_lshl_add_u32 v1, v9, 9, v11
    v_lshrrev_b32 v12, 1, v10
    v_lshlrev_b32 v12, 3, v12
    v_xor_b32 v12, v12, v9
    v_lshl_add_u32 v2, v12, 9, v11
    v_lshlrev_b32 v13, 8, v10
    v_lshl_add_u32 v3, v12, 4, v13
    v_mov_b32 v12, 135168
    v_mov_b32 v16, 0
    v_mov_b32 v17, 0
    v_mov_b32 v18, 0
    v_mov_b32 v19, 0
    ds_write_b128 v12, v[16:19]
    ds_write_b128 v12, v[16:19] offset:16
    ds_write_b128 v12, v[16:19] offset:32
    s_waitcnt lgkmcnt(0)
    s_mov_b32 s4, s40
    s_mov_b32 s5, s41
    s_mov_b32 s6, 16777216
    s_mov_b32 s7, 0x00020000
    s_mov_b32 s8, s42
    s_mov_b32 s9, s43
    s_mov_b32 s10, 16777216
    s_mov_b32 s11, 0x00020000
    s_mov_b32 s12, s44
    s_mov_b32 s13, s45
    s_mov_b32 s14, 16777216
    s_mov_b32 s15, 0x00020000
    s_mov_b32 s16, s46
    s_mov_b32 s17, s47
    s_mov_b32 s18, 16777216
    s_mov_b32 s19, 0x00020000
    s_mov_b32 s20, s48
    s_mov_b32 s21, s49
    s_mov_b32 s22, 16777216
    s_mov_b32 s23, 0x00020000
    s_mov_b32 s24, s50
    s_mov_b32 s25, s51
    s_mov_b32 s26, 256
    s_mov_b32 s27, 0x00020000
    s_mov_b32 s28, s52
    s_mov_b32 s29, s53
    s_mov_b32 s30, 268435456
    s_mov_b32 s31, 0x00020000
    s_lshl_b32 s39, s32, 10
    s_add_u32 s39, s39, 16777216
    s_cmp_eq_u32 s34, 0
    s_cbranch_scc0 L_noscan
    v_lshrrev_b32 v14, 3, v7
    v_lshlrev_b32 v14, 7, v14
    v_and_b32 v15, 7, v7
    v_lshl_add_u32 v14, v15, 2, v14
    buffer_load_dword v15, v14, s[28:31], s39 offen sc1
L_noscan:
    s_cmp_lt_u32 s34, 4
    s_cbranch_scc0 L_nog
    buffer_load_dwordx4 v[144:147], v1, s[16:19], s36 offen offset:0 nt
    buffer_load_dwordx4 v[148:151], v1, s[16:19], s36 offen offset:256 nt
    buffer_load_dwordx4 v[152:155], v1, s[16:19], s36 offen offset:64 nt
    buffer_load_dwordx4 v[156:159], v1, s[16:19], s36 offen offset:320 nt
    buffer_load_dwordx4 v[160:163], v1, s[16:19], s36 offen offset:128 nt
    buffer_load_dwordx4 v[164:167], v1, s[16:19], s36 offen offset:384 nt
    buffer_load_dwordx4 v[168:171], v1, s[16:19], s36 offen offset:192 nt
    buffer_load_dwordx4 v[172:175], v1, s[16:19], s36 offen offset:448 nt
L_nog:
    s_barrier
    s_mov_b32 s62, 0xbfb8aa3b
    s_mov_b32 s63, s62
    s_mov_b32 s64, 0x3db504f3
    s_mov_b32 s65, s64
    s_mov_b32 s66, 1.0
    s_mov_b32 s67, 1.0
    s_mov_b32 s68, -1.0
    s_mov_b32 s69, -1.0
    s_mov_b32 s56, 0x0000ffff
    s_mov_b32 s57, 0x0000ffff
    s_mov_b32 s58, 0xffff0000
    s_mov_b32 s59, 0xffff0000
    s_mov_b32 s60, 0x00010001
    s_mov_b32 s61, 0x00010001
    s_mov_b32 s70, 0xffff0000
    s_cmp_lt_u32 s34, 4
    s_cbranch_scc1 L_light
    buffer_load_dwordx4 v[144:147], v1, s[16:19], s36 offen offset:0 nt
    buffer_load_dwordx4 v[148:151], v1, s[16:19], s36 offen offset:256 nt
    buffer_load_dwordx4 v[152:155], v1, s[16:19], s36 offen offset:64 nt
    buffer_load_dwordx4 v[156:159], v1, s[16:19], s36 offen offset:320 nt
    buffer_load_dwordx4 v[160:163], v1, s[16:19], s36 offen offset:128 nt
    buffer_load_dwordx4 v[164:167], v1, s[16:19], s36 offen offset:384 nt
    buffer_load_dwordx4 v[168:171], v1, s[16:19], s36 offen offset:192 nt
    buffer_load_dwordx4 v[172:175], v1, s[16:19], s36 offen offset:448 nt
    v_mov_b32 v6, 1.0
    v_lshrrev_b32 v11, 2, v7
    v_and_b32 v12, 3, v7
    v_lshrrev_b32 v13, 1, v12
    v_lshlrev_b32 v13, 3, v13
    v_xor_b32 v11, v11, v13
    v_lshlrev_b32 v11, 4, v11
    v_lshl_add_u32 v11, v12, 8, v11
    v_and_b32 v12, 1, v12
    v_lshl_add_u32 v4, v12, 3, v11
    v_xor_b32 v5, 8, v4
    v_lshlrev_b32 v11, 2, v10
    v_add_u32 v12, 0, v11
    v_cmp_le_u32 s[40:41], v12, v9
    v_cmp_lt_u32 s[48:49], v12, v9
    v_add_u32 v12, 1, v11
    v_cmp_le_u32 s[42:43], v12, v9
    v_cmp_lt_u32 s[50:51], v12, v9
    v_add_u32 v12, 2, v11
    v_cmp_le_u32 s[44:45], v12, v9
    v_cmp_lt_u32 s[52:53], v12, v9
    v_add_u32 v12, 3, v11
    v_cmp_le_u32 s[46:47], v12, v9
    v_cmp_lt_u32 s[54:55], v12, v9
    s_waitcnt vmcnt(6)
    v_lshlrev_b32 v16, 16, v144
    v_and_b32 v17, s70, v144
    v_lshlrev_b32 v18, 16, v145
    v_and_b32 v19, s70, v145
    v_lshlrev_b32 v20, 16, v146
    v_and_b32 v21, s70, v146
    v_lshlrev_b32 v22, 16, v147
    v_and_b32 v23, s70, v147
    v_lshlrev_b32 v112, 16, v148
    v_and_b32 v113, s70, v148
    v_lshlrev_b32 v114, 16, v149
    v_and_b32 v115, s70, v149
    v_lshlrev_b32 v116, 16, v150
    v_and_b32 v117, s70, v150
    v_lshlrev_b32 v118, 16, v151
    v_and_b32 v119, s70, v151
    v_pk_mul_f32 v[16:17], v[16:17], s[62:63]
    v_pk_mul_f32 v[18:19], v[18:19], s[62:63]
    v_pk_mul_f32 v[20:21], v[20:21], s[62:63]
    v_pk_mul_f32 v[22:23], v[22:23], s[62:63]
    v_pk_mul_f32 v[112:113], v[112:113], s[62:63]
    v_pk_mul_f32 v[114:115], v[114:115], s[62:63]
    v_pk_mul_f32 v[116:117], v[116:117], s[62:63]
    v_pk_mul_f32 v[118:119], v[118:119], s[62:63]
    v_exp_f32 v16, v16
    v_exp_f32 v17, v17
    v_exp_f32 v18, v18
    v_exp_f32 v19, v19
    v_exp_f32 v20, v20
    v_exp_f32 v21, v21
    v_exp_f32 v22, v22
    v_exp_f32 v23, v23
    v_exp_f32 v112, v112
    v_exp_f32 v113, v113
    v_exp_f32 v114, v114
    v_exp_f32 v115, v115
    v_exp_f32 v116, v116
    v_exp_f32 v117, v117
    v_exp_f32 v118, v118
    v_exp_f32 v119, v119
    v_pk_add_f32 v[16:17], v[16:17], s[66:67]
    v_pk_add_f32 v[18:19], v[18:19], s[66:67]
    v_pk_add_f32 v[20:21], v[20:21], s[66:67]
    v_pk_add_f32 v[22:23], v[22:23], s[66:67]
    v_pk_add_f32 v[112:113], v[112:113], s[66:67]
    v_pk_add_f32 v[114:115], v[114:115], s[66:67]
    v_pk_add_f32 v[116:117], v[116:117], s[66:67]
    v_pk_add_f32 v[118:119], v[118:119], s[66:67]
    v_pk_mul_f32 v[80:81], v[16:17], v[112:113]
    v_pk_mul_f32 v[82:83], v[18:19], v[114:115]
    v_pk_mul_f32 v[84:85], v[20:21], v[116:117]
    v_pk_mul_f32 v[86:87], v[22:23], v[118:119]
    v_pk_add_f32 v[120:121], v[80:81], s[68:69]
    v_pk_add_f32 v[122:123], v[82:83], s[68:69]
    v_pk_add_f32 v[124:125], v[84:85], s[68:69]
    v_pk_add_f32 v[126:127], v[86:87], s[68:69]
    v_add_f32_dpp v48, v120, v6 row_shl:1 row_mask:0xf bank_mask:0xf bound_ctrl:0
    v_add_f32_dpp v49, v121, v6 row_shl:1 row_mask:0xf bank_mask:0xf bound_ctrl:0
    v_add_f32_dpp v50, v122, v6 row_shl:1 row_mask:0xf bank_mask:0xf bound_ctrl:0
    v_add_f32_dpp v51, v123, v6 row_shl:1 row_mask:0xf bank_mask:0xf bound_ctrl:0
    v_add_f32_dpp v52, v124, v6 row_shl:1 row_mask:0xf bank_mask:0xf bound_ctrl:0
    v_add_f32_dpp v53, v125, v6 row_shl:1 row_mask:0xf bank_mask:0xf bound_ctrl:0
    v_add_f32_dpp v54, v126, v6 row_shl:1 row_mask:0xf bank_mask:0xf bound_ctrl:0
    v_add_f32_dpp v55, v127, v6 row_shl:1 row_mask:0xf bank_mask:0xf bound_ctrl:0
    v_mul_f32_dpp v48, v48, v48 row_shl:1 row_mask:0xf bank_mask:0xf
    v_mul_f32_dpp v49, v49, v49 row_shl:1 row_mask:0xf bank_mask:0xf
    v_mul_f32_dpp v50, v50, v50 row_shl:1 row_mask:0xf bank_mask:0xf
    v_mul_f32_dpp v51, v51, v51 row_shl:1 row_mask:0xf bank_mask:0xf
    v_mul_f32_dpp v52, v52, v52 row_shl:1 row_mask:0xf bank_mask:0xf
    v_mul_f32_dpp v53, v53, v53 row_shl:1 row_mask:0xf bank_mask:0xf
    v_mul_f32_dpp v54, v54, v54 row_shl:1 row_mask:0xf bank_mask:0xf
    v_mul_f32_dpp v55, v55, v55 row_shl:1 row_mask:0xf bank_mask:0xf
    v_mul_f32_dpp v48, v48, v48 row_shl:2 row_mask:0xf bank_mask:0xf
    v_mul_f32_dpp v49, v49, v49 row_shl:2 row_mask:0xf bank_mask:0xf
    v_mul_f32_dpp v50, v50, v50 row_shl:2 row_mask:0xf bank_mask:0xf
    v_mul_f32_dpp v51, v51, v51 row_shl:2 row_mask:0xf bank_mask:0xf
    v_mul_f32_dpp v52, v52, v52 row_shl:2 row_mask:0xf bank_mask:0xf
    v_mul_f32_dpp v53, v53, v53 row_shl:2 row_mask:0xf bank_mask:0xf
    v_mul_f32_dpp v54, v54, v54 row_shl:2 row_mask:0xf bank_mask:0xf
    v_mul_f32_dpp v55, v55, v55 row_shl:2 row_mask:0xf bank_mask:0xf
    v_mul_f32_dpp v48, v48, v48 row_shl:4 row_mask:0xf bank_mask:0xf
    v_mul_f32_dpp v49, v49, v49 row_shl:4 row_mask:0xf bank_mask:0xf
    v_mul_f32_dpp v50, v50, v50 row_shl:4 row_mask:0xf bank_mask:0xf
    v_mul_f32_dpp v51, v51, v51 row_shl:4 row_mask:0xf bank_mask:0xf
    v_mul_f32_dpp v52, v52, v52 row_shl:4 row_mask:0xf bank_mask:0xf
    v_mul_f32_dpp v53, v53, v53 row_shl:4 row_mask:0xf bank_mask:0xf
    v_mul_f32_dpp v54, v54, v54 row_shl:4 row_mask:0xf bank_mask:0xf
    v_mul_f32_dpp v55, v55, v55 row_shl:4 row_mask:0xf bank_mask:0xf
    v_mul_f32_dpp v48, v48, v48 row_shl:8 row_mask:0xf bank_mask:0xf
    v_mul_f32_dpp v49, v49, v49 row_shl:8 row_mask:0xf bank_mask:0xf
    v_mul_f32_dpp v50, v50, v50 row_shl:8 row_mask:0xf bank_mask:0xf
    v_mul_f32_dpp v51, v51, v51 row_shl:8 row_mask:0xf bank_mask:0xf
    v_mul_f32_dpp v52, v52, v52 row_shl:8 row_mask:0xf bank_mask:0xf
    v_mul_f32_dpp v53, v53, v53 row_shl:8 row_mask:0xf bank_mask:0xf
    v_mul_f32_dpp v54, v54, v54 row_shl:8 row_mask:0xf bank_mask:0xf
    v_mul_f32_dpp v55, v55, v55 row_shl:8 row_mask:0xf bank_mask:0xf
    v_pk_mul_f32 v[16:17], v[48:49], v[112:113]
    v_pk_mul_f32 v[18:19], v[50:51], v[114:115]
    v_pk_mul_f32 v[20:21], v[52:53], v[116:117]
    v_pk_mul_f32 v[22:23], v[54:55], v[118:119]
    v_pk_mul_f32 v[80:81], v[48:49], v[80:81]
    v_pk_mul_f32 v[82:83], v[50:51], v[82:83]
    v_pk_mul_f32 v[84:85], v[52:53], v[84:85]
    v_pk_mul_f32 v[86:87], v[54:55], v[86:87]
    s_waitcnt vmcnt(4)
    v_lshlrev_b32 v24, 16, v152
    v_and_b32 v25, s70, v152
    v_lshlrev_b32 v26, 16, v153
    v_and_b32 v27, s70, v153
    v_lshlrev_b32 v28, 16, v154
    v_and_b32 v29, s70, v154
    v_lshlrev_b32 v30, 16, v155
    v_and_b32 v31, s70, v155
    v_lshlrev_b32 v112, 16, v156
    v_and_b32 v113, s70, v156
    v_lshlrev_b32 v114, 16, v157
    v_and_b32 v115, s70, v157
    v_lshlrev_b32 v116, 16, v158
    v_and_b32 v117, s70, v158
    v_lshlrev_b32 v118, 16, v159
    v_and_b32 v119, s70, v159
    v_pk_mul_f32 v[24:25], v[24:25], s[62:63]
    v_pk_mul_f32 v[26:27], v[26:27], s[62:63]
    v_pk_mul_f32 v[28:29], v[28:29], s[62:63]
    v_pk_mul_f32 v[30:31], v[30:31], s[62:63]
    v_pk_mul_f32 v[112:113], v[112:113], s[62:63]
    v_pk_mul_f32 v[114:115], v[114:115], s[62:63]
    v_pk_mul_f32 v[116:117], v[116:117], s[62:63]
    v_pk_mul_f32 v[118:119], v[118:119], s[62:63]
    v_exp_f32 v24, v24
    v_exp_f32 v25, v25
    v_exp_f32 v26, v26
    v_exp_f32 v27, v27
    v_exp_f32 v28, v28
    v_exp_f32 v29, v29
    v_exp_f32 v30, v30
    v_exp_f32 v31, v31
    v_exp_f32 v112, v112
    v_exp_f32 v113, v113
    v_exp_f32 v114, v114
    v_exp_f32 v115, v115
    v_exp_f32 v116, v116
    v_exp_f32 v117, v117
    v_exp_f32 v118, v118
    v_exp_f32 v119, v119
    v_pk_add_f32 v[24:25], v[24:25], s[66:67]
    v_pk_add_f32 v[26:27], v[26:27], s[66:67]
    v_pk_add_f32 v[28:29], v[28:29], s[66:67]
    v_pk_add_f32 v[30:31], v[30:31], s[66:67]
    v_pk_add_f32 v[112:113], v[112:113], s[66:67]
    v_pk_add_f32 v[114:115], v[114:115], s[66:67]
    v_pk_add_f32 v[116:117], v[116:117], s[66:67]
    v_pk_add_f32 v[118:119], v[118:119], s[66:67]
    v_pk_mul_f32 v[88:89], v[24:25], v[112:113]
    v_pk_mul_f32 v[90:91], v[26:27], v[114:115]
    v_pk_mul_f32 v[92:93], v[28:29], v[116:117]
    v_pk_mul_f32 v[94:95], v[30:31], v[118:119]
    v_pk_add_f32 v[120:121], v[88:89], s[68:69]
    v_pk_add_f32 v[122:123], v[90:91], s[68:69]
    v_pk_add_f32 v[124:125], v[92:93], s[68:69]
    v_pk_add_f32 v[126:127], v[94:95], s[68:69]
    v_add_f32_dpp v56, v120, v6 row_shl:1 row_mask:0xf bank_mask:0xf bound_ctrl:0
    v_add_f32_dpp v57, v121, v6 row_shl:1 row_mask:0xf bank_mask:0xf bound_ctrl:0
    v_add_f32_dpp v58, v122, v6 row_shl:1 row_mask:0xf bank_mask:0xf bound_ctrl:0
    v_add_f32_dpp v59, v123, v6 row_shl:1 row_mask:0xf bank_mask:0xf bound_ctrl:0
    v_add_f32_dpp v60, v124, v6 row_shl:1 row_mask:0xf bank_mask:0xf bound_ctrl:0
    v_add_f32_dpp v61, v125, v6 row_shl:1 row_mask:0xf bank_mask:0xf bound_ctrl:0
    v_add_f32_dpp v62, v126, v6 row_shl:1 row_mask:0xf bank_mask:0xf bound_ctrl:0
    v_add_f32_dpp v63, v127, v6 row_shl:1 row_mask:0xf bank_mask:0xf bound_ctrl:0
    v_mul_f32_dpp v56, v56, v56 row_shl:1 row_mask:0xf bank_mask:0xf
    v_mul_f32_dpp v57, v57, v57 row_shl:1 row_mask:0xf bank_mask:0xf
    v_mul_f32_dpp v58, v58, v58 row_shl:1 row_mask:0xf bank_mask:0xf
    v_mul_f32_dpp v59, v59, v59 row_shl:1 row_mask:0xf bank_mask:0xf
    v_mul_f32_dpp v60, v60, v60 row_shl:1 row_mask:0xf bank_mask:0xf
    v_mul_f32_dpp v61, v61, v61 row_shl:1 row_mask:0xf bank_mask:0xf
    v_mul_f32_dpp v62, v62, v62 row_shl:1 row_mask:0xf bank_mask:0xf
    v_mul_f32_dpp v63, v63, v63 row_shl:1 row_mask:0xf bank_mask:0xf
    v_mul_f32_dpp v56, v56, v56 row_shl:2 row_mask:0xf bank_mask:0xf
    v_mul_f32_dpp v57, v57, v57 row_shl:2 row_mask:0xf bank_mask:0xf
    v_mul_f32_dpp v58, v58, v58 row_shl:2 row_mask:0xf bank_mask:0xf
    v_mul_f32_dpp v59, v59, v59 row_shl:2 row_mask:0xf bank_mask:0xf
    v_mul_f32_dpp v60, v60, v60 row_shl:2 row_mask:0xf bank_mask:0xf
    v_mul_f32_dpp v61, v61, v61 row_shl:2 row_mask:0xf bank_mask:0xf
    v_mul_f32_dpp v62, v62, v62 row_shl:2 row_mask:0xf bank_mask:0xf
    v_mul_f32_dpp v63, v63, v63 row_shl:2 row_mask:0xf bank_mask:0xf
    v_mul_f32_dpp v56, v56, v56 row_shl:4 row_mask:0xf bank_mask:0xf
    v_mul_f32_dpp v57, v57, v57 row_shl:4 row_mask:0xf bank_mask:0xf
    v_mul_f32_dpp v58, v58, v58 row_shl:4 row_mask:0xf bank_mask:0xf
    v_mul_f32_dpp v59, v59, v59 row_shl:4 row_mask:0xf bank_mask:0xf
    v_mul_f32_dpp v60, v60, v60 row_shl:4 row_mask:0xf bank_mask:0xf
    v_mul_f32_dpp v61, v61, v61 row_shl:4 row_mask:0xf bank_mask:0xf
    v_mul_f32_dpp v62, v62, v62 row_shl:4 row_mask:0xf bank_mask:0xf
    v_mul_f32_dpp v63, v63, v63 row_shl:4 row_mask:0xf bank_mask:0xf
    v_mul_f32_dpp v56, v56, v56 row_shl:8 row_mask:0xf bank_mask:0xf
    v_mul_f32_dpp v57, v57, v57 row_shl:8 row_mask:0xf bank_mask:0xf
    v_mul_f32_dpp v58, v58, v58 row_shl:8 row_mask:0xf bank_mask:0xf
    v_mul_f32_dpp v59, v59, v59 row_shl:8 row_mask:0xf bank_mask:0xf
    v_mul_f32_dpp v60, v60, v60 row_shl:8 row_mask:0xf bank_mask:0xf
    v_mul_f32_dpp v61, v61, v61 row_shl:8 row_mask:0xf bank_mask:0xf
    v_mul_f32_dpp v62, v62, v62 row_shl:8 row_mask:0xf bank_mask:0xf
    v_mul_f32_dpp v63, v63, v63 row_shl:8 row_mask:0xf bank_mask:0xf
    v_pk_mul_f32 v[24:25], v[56:57], v[112:113]
    v_pk_mul_f32 v[26:27], v[58:59], v[114:115]
    v_pk_mul_f32 v[28:29], v[60:61], v[116:117]
    v_pk_mul_f32 v[30:31], v[62:63], v[118:119]
    v_pk_mul_f32 v[88:89], v[56:57], v[88:89]
    v_pk_mul_f32 v[90:91], v[58:59], v[90:91]
    v_pk_mul_f32 v[92:93], v[60:61], v[92:93]
    v_pk_mul_f32 v[94:95], v[62:63], v[94:95]
    s_waitcnt vmcnt(2)
    v_lshlrev_b32 v32, 16, v160
    v_and_b32 v33, s70, v160
    v_lshlrev_b32 v34, 16, v161
    v_and_b32 v35, s70, v161
    v_lshlrev_b32 v36, 16, v162
    v_and_b32 v37, s70, v162
    v_lshlrev_b32 v38, 16, v163
    v_and_b32 v39, s70, v163
    v_lshlrev_b32 v112, 16, v164
    v_and_b32 v113, s70, v164
    v_lshlrev_b32 v114, 16, v165
    v_and_b32 v115, s70, v165
    v_lshlrev_b32 v116, 16, v166
    v_and_b32 v117, s70, v166
    v_lshlrev_b32 v118, 16, v167
    v_and_b32 v119, s70, v167
    v_pk_mul_f32 v[32:33], v[32:33], s[62:63]
    v_pk_mul_f32 v[34:35], v[34:35], s[62:63]
    v_pk_mul_f32 v[36:37], v[36:37], s[62:63]
    v_pk_mul_f32 v[38:39], v[38:39], s[62:63]
    v_pk_mul_f32 v[112:113], v[112:113], s[62:63]
    v_pk_mul_f32 v[114:115], v[114:115], s[62:63]
    v_pk_mul_f32 v[116:117], v[116:117], s[62:63]
    v_pk_mul_f32 v[118:119], v[118:119], s[62:63]
    v_exp_f32 v32, v32
    v_exp_f32 v33, v33
    v_exp_f32 v34, v34
    v_exp_f32 v35, v35
    v_exp_f32 v36, v36
    v_exp_f32 v37, v37
    v_exp_f32 v38, v38
    v_exp_f32 v39, v39
    v_exp_f32 v112, v112
    v_exp_f32 v113, v113
    v_exp_f32 v114, v114
    v_exp_f32 v115, v115
    v_exp_f32 v116, v116
    v_exp_f32 v117, v117
    v_exp_f32 v118, v118
    v_exp_f32 v119, v119
    v_pk_add_f32 v[32:33], v[32:33], s[66:67]
    v_pk_add_f32 v[34:35], v[34:35], s[66:67]
    v_pk_add_f32 v[36:37], v[36:37], s[66:67]
    v_pk_add_f32 v[38:39], v[38:39], s[66:67]
    v_pk_add_f32 v[112:113], v[112:113], s[66:67]
    v_pk_add_f32 v[114:115], v[114:115], s[66:67]
    v_pk_add_f32 v[116:117], v[116:117], s[66:67]
    v_pk_add_f32 v[118:119], v[118:119], s[66:67]
    v_pk_mul_f32 v[96:97], v[32:33], v[112:113]
    v_pk_mul_f32 v[98:99], v[34:35], v[114:115]
    v_pk_mul_f32 v[100:101], v[36:37], v[116:117]
    v_pk_mul_f32 v[102:103], v[38:39], v[118:119]
    v_pk_add_f32 v[120:121], v[96:97], s[68:69]
    v_pk_add_f32 v[122:123], v[98:99], s[68:69]
    v_pk_add_f32 v[124:125], v[100:101], s[68:69]
    v_pk_add_f32 v[126:127], v[102:103], s[68:69]
    v_add_f32_dpp v64, v120, v6 row_shl:1 row_mask:0xf bank_mask:0xf bound_ctrl:0
    v_add_f32_dpp v65, v121, v6 row_shl:1 row_mask:0xf bank_mask:0xf bound_ctrl:0
    v_add_f32_dpp v66, v122, v6 row_shl:1 row_mask:0xf bank_mask:0xf bound_ctrl:0
    v_add_f32_dpp v67, v123, v6 row_shl:1 row_mask:0xf bank_mask:0xf bound_ctrl:0
    v_add_f32_dpp v68, v124, v6 row_shl:1 row_mask:0xf bank_mask:0xf bound_ctrl:0
    v_add_f32_dpp v69, v125, v6 row_shl:1 row_mask:0xf bank_mask:0xf bound_ctrl:0
    v_add_f32_dpp v70, v126, v6 row_shl:1 row_mask:0xf bank_mask:0xf bound_ctrl:0
    v_add_f32_dpp v71, v127, v6 row_shl:1 row_mask:0xf bank_mask:0xf bound_ctrl:0
    v_mul_f32_dpp v64, v64, v64 row_shl:1 row_mask:0xf bank_mask:0xf
    v_mul_f32_dpp v65, v65, v65 row_shl:1 row_mask:0xf bank_mask:0xf
    v_mul_f32_dpp v66, v66, v66 row_shl:1 row_mask:0xf bank_mask:0xf
    v_mul_f32_dpp v67, v67, v67 row_shl:1 row_mask:0xf bank_mask:0xf
    v_mul_f32_dpp v68, v68, v68 row_shl:1 row_mask:0xf bank_mask:0xf
    v_mul_f32_dpp v69, v69, v69 row_shl:1 row_mask:0xf bank_mask:0xf
    v_mul_f32_dpp v70, v70, v70 row_shl:1 row_mask:0xf bank_mask:0xf
    v_mul_f32_dpp v71, v71, v71 row_shl:1 row_mask:0xf bank_mask:0xf
    v_mul_f32_dpp v64, v64, v64 row_shl:2 row_mask:0xf bank_mask:0xf
    v_mul_f32_dpp v65, v65, v65 row_shl:2 row_mask:0xf bank_mask:0xf
    v_mul_f32_dpp v66, v66, v66 row_shl:2 row_mask:0xf bank_mask:0xf
    v_mul_f32_dpp v67, v67, v67 row_shl:2 row_mask:0xf bank_mask:0xf
    v_mul_f32_dpp v68, v68, v68 row_shl:2 row_mask:0xf bank_mask:0xf
    v_mul_f32_dpp v69, v69, v69 row_shl:2 row_mask:0xf bank_mask:0xf
    v_mul_f32_dpp v70, v70, v70 row_shl:2 row_mask:0xf bank_mask:0xf
    v_mul_f32_dpp v71, v71, v71 row_shl:2 row_mask:0xf bank_mask:0xf
    v_mul_f32_dpp v64, v64, v64 row_shl:4 row_mask:0xf bank_mask:0xf
    v_mul_f32_dpp v65, v65, v65 row_shl:4 row_mask:0xf bank_mask:0xf
    v_mul_f32_dpp v66, v66, v66 row_shl:4 row_mask:0xf bank_mask:0xf
    v_mul_f32_dpp v67, v67, v67 row_shl:4 row_mask:0xf bank_mask:0xf
    v_mul_f32_dpp v68, v68, v68 row_shl:4 row_mask:0xf bank_mask:0xf
    v_mul_f32_dpp v69, v69, v69 row_shl:4 row_mask:0xf bank_mask:0xf
    v_mul_f32_dpp v70, v70, v70 row_shl:4 row_mask:0xf bank_mask:0xf
    v_mul_f32_dpp v71, v71, v71 row_shl:4 row_mask:0xf bank_mask:0xf
    v_mul_f32_dpp v64, v64, v64 row_shl:8 row_mask:0xf bank_mask:0xf
    v_mul_f32_dpp v65, v65, v65 row_shl:8 row_mask:0xf bank_mask:0xf
    v_mul_f32_dpp v66, v66, v66 row_shl:8 row_mask:0xf bank_mask:0xf
    v_mul_f32_dpp v67, v67, v67 row_shl:8 row_mask:0xf bank_mask:0xf
    v_mul_f32_dpp v68, v68, v68 row_shl:8 row_mask:0xf bank_mask:0xf
    v_mul_f32_dpp v69, v69, v69 row_shl:8 row_mask:0xf bank_mask:0xf
    v_mul_f32_dpp v70, v70, v70 row_shl:8 row_mask:0xf bank_mask:0xf
    v_mul_f32_dpp v71, v71, v71 row_shl:8 row_mask:0xf bank_mask:0xf
    v_pk_mul_f32 v[32:33], v[64:65], v[112:113]
    v_pk_mul_f32 v[34:35], v[66:67], v[114:115]
    v_pk_mul_f32 v[36:37], v[68:69], v[116:117]
    v_pk_mul_f32 v[38:39], v[70:71], v[118:119]
    v_pk_mul_f32 v[96:97], v[64:65], v[96:97]
    v_pk_mul_f32 v[98:99], v[66:67], v[98:99]
    v_pk_mul_f32 v[100:101], v[68:69], v[100:101]
    v_pk_mul_f32 v[102:103], v[70:71], v[102:103]
    s_waitcnt vmcnt(0)
    v_lshlrev_b32 v40, 16, v168
    v_and_b32 v41, s70, v168
    v_lshlrev_b32 v42, 16, v169
    v_and_b32 v43, s70, v169
    v_lshlrev_b32 v44, 16, v170
    v_and_b32 v45, s70, v170
    v_lshlrev_b32 v46, 16, v171
    v_and_b32 v47, s70, v171
    v_lshlrev_b32 v112, 16, v172
    v_and_b32 v113, s70, v172
    v_lshlrev_b32 v114, 16, v173
    v_and_b32 v115, s70, v173
    v_lshlrev_b32 v116, 16, v174
    v_and_b32 v117, s70, v174
    v_lshlrev_b32 v118, 16, v175
    v_and_b32 v119, s70, v175
    v_pk_mul_f32 v[40:41], v[40:41], s[62:63]
    v_pk_mul_f32 v[42:43], v[42:43], s[62:63]
    v_pk_mul_f32 v[44:45], v[44:45], s[62:63]
    v_pk_mul_f32 v[46:47], v[46:47], s[62:63]
    v_pk_mul_f32 v[112:113], v[112:113], s[62:63]
    v_pk_mul_f32 v[114:115], v[114:115], s[62:63]
    v_pk_mul_f32 v[116:117], v[116:117], s[62:63]
    v_pk_mul_f32 v[118:119], v[118:119], s[62:63]
    v_exp_f32 v40, v40
    v_exp_f32 v41, v41
    v_exp_f32 v42, v42
    v_exp_f32 v43, v43
    v_exp_f32 v44, v44
    v_exp_f32 v45, v45
    v_exp_f32 v46, v46
    v_exp_f32 v47, v47
    v_exp_f32 v112, v112
    v_exp_f32 v113, v113
    v_exp_f32 v114, v114
    v_exp_f32 v115, v115
    v_exp_f32 v116, v116
    v_exp_f32 v117, v117
    v_exp_f32 v118, v118
    v_exp_f32 v119, v119
    v_pk_add_f32 v[40:41], v[40:41], s[66:67]
    v_pk_add_f32 v[42:43], v[42:43], s[66:67]
    v_pk_add_f32 v[44:45], v[44:45], s[66:67]
    v_pk_add_f32 v[46:47], v[46:47], s[66:67]
    v_pk_add_f32 v[112:113], v[112:113], s[66:67]
    v_pk_add_f32 v[114:115], v[114:115], s[66:67]
    v_pk_add_f32 v[116:117], v[116:117], s[66:67]
    v_pk_add_f32 v[118:119], v[118:119], s[66:67]
    v_pk_mul_f32 v[104:105], v[40:41], v[112:113]
    v_pk_mul_f32 v[106:107], v[42:43], v[114:115]
    v_pk_mul_f32 v[108:109], v[44:45], v[116:117]
    v_pk_mul_f32 v[110:111], v[46:47], v[118:119]
    v_pk_add_f32 v[120:121], v[104:105], s[68:69]
    v_pk_add_f32 v[122:123], v[106:107], s[68:69]
    v_pk_add_f32 v[124:125], v[108:109], s[68:69]
    v_pk_add_f32 v[126:127], v[110:111], s[68:69]
    v_add_f32_dpp v72, v120, v6 row_shl:1 row_mask:0xf bank_mask:0xf bound_ctrl:0
    v_add_f32_dpp v73, v121, v6 row_shl:1 row_mask:0xf bank_mask:0xf bound_ctrl:0
    v_add_f32_dpp v74, v122, v6 row_shl:1 row_mask:0xf bank_mask:0xf bound_ctrl:0
    v_add_f32_dpp v75, v123, v6 row_shl:1 row_mask:0xf bank_mask:0xf bound_ctrl:0
    v_add_f32_dpp v76, v124, v6 row_shl:1 row_mask:0xf bank_mask:0xf bound_ctrl:0
    v_add_f32_dpp v77, v125, v6 row_shl:1 row_mask:0xf bank_mask:0xf bound_ctrl:0
    v_add_f32_dpp v78, v126, v6 row_shl:1 row_mask:0xf bank_mask:0xf bound_ctrl:0
    v_add_f32_dpp v79, v127, v6 row_shl:1 row_mask:0xf bank_mask:0xf bound_ctrl:0
    v_mul_f32_dpp v72, v72, v72 row_shl:1 row_mask:0xf bank_mask:0xf
    v_mul_f32_dpp v73, v73, v73 row_shl:1 row_mask:0xf bank_mask:0xf
    v_mul_f32_dpp v74, v74, v74 row_shl:1 row_mask:0xf bank_mask:0xf
    v_mul_f32_dpp v75, v75, v75 row_shl:1 row_mask:0xf bank_mask:0xf
    v_mul_f32_dpp v76, v76, v76 row_shl:1 row_mask:0xf bank_mask:0xf
    v_mul_f32_dpp v77, v77, v77 row_shl:1 row_mask:0xf bank_mask:0xf
    v_mul_f32_dpp v78, v78, v78 row_shl:1 row_mask:0xf bank_mask:0xf
    v_mul_f32_dpp v79, v79, v79 row_shl:1 row_mask:0xf bank_mask:0xf
    v_mul_f32_dpp v72, v72, v72 row_shl:2 row_mask:0xf bank_mask:0xf
    v_mul_f32_dpp v73, v73, v73 row_shl:2 row_mask:0xf bank_mask:0xf
    v_mul_f32_dpp v74, v74, v74 row_shl:2 row_mask:0xf bank_mask:0xf
    v_mul_f32_dpp v75, v75, v75 row_shl:2 row_mask:0xf bank_mask:0xf
    v_mul_f32_dpp v76, v76, v76 row_shl:2 row_mask:0xf bank_mask:0xf
    v_mul_f32_dpp v77, v77, v77 row_shl:2 row_mask:0xf bank_mask:0xf
    v_mul_f32_dpp v78, v78, v78 row_shl:2 row_mask:0xf bank_mask:0xf
    v_mul_f32_dpp v79, v79, v79 row_shl:2 row_mask:0xf bank_mask:0xf
    v_mul_f32_dpp v72, v72, v72 row_shl:4 row_mask:0xf bank_mask:0xf
    v_mul_f32_dpp v73, v73, v73 row_shl:4 row_mask:0xf bank_mask:0xf
    v_mul_f32_dpp v74, v74, v74 row_shl:4 row_mask:0xf bank_mask:0xf
    v_mul_f32_dpp v75, v75, v75 row_shl:4 row_mask:0xf bank_mask:0xf
    v_mul_f32_dpp v76, v76, v76 row_shl:4 row_mask:0xf bank_mask:0xf
    v_mul_f32_dpp v77, v77, v77 row_shl:4 row_mask:0xf bank_mask:0xf
    v_mul_f32_dpp v78, v78, v78 row_shl:4 row_mask:0xf bank_mask:0xf
    v_mul_f32_dpp v79, v79, v79 row_shl:4 row_mask:0xf bank_mask:0xf
    v_mul_f32_dpp v72, v72, v72 row_shl:8 row_mask:0xf bank_mask:0xf
    v_mul_f32_dpp v73, v73, v73 row_shl:8 row_mask:0xf bank_mask:0xf
    v_mul_f32_dpp v74, v74, v74 row_shl:8 row_mask:0xf bank_mask:0xf
    v_mul_f32_dpp v75, v75, v75 row_shl:8 row_mask:0xf bank_mask:0xf
    v_mul_f32_dpp v76, v76, v76 row_shl:8 row_mask:0xf bank_mask:0xf
    v_mul_f32_dpp v77, v77, v77 row_shl:8 row_mask:0xf bank_mask:0xf
    v_mul_f32_dpp v78, v78, v78 row_shl:8 row_mask:0xf bank_mask:0xf
    v_mul_f32_dpp v79, v79, v79 row_shl:8 row_mask:0xf bank_mask:0xf
    v_pk_mul_f32 v[40:41], v[72:73], v[112:113]
    v_pk_mul_f32 v[42:43], v[74:75], v[114:115]
    v_pk_mul_f32 v[44:45], v[76:77], v[116:117]
    v_pk_mul_f32 v[46:47], v[78:79], v[118:119]
    v_pk_mul_f32 v[104:105], v[72:73], v[104:105]
    v_pk_mul_f32 v[106:107], v[74:75], v[106:107]
    v_pk_mul_f32 v[108:109], v[76:77], v[108:109]
    v_pk_mul_f32 v[110:111], v[78:79], v[110:111]
    s_lshl_b32 s38, s35, 9
    s_add_u32 s38, s38, 131072
    v_lshlrev_b32 v8, 5, v10
    v_add_u32 v8, s38, v8
    s_mov_b64 exec, s[60:61]
    ds_write_b128 v8, v[80:83] offset:0
    ds_write_b128 v8, v[84:87] offset:16
    ds_write_b128 v8, v[88:91] offset:128
    ds_write_b128 v8, v[92:95] offset:144
    ds_write_b128 v8, v[96:99] offset:256
    ds_write_b128 v8, v[100:103] offset:272
    ds_write_b128 v8, v[104:107] offset:384
    ds_write_b128 v8, v[108:111] offset:400
    s_mov_b64 exec, -1
    v_lshlrev_b32 v8, 3, v7
    v_add_u32 v8, s38, v8
    ds_read_b64 v[112:113], v8
    s_mov_b32 s38, 0x5f800000
    s_waitcnt lgkmcnt(0)
    v_cmp_nge_f32 s[72:73], s38, v112
    v_cmp_nge_f32 vcc, s38, v113
    v_rcp_f32 v112, v112
    v_rcp_f32 v113, v113
    s_or_b64 s[72:73], s[72:73], vcc
    ds_write_b64 v8, v[112:113]
    v_mov_b32 v12, 135168
    v_mov_b32 v13, 1
    s_mov_b64 exec, 1
    ds_add_u32 v12, v13 offset:4
    s_mov_b64 exec, -1
    v_rcp_f32 v80, v16
    v_rcp_f32 v81, v17
    v_rcp_f32 v82, v18
    v_rcp_f32 v83, v19
    v_rcp_f32 v84, v20
    v_rcp_f32 v85, v21
    v_rcp_f32 v86, v22
    v_rcp_f32 v87, v23
    v_rcp_f32 v88, v48
    v_rcp_f32 v89, v49
    v_rcp_f32 v90, v50
    v_rcp_f32 v91, v51
    v_rcp_f32 v92, v52
    v_rcp_f32 v93, v53
    v_rcp_f32 v94, v54
    v_rcp_f32 v95, v55
    v_rcp_f32 v96, v24
    v_rcp_f32 v97, v25
    v_rcp_f32 v98, v26
    v_rcp_f32 v99, v27
    v_rcp_f32 v100, v28
    v_rcp_f32 v101, v29
    v_rcp_f32 v102, v30
    v_rcp_f32 v103, v31
    v_rcp_f32 v104, v56
    v_rcp_f32 v105, v57
    v_rcp_f32 v106, v58
    v_rcp_f32 v107, v59
    v_rcp_f32 v108, v60
    v_rcp_f32 v109, v61
    v_rcp_f32 v110, v62
    v_rcp_f32 v111, v63
    v_rcp_f32 v112, v32
    v_rcp_f32 v113, v33
    v_rcp_f32 v114, v34
    v_rcp_f32 v115, v35
    v_rcp_f32 v116, v36
    v_rcp_f32 v117, v37
    v_rcp_f32 v118, v38
    v_rcp_f32 v119, v39
    v_rcp_f32 v120, v64
    v_rcp_f32 v121, v65
    v_rcp_f32 v122, v66
    v_rcp_f32 v123, v67
    v_rcp_f32 v124, v68
    v_rcp_f32 v125, v69
    v_rcp_f32 v126, v70
    v_rcp_f32 v127, v71
    v_rcp_f32 v128, v40
    v_rcp_f32 v129, v41
    v_rcp_f32 v130, v42
    v_rcp_f32 v131, v43
    v_rcp_f32 v132, v44
    v_rcp_f32 v133, v45
    v_rcp_f32 v134, v46
    v_rcp_f32 v135, v47
    v_rcp_f32 v136, v72
    v_rcp_f32 v137, v73
    v_rcp_f32 v138, v74
    v_rcp_f32 v139, v75
    v_rcp_f32 v140, v76
    v_rcp_f32 v141, v77
    v_rcp_f32 v142, v78
    v_rcp_f32 v143, v79
    v_pk_mul_f32 v[80:81], v[80:81], s[64:65]
    v_pk_mul_f32 v[82:83], v[82:83], s[64:65]
    v_pk_mul_f32 v[84:85], v[84:85], s[64:65]
    v_pk_mul_f32 v[86:87], v[86:87], s[64:65]
    v_pk_mul_f32 v[88:89], v[88:89], s[64:65]
    v_pk_mul_f32 v[90:91], v[90:91], s[64:65]
    v_pk_mul_f32 v[92:93], v[92:93], s[64:65]
    v_pk_mul_f32 v[94:95], v[94:95], s[64:65]
    v_pk_mul_f32 v[96:97], v[96:97], s[64:65]
    v_pk_mul_f32 v[98:99], v[98:99], s[64:65]
    v_pk_mul_f32 v[100:101], v[100:101], s[64:65]
    v_pk_mul_f32 v[102:103], v[102:103], s[64:65]
    v_pk_mul_f32 v[104:105], v[104:105], s[64:65]
    v_pk_mul_f32 v[106:107], v[106:107], s[64:65]
    v_pk_mul_f32 v[108:109], v[108:109], s[64:65]
    v_pk_mul_f32 v[110:111], v[110:111], s[64:65]
    v_pk_mul_f32 v[112:113], v[112:113], s[64:65]
    v_pk_mul_f32 v[114:115], v[114:115], s[64:65]
    v_pk_mul_f32 v[116:117], v[116:117], s[64:65]
    v_pk_mul_f32 v[118:119], v[118:119], s[64:65]
    v_pk_mul_f32 v[120:121], v[120:121], s[64:65]
    v_pk_mul_f32 v[122:123], v[122:123], s[64:65]
    v_pk_mul_f32 v[124:125], v[124:125], s[64:65]
    v_pk_mul_f32 v[126:127], v[126:127], s[64:65]
    v_pk_mul_f32 v[128:129], v[128:129], s[64:65]
    v_pk_mul_f32 v[130:131], v[130:131], s[64:65]
    v_pk_mul_f32 v[132:133], v[132:133], s[64:65]
    v_pk_mul_f32 v[134:135], v[134:135], s[64:65]
    v_pk_mul_f32 v[136:137], v[136:137], s[64:65]
    v_pk_mul_f32 v[138:139], v[138:139], s[64:65]
    v_pk_mul_f32 v[140:141], v[140:141], s[64:65]
    v_pk_mul_f32 v[142:143], v[142:143], s[64:65]
    s_lshl_b32 s38, s35, 13
    v_add_u32 v9, s38, v3
    s_sub_u32 s71, s35, 4
    v_mov_b32 v12, 135168
L_spin1:
    ds_read_b32 v13, v12 offset:32
    s_waitcnt lgkmcnt(0)
    v_readfirstlane_b32 s38, v13
    s_nop 1
    s_cmp_ge_u32 s38, s71
    s_cbranch_scc1 L_spun2
    s_sleep 1
    s_branch L_spin1
L_spun2:
    buffer_load_dwordx4 v[176:179], v1, s[8:11], s36 offen offset:0 nt
    buffer_load_dwordx4 v[180:183], v1, s[8:11], s36 offen offset:256 nt
    buffer_load_dwordx4 v[184:187], v1, s[8:11], s36 offen offset:64 nt
    buffer_load_dwordx4 v[188:191], v1, s[8:11], s36 offen offset:320 nt
    buffer_load_dwordx4 v[192:195], v1, s[8:11], s36 offen offset:128 nt
    buffer_load_dwordx4 v[196:199], v1, s[8:11], s36 offen offset:384 nt
    buffer_load_dwordx4 v[200:203], v1, s[8:11], s36 offen offset:192 nt
    buffer_load_dwordx4 v[204:207], v1, s[8:11], s36 offen offset:448 nt
    s_lshl_b32 s38, s35, 13
    s_add_u32 s38, s38, 65536
    s_add_u32 m0, s38, 0
    s_nop 0
    buffer_load_dwordx4 v2, s[12:15], s36 offen offset:0 nt lds
    s_add_u32 m0, s38, 960
    s_nop 0
    buffer_load_dwordx4 v2, s[12:15], s36 offen offset:64 nt lds
    s_add_u32 m0, s38, 1920
    s_nop 0
    buffer_load_dwordx4 v2, s[12:15], s36 offen offset:128 nt lds
    s_add_u32 m0, s38, 2880
    s_nop 0
    buffer_load_dwordx4 v2, s[12:15], s36 offen offset:192 nt lds
    s_add_u32 m0, s38, 3840
    s_nop 0
    buffer_load_dwordx4 v2, s[12:15], s36 offen offset:256 nt lds
    s_add_u32 m0, s38, 4800
    s_nop 0
    buffer_load_dwordx4 v2, s[12:15], s36 offen offset:320 nt lds
    s_add_u32 m0, s38, 5760
    s_nop 0
    buffer_load_dwordx4 v2, s[12:15], s36 offen offset:384 nt lds
    s_add_u32 m0, s38, 6720
    s_nop 0
    buffer_load_dwordx4 v2, s[12:15], s36 offen offset:448 nt lds
    s_lshl_b32 s38, s35, 2
    s_lshl_b32 s71, 4, s38
    s_cmp_eq_u32 s35, 7
    s_cbranch_scc0 L_hq
    buffer_load_dwordx4 v[208:211], v1, s[4:7], s36 offen offset:0 nt
    buffer_load_dwordx4 v[212:215], v1, s[4:7], s36 offen offset:256 nt
    buffer_load_dwordx4 v[216:219], v1, s[4:7], s36 offen offset:64 nt
    buffer_load_dwordx4 v[220:223], v1, s[4:7], s36 offen offset:320 nt
    buffer_load_dwordx4 v[224:227], v1, s[4:7], s36 offen offset:128 nt
    buffer_load_dwordx4 v[228:231], v1, s[4:7], s36 offen offset:384 nt
    buffer_load_dwordx4 v[232:235], v1, s[4:7], s36 offen offset:192 nt
    buffer_load_dwordx4 v[236:239], v1, s[4:7], s36 offen offset:448 nt
    v_mov_b32 v12, 135168
    v_mov_b32 v13, 1
    s_mov_b64 exec, 1
    ds_add_u32 v12, v13 offset:32
    s_mov_b64 exec, -1
    s_waitcnt vmcnt(22)
    v_lshlrev_b32 v144, 16, v176
    v_and_b32 v145, s70, v176
    v_lshlrev_b32 v146, 16, v177
    v_and_b32 v147, s70, v177
    v_lshlrev_b32 v148, 16, v178
    v_and_b32 v149, s70, v178
    v_lshlrev_b32 v150, 16, v179
    v_and_b32 v151, s70, v179
    v_lshlrev_b32 v152, 16, v180
    v_and_b32 v153, s70, v180
    v_lshlrev_b32 v154, 16, v181
    v_and_b32 v155, s70, v181
    v_lshlrev_b32 v156, 16, v182
    v_and_b32 v157, s70, v182
    v_lshlrev_b32 v158, 16, v183
    v_and_b32 v159, s70, v183
    v_pk_mul_f32 v[144:145], v[144:145], v[80:81]
    v_pk_mul_f32 v[146:147], v[146:147], v[82:83]
    v_pk_mul_f32 v[148:149], v[148:149], v[84:85]
    v_pk_mul_f32 v[150:151], v[150:151], v[86:87]
    v_pk_mul_f32 v[152:153], v[152:153], v[88:89]
    v_pk_mul_f32 v[154:155], v[154:155], v[90:91]
    v_pk_mul_f32 v[156:157], v[156:157], v[92:93]
    v_pk_mul_f32 v[158:159], v[158:159], v[94:95]
    v_cvt_pk_bf16_f32 v176, v144, v145
    v_cvt_pk_bf16_f32 v177, v146, v147
    v_cvt_pk_bf16_f32 v178, v148, v149
    v_cvt_pk_bf16_f32 v179, v150, v151
    v_cvt_pk_bf16_f32 v180, v152, v153
    v_cvt_pk_bf16_f32 v181, v154, v155
    v_cvt_pk_bf16_f32 v182, v156, v157
    v_cvt_pk_bf16_f32 v183, v158, v159
    ds_write_b128 v9, v[176:179] offset:0
    ds_write_b128 v9, v[180:183] offset:4096
    s_waitcnt vmcnt(20)
    v_lshlrev_b32 v144, 16, v184
    v_and_b32 v145, s70, v184
    v_lshlrev_b32 v146, 16, v185
    v_and_b32 v147, s70, v185
    v_lshlrev_b32 v148, 16, v186
    v_and_b32 v149, s70, v186
    v_lshlrev_b32 v150, 16, v187
    v_and_b32 v151, s70, v187
    v_lshlrev_b32 v152, 16, v188
    v_and_b32 v153, s70, v188
    v_lshlrev_b32 v154, 16, v189
    v_and_b32 v155, s70, v189
    v_lshlrev_b32 v156, 16, v190
    v_and_b32 v157, s70, v190
    v_lshlrev_b32 v158, 16, v191
    v_and_b32 v159, s70, v191
    v_pk_mul_f32 v[144:145], v[144:145], v[96:97]
    v_pk_mul_f32 v[146:147], v[146:147], v[98:99]
    v_pk_mul_f32 v[148:149], v[148:149], v[100:101]
    v_pk_mul_f32 v[150:151], v[150:151], v[102:103]
    v_pk_mul_f32 v[152:153], v[152:153], v[104:105]
    v_pk_mul_f32 v[154:155], v[154:155], v[106:107]
    v_pk_mul_f32 v[156:157], v[156:157], v[108:109]
    v_pk_mul_f32 v[158:159], v[158:159], v[110:111]
    v_cvt_pk_bf16_f32 v184, v144, v145
    v_cvt_pk_bf16_f32 v185, v146, v147
    v_cvt_pk_bf16_f32 v186, v148, v149
    v_cvt_pk_bf16_f32 v187, v150, v151
    v_cvt_pk_bf16_f32 v188, v152, v153
    v_cvt_pk_bf16_f32 v189, v154, v155
    v_cvt_pk_bf16_f32 v190, v156, v157
    v_cvt_pk_bf16_f32 v191, v158, v159
    ds_write_b128 v9, v[184:187] offset:1024
    ds_write_b128 v9, v[188:191] offset:5120
    s_waitcnt vmcnt(18)
    v_lshlrev_b32 v144, 16, v192
    v_and_b32 v145, s70, v192
    v_lshlrev_b32 v146, 16, v193
    v_and_b32 v147, s70, v193
    v_lshlrev_b32 v148, 16, v194
    v_and_b32 v149, s70, v194
    v_lshlrev_b32 v150, 16, v195
    v_and_b32 v151, s70, v195
    v_lshlrev_b32 v152, 16, v196
    v_and_b32 v153, s70, v196
    v_lshlrev_b32 v154, 16, v197
    v_and_b32 v155, s70, v197
    v_lshlrev_b32 v156, 16, v198
    v_and_b32 v157, s70, v198
    v_lshlrev_b32 v158, 16, v199
    v_and_b32 v159, s70, v199
    v_pk_mul_f32 v[144:145], v[144:145], v[112:113]
    v_pk_mul_f32 v[146:147], v[146:147], v[114:115]
    v_pk_mul_f32 v[148:149], v[148:149], v[116:117]
    v_pk_mul_f32 v[150:151], v[150:151], v[118:119]
    v_pk_mul_f32 v[152:153], v[152:153], v[120:121]
    v_pk_mul_f32 v[154:155], v[154:155], v[122:123]
    v_pk_mul_f32 v[156:157], v[156:157], v[124:125]
    v_pk_mul_f32 v[158:159], v[158:159], v[126:127]
    v_cvt_pk_bf16_f32 v192, v144, v145
    v_cvt_pk_bf16_f32 v193, v146, v147
    v_cvt_pk_bf16_f32 v194, v148, v149
    v_cvt_pk_bf16_f32 v195, v150, v151
    v_cvt_pk_bf16_f32 v196, v152, v153
    v_cvt_pk_bf16_f32 v197, v154, v155
    v_cvt_pk_bf16_f32 v198, v156, v157
    v_cvt_pk_bf16_f32 v199, v158, v159
    ds_write_b128 v9, v[192:195] offset:2048
    ds_write_b128 v9, v[196:199] offset:6144
    s_waitcnt vmcnt(16)
    v_lshlrev_b32 v144, 16, v200
    v_and_b32 v145, s70, v200
    v_lshlrev_b32 v146, 16, v201
    v_and_b32 v147, s70, v201
    v_lshlrev_b32 v148, 16, v202
    v_and_b32 v149, s70, v202
    v_lshlrev_b32 v150, 16, v203
    v_and_b32 v151, s70, v203
    v_lshlrev_b32 v152, 16, v204
    v_and_b32 v153, s70, v204
    v_lshlrev_b32 v154, 16, v205
    v_and_b32 v155, s70, v205
    v_lshlrev_b32 v156, 16, v206
    v_and_b32 v157, s70, v206
    v_lshlrev_b32 v158, 16, v207
    v_and_b32 v159, s70, v207
    v_pk_mul_f32 v[144:145], v[144:145], v[128:129]
    v_pk_mul_f32 v[146:147], v[146:147], v[130:131]
    v_pk_mul_f32 v[148:149], v[148:149], v[132:133]
    v_pk_mul_f32 v[150:151], v[150:151], v[134:135]
    v_pk_mul_f32 v[152:153], v[152:153], v[136:137]
    v_pk_mul_f32 v[154:155], v[154:155], v[138:139]
    v_pk_mul_f32 v[156:157], v[156:157], v[140:141]
    v_pk_mul_f32 v[158:159], v[158:159], v[142:143]
    v_cvt_pk_bf16_f32 v200, v144, v145
    v_cvt_pk_bf16_f32 v201, v146, v147
    v_cvt_pk_bf16_f32 v202, v148, v149
    v_cvt_pk_bf16_f32 v203, v150, v151
    v_cvt_pk_bf16_f32 v204, v152, v153
    v_cvt_pk_bf16_f32 v205, v154, v155
    v_cvt_pk_bf16_f32 v206, v156, v157
    v_cvt_pk_bf16_f32 v207, v158, v159
    ds_write_b128 v9, v[200:203] offset:3072
    ds_write_b128 v9, v[204:207] offset:7168
    s_waitcnt vmcnt(8)
    v_mov_b32 v12, 135168
    v_mov_b32 v13, s71
    s_mov_b64 exec, 1
    ds_add_u32 v12, v13 offset:24
    s_mov_b64 exec, -1
    s_branch L_hq2
    s_nop 11
L_hq:
    v_mov_b32 v12, 135168
    v_mov_b32 v13, 1
    s_mov_b64 exec, 1
    ds_add_u32 v12, v13 offset:32
    s_mov_b64 exec, -1
    s_waitcnt vmcnt(14)
    v_lshlrev_b32 v144, 16, v176
    v_and_b32 v145, s70, v176
    v_lshlrev_b32 v146, 16, v177
    v_and_b32 v147, s70, v177
    v_lshlrev_b32 v148, 16, v178
    v_and_b32 v149, s70, v178
    v_lshlrev_b32 v150, 16, v179
    v_and_b32 v151, s70, v179
    v_lshlrev_b32 v152, 16, v180
    v_and_b32 v153, s70, v180
    v_lshlrev_b32 v154, 16, v181
    v_and_b32 v155, s70, v181
    v_lshlrev_b32 v156, 16, v182
    v_and_b32 v157, s70, v182
    v_lshlrev_b32 v158, 16, v183
    v_and_b32 v159, s70, v183
    v_pk_mul_f32 v[144:145], v[144:145], v[80:81]
    v_pk_mul_f32 v[146:147], v[146:147], v[82:83]
    v_pk_mul_f32 v[148:149], v[148:149], v[84:85]
    v_pk_mul_f32 v[150:151], v[150:151], v[86:87]
    v_pk_mul_f32 v[152:153], v[152:153], v[88:89]
    v_pk_mul_f32 v[154:155], v[154:155], v[90:91]
    v_pk_mul_f32 v[156:157], v[156:157], v[92:93]
    v_pk_mul_f32 v[158:159], v[158:159], v[94:95]
    v_cvt_pk_bf16_f32 v176, v144, v145
    v_cvt_pk_bf16_f32 v177, v146, v147
    v_cvt_pk_bf16_f32 v178, v148, v149
    v_cvt_pk_bf16_f32 v179, v150, v151
    v_cvt_pk_bf16_f32 v180, v152, v153
    v_cvt_pk_bf16_f32 v181, v154, v155
    v_cvt_pk_bf16_f32 v182, v156, v157
    v_cvt_pk_bf16_f32 v183, v158, v159
    ds_write_b128 v9, v[176:179] offset:0
    ds_write_b128 v9, v[180:183] offset:4096
    s_waitcnt vmcnt(12)
    v_lshlrev_b32 v144, 16, v184
    v_and_b32 v145, s70, v184
    v_lshlrev_b32 v146, 16, v185
    v_and_b32 v147, s70, v185
    v_lshlrev_b32 v148, 16, v186
    v_and_b32 v149, s70, v186
    v_lshlrev_b32 v150, 16, v187
    v_and_b32 v151, s70, v187
    v_lshlrev_b32 v152, 16, v188
    v_and_b32 v153, s70, v188
    v_lshlrev_b32 v154, 16, v189
    v_and_b32 v155, s70, v189
    v_lshlrev_b32 v156, 16, v190
    v_and_b32 v157, s70, v190
    v_lshlrev_b32 v158, 16, v191
    v_and_b32 v159, s70, v191
    v_pk_mul_f32 v[144:145], v[144:145], v[96:97]
    v_pk_mul_f32 v[146:147], v[146:147], v[98:99]
    v_pk_mul_f32 v[148:149], v[148:149], v[100:101]
    v_pk_mul_f32 v[150:151], v[150:151], v[102:103]
    v_pk_mul_f32 v[152:153], v[152:153], v[104:105]
    v_pk_mul_f32 v[154:155], v[154:155], v[106:107]
    v_pk_mul_f32 v[156:157], v[156:157], v[108:109]
    v_pk_mul_f32 v[158:159], v[158:159], v[110:111]
    v_cvt_pk_bf16_f32 v184, v144, v145
    v_cvt_pk_bf16_f32 v185, v146, v147
    v_cvt_pk_bf16_f32 v186, v148, v149
    v_cvt_pk_bf16_f32 v187, v150, v151
    v_cvt_pk_bf16_f32 v188, v152, v153
    v_cvt_pk_bf16_f32 v189, v154, v155
    v_cvt_pk_bf16_f32 v190, v156, v157
    v_cvt_pk_bf16_f32 v191, v158, v159
    ds_write_b128 v9, v[184:187] offset:1024
    ds_write_b128 v9, v[188:191] offset:5120
    s_waitcnt vmcnt(10)
    v_lshlrev_b32 v144, 16, v192
    v_and_b32 v145, s70, v192
    v_lshlrev_b32 v146, 16, v193
    v_and_b32 v147, s70, v193
    v_lshlrev_b32 v148, 16, v194
    v_and_b32 v149, s70, v194
    v_lshlrev_b32 v150, 16, v195
    v_and_b32 v151, s70, v195
    v_lshlrev_b32 v152, 16, v196
    v_and_b32 v153, s70, v196
    v_lshlrev_b32 v154, 16, v197
    v_and_b32 v155, s70, v197
    v_lshlrev_b32 v156, 16, v198
    v_and_b32 v157, s70, v198
    v_lshlrev_b32 v158, 16, v199
    v_and_b32 v159, s70, v199
    v_pk_mul_f32 v[144:145], v[144:145], v[112:113]
    v_pk_mul_f32 v[146:147], v[146:147], v[114:115]
    v_pk_mul_f32 v[148:149], v[148:149], v[116:117]
    v_pk_mul_f32 v[150:151], v[150:151], v[118:119]
    v_pk_mul_f32 v[152:153], v[152:153], v[120:121]
    v_pk_mul_f32 v[154:155], v[154:155], v[122:123]
    v_pk_mul_f32 v[156:157], v[156:157], v[124:125]
    v_pk_mul_f32 v[158:159], v[158:159], v[126:127]
    v_cvt_pk_bf16_f32 v192, v144, v145
    v_cvt_pk_bf16_f32 v193, v146, v147
    v_cvt_pk_bf16_f32 v194, v148, v149
    v_cvt_pk_bf16_f32 v195, v150, v151
    v_cvt_pk_bf16_f32 v196, v152, v153
    v_cvt_pk_bf16_f32 v197, v154, v155
    v_cvt_pk_bf16_f32 v198, v156, v157
    v_cvt_pk_bf16_f32 v199, v158, v159
    ds_write_b128 v9, v[192:195] offset:2048
    ds_write_b128 v9, v[196:199] offset:6144
    s_waitcnt vmcnt(8)
    v_lshlrev_b32 v144, 16, v200
    v_and_b32 v145, s70, v200
    v_lshlrev_b32 v146, 16, v201
    v_and_b32 v147, s70, v201
    v_lshlrev_b32 v148, 16, v202
    v_and_b32 v149, s70, v202
    v_lshlrev_b32 v150, 16, v203
    v_and_b32 v151, s70, v203
    v_lshlrev_b32 v152, 16, v204
    v_and_b32 v153, s70, v204
    v_lshlrev_b32 v154, 16, v205
    v_and_b32 v155, s70, v205
    v_lshlrev_b32 v156, 16, v206
    v_and_b32 v157, s70, v206
    v_lshlrev_b32 v158, 16, v207
    v_and_b32 v159, s70, v207
    v_pk_mul_f32 v[144:145], v[144:145], v[128:129]
    v_pk_mul_f32 v[146:147], v[146:147], v[130:131]
    v_pk_mul_f32 v[148:149], v[148:149], v[132:133]
    v_pk_mul_f32 v[150:151], v[150:151], v[134:135]
    v_pk_mul_f32 v[152:153], v[152:153], v[136:137]
    v_pk_mul_f32 v[154:155], v[154:155], v[138:139]
    v_pk_mul_f32 v[156:157], v[156:157], v[140:141]
    v_pk_mul_f32 v[158:159], v[158:159], v[142:143]
    v_cvt_pk_bf16_f32 v200, v144, v145
    v_cvt_pk_bf16_f32 v201, v146, v147
    v_cvt_pk_bf16_f32 v202, v148, v149
    v_cvt_pk_bf16_f32 v203, v150, v151
    v_cvt_pk_bf16_f32 v204, v152, v153
    v_cvt_pk_bf16_f32 v205, v154, v155
    v_cvt_pk_bf16_f32 v206, v156, v157
    v_cvt_pk_bf16_f32 v207, v158, v159
    ds_write_b128 v9, v[200:203] offset:3072
    ds_write_b128 v9, v[204:207] offset:7168
    s_waitcnt vmcnt(0)
    v_mov_b32 v12, 135168
    v_mov_b32 v13, s71
    s_mov_b64 exec, 1
    ds_add_u32 v12, v13 offset:24
    s_mov_b64 exec, -1
    v_mov_b32 v12, 135168
L_spin3:
    ds_read_b32 v13, v12 offset:32
    s_waitcnt lgkmcnt(0)
    v_readfirstlane_b32 s38, v13
    s_nop 1
    s_cmp_ge_u32 s38, 4
    s_cbranch_scc1 L_spun4
    s_sleep 1
    s_branch L_spin3
L_spun4:
    buffer_load_dwordx4 v[208:211], v1, s[4:7], s36 offen offset:0 nt
    buffer_load_dwordx4 v[212:215], v1, s[4:7], s36 offen offset:256 nt
    buffer_load_dwordx4 v[216:219], v1, s[4:7], s36 offen offset:64 nt
    buffer_load_dwordx4 v[220:223], v1, s[4:7], s36 offen offset:320 nt
    buffer_load_dwordx4 v[224:227], v1, s[4:7], s36 offen offset:128 nt
    buffer_load_dwordx4 v[228:231], v1, s[4:7], s36 offen offset:384 nt
    buffer_load_dwordx4 v[232:235], v1, s[4:7], s36 offen offset:192 nt
    buffer_load_dwordx4 v[236:239], v1, s[4:7], s36 offen offset:448 nt
    v_mov_b32 v12, 135168
    v_mov_b32 v13, 1
    s_mov_b64 exec, 1
    ds_add_u32 v12, v13 offset:32
    s_mov_b64 exec, -1
L_hq2:
    s_waitcnt vmcnt(0)
    v_lshlrev_b32 v112, 16, v208
    v_and_b32 v113, s70, v208
    v_lshlrev_b32 v114, 16, v209
    v_and_b32 v115, s70, v209
    v_lshlrev_b32 v116, 16, v210
    v_and_b32 v117, s70, v210
    v_lshlrev_b32 v118, 16, v211
    v_and_b32 v119, s70, v211
    v_pk_mul_f32 v[16:17], v[16:17], v[112:113]
    v_pk_mul_f32 v[18:19], v[18:19], v[114:115]
    v_pk_mul_f32 v[20:21], v[20:21], v[116:117]
    v_pk_mul_f32 v[22:23], v[22:23], v[118:119]
    v_lshlrev_b32 v112, 16, v212
    v_and_b32 v113, s70, v212
    v_lshlrev_b32 v114, 16, v213
    v_and_b32 v115, s70, v213
    v_lshlrev_b32 v116, 16, v214
    v_and_b32 v117, s70, v214
    v_lshlrev_b32 v118, 16, v215
    v_and_b32 v119, s70, v215
    v_pk_mul_f32 v[48:49], v[48:49], v[112:113]
    v_pk_mul_f32 v[50:51], v[50:51], v[114:115]
    v_pk_mul_f32 v[52:53], v[52:53], v[116:117]
    v_pk_mul_f32 v[54:55], v[54:55], v[118:119]
    v_lshlrev_b32 v112, 16, v216
    v_and_b32 v113, s70, v216
    v_lshlrev_b32 v114, 16, v217
    v_and_b32 v115, s70, v217
    v_lshlrev_b32 v116, 16, v218
    v_and_b32 v117, s70, v218
    v_lshlrev_b32 v118, 16, v219
    v_and_b32 v119, s70, v219
    v_pk_mul_f32 v[24:25], v[24:25], v[112:113]
    v_pk_mul_f32 v[26:27], v[26:27], v[114:115]
    v_pk_mul_f32 v[28:29], v[28:29], v[116:117]
    v_pk_mul_f32 v[30:31], v[30:31], v[118:119]
    v_lshlrev_b32 v112, 16, v220
    v_and_b32 v113, s70, v220
    v_lshlrev_b32 v114, 16, v221
    v_and_b32 v115, s70, v221
    v_lshlrev_b32 v116, 16, v222
    v_and_b32 v117, s70, v222
    v_lshlrev_b32 v118, 16, v223
    v_and_b32 v119, s70, v223
    v_pk_mul_f32 v[56:57], v[56:57], v[112:113]
    v_pk_mul_f32 v[58:59], v[58:59], v[114:115]
    v_pk_mul_f32 v[60:61], v[60:61], v[116:117]
    v_pk_mul_f32 v[62:63], v[62:63], v[118:119]
    v_lshlrev_b32 v112, 16, v224
    v_and_b32 v113, s70, v224
    v_lshlrev_b32 v114, 16, v225
    v_and_b32 v115, s70, v225
    v_lshlrev_b32 v116, 16, v226
    v_and_b32 v117, s70, v226
    v_lshlrev_b32 v118, 16, v227
    v_and_b32 v119, s70, v227
    v_pk_mul_f32 v[32:33], v[32:33], v[112:113]
    v_pk_mul_f32 v[34:35], v[34:35], v[114:115]
    v_pk_mul_f32 v[36:37], v[36:37], v[116:117]
    v_pk_mul_f32 v[38:39], v[38:39], v[118:119]
    v_lshlrev_b32 v112, 16, v228
    v_and_b32 v113, s70, v228
    v_lshlrev_b32 v114, 16, v229
    v_and_b32 v115, s70, v229
    v_lshlrev_b32 v116, 16, v230
    v_and_b32 v117, s70, v230
    v_lshlrev_b32 v118, 16, v231
    v_and_b32 v119, s70, v231
    v_pk_mul_f32 v[64:65], v[64:65], v[112:113]
    v_pk_mul_f32 v[66:67], v[66:67], v[114:115]
    v_pk_mul_f32 v[68:69], v[68:69], v[116:117]
    v_pk_mul_f32 v[70:71], v[70:71], v[118:119]
    v_lshlrev_b32 v112, 16, v232
    v_and_b32 v113, s70, v232
    v_lshlrev_b32 v114, 16, v233
    v_and_b32 v115, s70, v233
    v_lshlrev_b32 v116, 16, v234
    v_and_b32 v117, s70, v234
    v_lshlrev_b32 v118, 16, v235
    v_and_b32 v119, s70, v235
    v_pk_mul_f32 v[40:41], v[40:41], v[112:113]
    v_pk_mul_f32 v[42:43], v[42:43], v[114:115]
    v_pk_mul_f32 v[44:45], v[44:45], v[116:117]
    v_pk_mul_f32 v[46:47], v[46:47], v[118:119]
    v_lshlrev_b32 v112, 16, v236
    v_and_b32 v113, s70, v236
    v_lshlrev_b32 v114, 16, v237
    v_and_b32 v115, s70, v237
    v_lshlrev_b32 v116, 16, v238
    v_and_b32 v117, s70, v238
    v_lshlrev_b32 v118, 16, v239
    v_and_b32 v119, s70, v239
    v_pk_mul_f32 v[72:73], v[72:73], v[112:113]
    v_pk_mul_f32 v[74:75], v[74:75], v[114:115]
    v_pk_mul_f32 v[76:77], v[76:77], v[116:117]
    v_pk_mul_f32 v[78:79], v[78:79], v[118:119]
    v_mov_b32 v12, 135168
L_spin5:
    ds_read_b32 v13, v12 offset:24
    s_waitcnt lgkmcnt(0)
    v_readfirstlane_b32 s38, v13
    s_nop 1
    s_bitcmp1_b32 s38, 18
    s_cbranch_scc1 L_spun6
    s_sleep 1
    s_branch L_spin5
L_spun6:
    v_mov_b32 v12, 135168
L_spin7:
    ds_read_b32 v13, v12 offset:24
    s_waitcnt lgkmcnt(0)
    v_readfirstlane_b32 s38, v13
    s_nop 1
    s_bitcmp1_b32 s38, 22
    s_cbranch_scc1 L_spun8
    s_sleep 1
    s_branch L_spin7
L_spun8:
    v_mov_b32 v12, 135168
L_spin9:
    ds_read_b32 v13, v12 offset:24
    s_waitcnt lgkmcnt(0)
    v_readfirstlane_b32 s38, v13
    s_nop 1
    s_bitcmp1_b32 s38, 26
    s_cbranch_scc1 L_spun10
    s_sleep 1
    s_branch L_spin9
L_spun10:
    v_mov_b32 v12, 135168
L_spin11:
    ds_read_b32 v13, v12 offset:24
    s_waitcnt lgkmcnt(0)
    v_readfirstlane_b32 s38, v13
    s_nop 1
    s_bitcmp1_b32 s38, 30
    s_cbranch_scc1 L_spun12
    s_sleep 1
    s_branch L_spin11
L_spun12:
    s_mov_b32 s95, 100
    s_branch L_phase2
    s_nop 11
L_light:
    s_setprio 1
    v_mov_b32 v6, 1.0
    v_lshrrev_b32 v11, 2, v7
    v_and_b32 v12, 3, v7
    v_lshrrev_b32 v13, 1, v12
    v_lshlrev_b32 v13, 3, v13
    v_xor_b32 v11, v11, v13
    v_lshlrev_b32 v11, 4, v11
    v_lshl_add_u32 v11, v12, 8, v11
    v_and_b32 v12, 1, v12
    v_lshl_add_u32 v4, v12, 3, v11
    v_xor_b32 v5, 8, v4
    v_lshlrev_b32 v11, 2, v10
    v_add_u32 v12, 0, v11
    v_cmp_le_u32 s[40:41], v12, v9
    v_cmp_lt_u32 s[48:49], v12, v9
    v_add_u32 v12, 1, v11
    v_cmp_le_u32 s[42:43], v12, v9
    v_cmp_lt_u32 s[50:51], v12, v9
    v_add_u32 v12, 2, v11
    v_cmp_le_u32 s[44:45], v12, v9
    v_cmp_lt_u32 s[52:53], v12, v9
    v_add_u32 v12, 3, v11
    v_cmp_le_u32 s[46:47], v12, v9
    v_cmp_lt_u32 s[54:55], v12, v9
    s_waitcnt vmcnt(6)
    v_lshlrev_b32 v16, 16, v144
    v_and_b32 v17, s70, v144
    v_lshlrev_b32 v18, 16, v145
    v_and_b32 v19, s70, v145
    v_lshlrev_b32 v20, 16, v146
    v_and_b32 v21, s70, v146
    v_lshlrev_b32 v22, 16, v147
    v_and_b32 v23, s70, v147
    v_lshlrev_b32 v112, 16, v148
    v_and_b32 v113, s70, v148
    v_lshlrev_b32 v114, 16, v149
    v_and_b32 v115, s70, v149
    v_lshlrev_b32 v116, 16, v150
    v_and_b32 v117, s70, v150
    v_lshlrev_b32 v118, 16, v151
    v_and_b32 v119, s70, v151
    v_pk_mul_f32 v[16:17], v[16:17], s[62:63]
    v_pk_mul_f32 v[18:19], v[18:19], s[62:63]
    v_pk_mul_f32 v[20:21], v[20:21], s[62:63]
    v_pk_mul_f32 v[22:23], v[22:23], s[62:63]
    v_pk_mul_f32 v[112:113], v[112:113], s[62:63]
    v_pk_mul_f32 v[114:115], v[114:115], s[62:63]
    v_pk_mul_f32 v[116:117], v[116:117], s[62:63]
    v_pk_mul_f32 v[118:119], v[118:119], s[62:63]
    v_exp_f32 v16, v16
    v_exp_f32 v17, v17
    v_exp_f32 v18, v18
    v_exp_f32 v19, v19
    v_exp_f32 v20, v20
    v_exp_f32 v21, v21
    v_exp_f32 v22, v22
    v_exp_f32 v23, v23
    v_exp_f32 v112, v112
    v_exp_f32 v113, v113
    v_exp_f32 v114, v114
    v_exp_f32 v115, v115
    v_exp_f32 v116, v116
    v_exp_f32 v117, v117
    v_exp_f32 v118, v118
    v_exp_f32 v119, v119
    v_pk_add_f32 v[16:17], v[16:17], s[66:67]
    v_pk_add_f32 v[18:19], v[18:19], s[66:67]
    v_pk_add_f32 v[20:21], v[20:21], s[66:67]
    v_pk_add_f32 v[22:23], v[22:23], s[66:67]
    v_pk_add_f32 v[112:113], v[112:113], s[66:67]
    v_pk_add_f32 v[114:115], v[114:115], s[66:67]
    v_pk_add_f32 v[116:117], v[116:117], s[66:67]
    v_pk_add_f32 v[118:119], v[118:119], s[66:67]
    v_pk_mul_f32 v[80:81], v[16:17], v[112:113]
    v_pk_mul_f32 v[82:83], v[18:19], v[114:115]
    v_pk_mul_f32 v[84:85], v[20:21], v[116:117]
    v_pk_mul_f32 v[86:87], v[22:23], v[118:119]
    v_pk_add_f32 v[120:121], v[80:81], s[68:69]
    v_pk_add_f32 v[122:123], v[82:83], s[68:69]
    v_pk_add_f32 v[124:125], v[84:85], s[68:69]
    v_pk_add_f32 v[126:127], v[86:87], s[68:69]
    v_add_f32_dpp v48, v120, v6 row_shl:1 row_mask:0xf bank_mask:0xf bound_ctrl:0
    v_add_f32_dpp v49, v121, v6 row_shl:1 row_mask:0xf bank_mask:0xf bound_ctrl:0
    v_add_f32_dpp v50, v122, v6 row_shl:1 row_mask:0xf bank_mask:0xf bound_ctrl:0
    v_add_f32_dpp v51, v123, v6 row_shl:1 row_mask:0xf bank_mask:0xf bound_ctrl:0
    v_add_f32_dpp v52, v124, v6 row_shl:1 row_mask:0xf bank_mask:0xf bound_ctrl:0
    v_add_f32_dpp v53, v125, v6 row_shl:1 row_mask:0xf bank_mask:0xf bound_ctrl:0
    v_add_f32_dpp v54, v126, v6 row_shl:1 row_mask:0xf bank_mask:0xf bound_ctrl:0
    v_add_f32_dpp v55, v127, v6 row_shl:1 row_mask:0xf bank_mask:0xf bound_ctrl:0
    v_mul_f32_dpp v48, v48, v48 row_shl:1 row_mask:0xf bank_mask:0xf
    v_mul_f32_dpp v49, v49, v49 row_shl:1 row_mask:0xf bank_mask:0xf
    v_mul_f32_dpp v50, v50, v50 row_shl:1 row_mask:0xf bank_mask:0xf
    v_mul_f32_dpp v51, v51, v51 row_shl:1 row_mask:0xf bank_mask:0xf
    v_mul_f32_dpp v52, v52, v52 row_shl:1 row_mask:0xf bank_mask:0xf
    v_mul_f32_dpp v53, v53, v53 row_shl:1 row_mask:0xf bank_mask:0xf
    v_mul_f32_dpp v54, v54, v54 row_shl:1 row_mask:0xf bank_mask:0xf
    v_mul_f32_dpp v55, v55, v55 row_shl:1 row_mask:0xf bank_mask:0xf
    v_mul_f32_dpp v48, v48, v48 row_shl:2 row_mask:0xf bank_mask:0xf
    v_mul_f32_dpp v49, v49, v49 row_shl:2 row_mask:0xf bank_mask:0xf
    v_mul_f32_dpp v50, v50, v50 row_shl:2 row_mask:0xf bank_mask:0xf
    v_mul_f32_dpp v51, v51, v51 row_shl:2 row_mask:0xf bank_mask:0xf
    v_mul_f32_dpp v52, v52, v52 row_shl:2 row_mask:0xf bank_mask:0xf
    v_mul_f32_dpp v53, v53, v53 row_shl:2 row_mask:0xf bank_mask:0xf
    v_mul_f32_dpp v54, v54, v54 row_shl:2 row_mask:0xf bank_mask:0xf
    v_mul_f32_dpp v55, v55, v55 row_shl:2 row_mask:0xf bank_mask:0xf
    v_mul_f32_dpp v48, v48, v48 row_shl:4 row_mask:0xf bank_mask:0xf
    v_mul_f32_dpp v49, v49, v49 row_shl:4 row_mask:0xf bank_mask:0xf
    v_mul_f32_dpp v50, v50, v50 row_shl:4 row_mask:0xf bank_mask:0xf
    v_mul_f32_dpp v51, v51, v51 row_shl:4 row_mask:0xf bank_mask:0xf
    v_mul_f32_dpp v52, v52, v52 row_shl:4 row_mask:0xf bank_mask:0xf
    v_mul_f32_dpp v53, v53, v53 row_shl:4 row_mask:0xf bank_mask:0xf
    v_mul_f32_dpp v54, v54, v54 row_shl:4 row_mask:0xf bank_mask:0xf
    v_mul_f32_dpp v55, v55, v55 row_shl:4 row_mask:0xf bank_mask:0xf
    v_mul_f32_dpp v48, v48, v48 row_shl:8 row_mask:0xf bank_mask:0xf
    v_mul_f32_dpp v49, v49, v49 row_shl:8 row_mask:0xf bank_mask:0xf
    v_mul_f32_dpp v50, v50, v50 row_shl:8 row_mask:0xf bank_mask:0xf
    v_mul_f32_dpp v51, v51, v51 row_shl:8 row_mask:0xf bank_mask:0xf
    v_mul_f32_dpp v52, v52, v52 row_shl:8 row_mask:0xf bank_mask:0xf
    v_mul_f32_dpp v53, v53, v53 row_shl:8 row_mask:0xf bank_mask:0xf
    v_mul_f32_dpp v54, v54, v54 row_shl:8 row_mask:0xf bank_mask:0xf
    v_mul_f32_dpp v55, v55, v55 row_shl:8 row_mask:0xf bank_mask:0xf
    v_pk_mul_f32 v[16:17], v[48:49], v[112:113]
    v_pk_mul_f32 v[18:19], v[50:51], v[114:115]
    v_pk_mul_f32 v[20:21], v[52:53], v[116:117]
    v_pk_mul_f32 v[22:23], v[54:55], v[118:119]
    v_pk_mul_f32 v[80:81], v[48:49], v[80:81]
    v_pk_mul_f32 v[82:83], v[50:51], v[82:83]
    v_pk_mul_f32 v[84:85], v[52:53], v[84:85]
    v_pk_mul_f32 v[86:87], v[54:55], v[86:87]
    s_waitcnt vmcnt(4)
    v_lshlrev_b32 v24, 16, v152
    v_and_b32 v25, s70, v152
    v_lshlrev_b32 v26, 16, v153
    v_and_b32 v27, s70, v153
    v_lshlrev_b32 v28, 16, v154
    v_and_b32 v29, s70, v154
    v_lshlrev_b32 v30, 16, v155
    v_and_b32 v31, s70, v155
    v_lshlrev_b32 v112, 16, v156
    v_and_b32 v113, s70, v156
    v_lshlrev_b32 v114, 16, v157
    v_and_b32 v115, s70, v157
    v_lshlrev_b32 v116, 16, v158
    v_and_b32 v117, s70, v158
    v_lshlrev_b32 v118, 16, v159
    v_and_b32 v119, s70, v159
    v_pk_mul_f32 v[24:25], v[24:25], s[62:63]
    v_pk_mul_f32 v[26:27], v[26:27], s[62:63]
    v_pk_mul_f32 v[28:29], v[28:29], s[62:63]
    v_pk_mul_f32 v[30:31], v[30:31], s[62:63]
    v_pk_mul_f32 v[112:113], v[112:113], s[62:63]
    v_pk_mul_f32 v[114:115], v[114:115], s[62:63]
    v_pk_mul_f32 v[116:117], v[116:117], s[62:63]
    v_pk_mul_f32 v[118:119], v[118:119], s[62:63]
    v_exp_f32 v24, v24
    v_exp_f32 v25, v25
    v_exp_f32 v26, v26
    v_exp_f32 v27, v27
    v_exp_f32 v28, v28
    v_exp_f32 v29, v29
    v_exp_f32 v30, v30
    v_exp_f32 v31, v31
    v_exp_f32 v112, v112
    v_exp_f32 v113, v113
    v_exp_f32 v114, v114
    v_exp_f32 v115, v115
    v_exp_f32 v116, v116
    v_exp_f32 v117, v117
    v_exp_f32 v118, v118
    v_exp_f32 v119, v119
    v_pk_add_f32 v[24:25], v[24:25], s[66:67]
    v_pk_add_f32 v[26:27], v[26:27], s[66:67]
    v_pk_add_f32 v[28:29], v[28:29], s[66:67]
    v_pk_add_f32 v[30:31], v[30:31], s[66:67]
    v_pk_add_f32 v[112:113], v[112:113], s[66:67]
    v_pk_add_f32 v[114:115], v[114:115], s[66:67]
    v_pk_add_f32 v[116:117], v[116:117], s[66:67]
    v_pk_add_f32 v[118:119], v[118:119], s[66:67]
    v_pk_mul_f32 v[88:89], v[24:25], v[112:113]
    v_pk_mul_f32 v[90:91], v[26:27], v[114:115]
    v_pk_mul_f32 v[92:93], v[28:29], v[116:117]
    v_pk_mul_f32 v[94:95], v[30:31], v[118:119]
    v_pk_add_f32 v[120:121], v[88:89], s[68:69]
    v_pk_add_f32 v[122:123], v[90:91], s[68:69]
    v_pk_add_f32 v[124:125], v[92:93], s[68:69]
    v_pk_add_f32 v[126:127], v[94:95], s[68:69]
    v_add_f32_dpp v56, v120, v6 row_shl:1 row_mask:0xf bank_mask:0xf bound_ctrl:0
    v_add_f32_dpp v57, v121, v6 row_shl:1 row_mask:0xf bank_mask:0xf bound_ctrl:0
    v_add_f32_dpp v58, v122, v6 row_shl:1 row_mask:0xf bank_mask:0xf bound_ctrl:0
    v_add_f32_dpp v59, v123, v6 row_shl:1 row_mask:0xf bank_mask:0xf bound_ctrl:0
    v_add_f32_dpp v60, v124, v6 row_shl:1 row_mask:0xf bank_mask:0xf bound_ctrl:0
    v_add_f32_dpp v61, v125, v6 row_shl:1 row_mask:0xf bank_mask:0xf bound_ctrl:0
    v_add_f32_dpp v62, v126, v6 row_shl:1 row_mask:0xf bank_mask:0xf bound_ctrl:0
    v_add_f32_dpp v63, v127, v6 row_shl:1 row_mask:0xf bank_mask:0xf bound_ctrl:0
    v_mul_f32_dpp v56, v56, v56 row_shl:1 row_mask:0xf bank_mask:0xf
    v_mul_f32_dpp v57, v57, v57 row_shl:1 row_mask:0xf bank_mask:0xf
    v_mul_f32_dpp v58, v58, v58 row_shl:1 row_mask:0xf bank_mask:0xf
    v_mul_f32_dpp v59, v59, v59 row_shl:1 row_mask:0xf bank_mask:0xf
    v_mul_f32_dpp v60, v60, v60 row_shl:1 row_mask:0xf bank_mask:0xf
    v_mul_f32_dpp v61, v61, v61 row_shl:1 row_mask:0xf bank_mask:0xf
    v_mul_f32_dpp v62, v62, v62 row_shl:1 row_mask:0xf bank_mask:0xf
    v_mul_f32_dpp v63, v63, v63 row_shl:1 row_mask:0xf bank_mask:0xf
    v_mul_f32_dpp v56, v56, v56 row_shl:2 row_mask:0xf bank_mask:0xf
    v_mul_f32_dpp v57, v57, v57 row_shl:2 row_mask:0xf bank_mask:0xf
    v_mul_f32_dpp v58, v58, v58 row_shl:2 row_mask:0xf bank_mask:0xf
    v_mul_f32_dpp v59, v59, v59 row_shl:2 row_mask:0xf bank_mask:0xf
    v_mul_f32_dpp v60, v60, v60 row_shl:2 row_mask:0xf bank_mask:0xf
    v_mul_f32_dpp v61, v61, v61 row_shl:2 row_mask:0xf bank_mask:0xf
    v_mul_f32_dpp v62, v62, v62 row_shl:2 row_mask:0xf bank_mask:0xf
    v_mul_f32_dpp v63, v63, v63 row_shl:2 row_mask:0xf bank_mask:0xf
    v_mul_f32_dpp v56, v56, v56 row_shl:4 row_mask:0xf bank_mask:0xf
    v_mul_f32_dpp v57, v57, v57 row_shl:4 row_mask:0xf bank_mask:0xf
    v_mul_f32_dpp v58, v58, v58 row_shl:4 row_mask:0xf bank_mask:0xf
    v_mul_f32_dpp v59, v59, v59 row_shl:4 row_mask:0xf bank_mask:0xf
    v_mul_f32_dpp v60, v60, v60 row_shl:4 row_mask:0xf bank_mask:0xf
    v_mul_f32_dpp v61, v61, v61 row_shl:4 row_mask:0xf bank_mask:0xf
    v_mul_f32_dpp v62, v62, v62 row_shl:4 row_mask:0xf bank_mask:0xf
    v_mul_f32_dpp v63, v63, v63 row_shl:4 row_mask:0xf bank_mask:0xf
    v_mul_f32_dpp v56, v56, v56 row_shl:8 row_mask:0xf bank_mask:0xf
    v_mul_f32_dpp v57, v57, v57 row_shl:8 row_mask:0xf bank_mask:0xf
    v_mul_f32_dpp v58, v58, v58 row_shl:8 row_mask:0xf bank_mask:0xf
    v_mul_f32_dpp v59, v59, v59 row_shl:8 row_mask:0xf bank_mask:0xf
    v_mul_f32_dpp v60, v60, v60 row_shl:8 row_mask:0xf bank_mask:0xf
    v_mul_f32_dpp v61, v61, v61 row_shl:8 row_mask:0xf bank_mask:0xf
    v_mul_f32_dpp v62, v62, v62 row_shl:8 row_mask:0xf bank_mask:0xf
    v_mul_f32_dpp v63, v63, v63 row_shl:8 row_mask:0xf bank_mask:0xf
    v_pk_mul_f32 v[24:25], v[56:57], v[112:113]
    v_pk_mul_f32 v[26:27], v[58:59], v[114:115]
    v_pk_mul_f32 v[28:29], v[60:61], v[116:117]
    v_pk_mul_f32 v[30:31], v[62:63], v[118:119]
    v_pk_mul_f32 v[88:89], v[56:57], v[88:89]
    v_pk_mul_f32 v[90:91], v[58:59], v[90:91]
    v_pk_mul_f32 v[92:93], v[60:61], v[92:93]
    v_pk_mul_f32 v[94:95], v[62:63], v[94:95]
    s_cmp_eq_u32 s34, 0
    s_cbranch_scc0 L_noatomic
    s_mov_b32 s37, 0
    s_nop 11
L_nonce:
    s_add_u32 s37, s37, 1
    v_cmp_eq_u32 vcc, s37, v15
    s_nop 4
    s_cbranch_vccnz L_nonce
    v_mov_b32 v14, s37
    v_mov_b32 v15, 0
    s_lshl_b32 s38, s32, 3
    v_mov_b32 v13, s38
    s_mov_b64 exec, 1
    buffer_atomic_cmpswap v[14:15], v13, s[24:27], 0 offen sc0 sc1
    s_branch L_atomic_done
    s_nop 11
L_noatomic:
    v_mov_b32 v13, 0
    s_mov_b64 exec, 1
    buffer_load_dword v14, v13, s[16:19], s36 offen
L_atomic_done:
    s_mov_b64 exec, -1
    buffer_load_dwordx4 v[176:179], v1, s[8:11], s36 offen offset:0 nt
    buffer_load_dwordx4 v[180:183], v1, s[8:11], s36 offen offset:256 nt
    buffer_load_dwordx4 v[184:187], v1, s[8:11], s36 offen offset:64 nt
    buffer_load_dwordx4 v[188:191], v1, s[8:11], s36 offen offset:320 nt
    buffer_load_dwordx4 v[192:195], v1, s[8:11], s36 offen offset:128 nt
    buffer_load_dwordx4 v[196:199], v1, s[8:11], s36 offen offset:384 nt
    buffer_load_dwordx4 v[200:203], v1, s[8:11], s36 offen offset:192 nt
    buffer_load_dwordx4 v[204:207], v1, s[8:11], s36 offen offset:448 nt
    s_waitcnt vmcnt(11)
    v_lshlrev_b32 v32, 16, v160
    v_and_b32 v33, s70, v160
    v_lshlrev_b32 v34, 16, v161
    v_and_b32 v35, s70, v161
    v_lshlrev_b32 v36, 16, v162
    v_and_b32 v37, s70, v162
    v_lshlrev_b32 v38, 16, v163
    v_and_b32 v39, s70, v163
    v_lshlrev_b32 v112, 16, v164
    v_and_b32 v113, s70, v164
    v_lshlrev_b32 v114, 16, v165
    v_and_b32 v115, s70, v165
    v_lshlrev_b32 v116, 16, v166
    v_and_b32 v117, s70, v166
    v_lshlrev_b32 v118, 16, v167
    v_and_b32 v119, s70, v167
    v_pk_mul_f32 v[32:33], v[32:33], s[62:63]
    v_pk_mul_f32 v[34:35], v[34:35], s[62:63]
    v_pk_mul_f32 v[36:37], v[36:37], s[62:63]
    v_pk_mul_f32 v[38:39], v[38:39], s[62:63]
    v_pk_mul_f32 v[112:113], v[112:113], s[62:63]
    v_pk_mul_f32 v[114:115], v[114:115], s[62:63]
    v_pk_mul_f32 v[116:117], v[116:117], s[62:63]
    v_pk_mul_f32 v[118:119], v[118:119], s[62:63]
    v_exp_f32 v32, v32
    v_exp_f32 v33, v33
    v_exp_f32 v34, v34
    v_exp_f32 v35, v35
    v_exp_f32 v36, v36
    v_exp_f32 v37, v37
    v_exp_f32 v38, v38
    v_exp_f32 v39, v39
    v_exp_f32 v112, v112
    v_exp_f32 v113, v113
    v_exp_f32 v114, v114
    v_exp_f32 v115, v115
    v_exp_f32 v116, v116
    v_exp_f32 v117, v117
    v_exp_f32 v118, v118
    v_exp_f32 v119, v119
    v_pk_add_f32 v[32:33], v[32:33], s[66:67]
    v_pk_add_f32 v[34:35], v[34:35], s[66:67]
    v_pk_add_f32 v[36:37], v[36:37], s[66:67]
    v_pk_add_f32 v[38:39], v[38:39], s[66:67]
    v_pk_add_f32 v[112:113], v[112:113], s[66:67]
    v_pk_add_f32 v[114:115], v[114:115], s[66:67]
    v_pk_add_f32 v[116:117], v[116:117], s[66:67]
    v_pk_add_f32 v[118:119], v[118:119], s[66:67]
    v_pk_mul_f32 v[96:97], v[32:33], v[112:113]
    v_pk_mul_f32 v[98:99], v[34:35], v[114:115]
    v_pk_mul_f32 v[100:101], v[36:37], v[116:117]
    v_pk_mul_f32 v[102:103], v[38:39], v[118:119]
    v_pk_add_f32 v[120:121], v[96:97], s[68:69]
    v_pk_add_f32 v[122:123], v[98:99], s[68:69]
    v_pk_add_f32 v[124:125], v[100:101], s[68:69]
    v_pk_add_f32 v[126:127], v[102:103], s[68:69]
    v_add_f32_dpp v64, v120, v6 row_shl:1 row_mask:0xf bank_mask:0xf bound_ctrl:0
    v_add_f32_dpp v65, v121, v6 row_shl:1 row_mask:0xf bank_mask:0xf bound_ctrl:0
    v_add_f32_dpp v66, v122, v6 row_shl:1 row_mask:0xf bank_mask:0xf bound_ctrl:0
    v_add_f32_dpp v67, v123, v6 row_shl:1 row_mask:0xf bank_mask:0xf bound_ctrl:0
    v_add_f32_dpp v68, v124, v6 row_shl:1 row_mask:0xf bank_mask:0xf bound_ctrl:0
    v_add_f32_dpp v69, v125, v6 row_shl:1 row_mask:0xf bank_mask:0xf bound_ctrl:0
    v_add_f32_dpp v70, v126, v6 row_shl:1 row_mask:0xf bank_mask:0xf bound_ctrl:0
    v_add_f32_dpp v71, v127, v6 row_shl:1 row_mask:0xf bank_mask:0xf bound_ctrl:0
    v_mul_f32_dpp v64, v64, v64 row_shl:1 row_mask:0xf bank_mask:0xf
    v_mul_f32_dpp v65, v65, v65 row_shl:1 row_mask:0xf bank_mask:0xf
    v_mul_f32_dpp v66, v66, v66 row_shl:1 row_mask:0xf bank_mask:0xf
    v_mul_f32_dpp v67, v67, v67 row_shl:1 row_mask:0xf bank_mask:0xf
    v_mul_f32_dpp v68, v68, v68 row_shl:1 row_mask:0xf bank_mask:0xf
    v_mul_f32_dpp v69, v69, v69 row_shl:1 row_mask:0xf bank_mask:0xf
    v_mul_f32_dpp v70, v70, v70 row_shl:1 row_mask:0xf bank_mask:0xf
    v_mul_f32_dpp v71, v71, v71 row_shl:1 row_mask:0xf bank_mask:0xf
    v_mul_f32_dpp v64, v64, v64 row_shl:2 row_mask:0xf bank_mask:0xf
    v_mul_f32_dpp v65, v65, v65 row_shl:2 row_mask:0xf bank_mask:0xf
    v_mul_f32_dpp v66, v66, v66 row_shl:2 row_mask:0xf bank_mask:0xf
    v_mul_f32_dpp v67, v67, v67 row_shl:2 row_mask:0xf bank_mask:0xf
    v_mul_f32_dpp v68, v68, v68 row_shl:2 row_mask:0xf bank_mask:0xf
    v_mul_f32_dpp v69, v69, v69 row_shl:2 row_mask:0xf bank_mask:0xf
    v_mul_f32_dpp v70, v70, v70 row_shl:2 row_mask:0xf bank_mask:0xf
    v_mul_f32_dpp v71, v71, v71 row_shl:2 row_mask:0xf bank_mask:0xf
    v_mul_f32_dpp v64, v64, v64 row_shl:4 row_mask:0xf bank_mask:0xf
    v_mul_f32_dpp v65, v65, v65 row_shl:4 row_mask:0xf bank_mask:0xf
    v_mul_f32_dpp v66, v66, v66 row_shl:4 row_mask:0xf bank_mask:0xf
    v_mul_f32_dpp v67, v67, v67 row_shl:4 row_mask:0xf bank_mask:0xf
    v_mul_f32_dpp v68, v68, v68 row_shl:4 row_mask:0xf bank_mask:0xf
    v_mul_f32_dpp v69, v69, v69 row_shl:4 row_mask:0xf bank_mask:0xf
    v_mul_f32_dpp v70, v70, v70 row_shl:4 row_mask:0xf bank_mask:0xf
    v_mul_f32_dpp v71, v71, v71 row_shl:4 row_mask:0xf bank_mask:0xf
    v_mul_f32_dpp v64, v64, v64 row_shl:8 row_mask:0xf bank_mask:0xf
    v_mul_f32_dpp v65, v65, v65 row_shl:8 row_mask:0xf bank_mask:0xf
    v_mul_f32_dpp v66, v66, v66 row_shl:8 row_mask:0xf bank_mask:0xf
    v_mul_f32_dpp v67, v67, v67 row_shl:8 row_mask:0xf bank_mask:0xf
    v_mul_f32_dpp v68, v68, v68 row_shl:8 row_mask:0xf bank_mask:0xf
    v_mul_f32_dpp v69, v69, v69 row_shl:8 row_mask:0xf bank_mask:0xf
    v_mul_f32_dpp v70, v70, v70 row_shl:8 row_mask:0xf bank_mask:0xf
    v_mul_f32_dpp v71, v71, v71 row_shl:8 row_mask:0xf bank_mask:0xf
    v_pk_mul_f32 v[32:33], v[64:65], v[112:113]
    v_pk_mul_f32 v[34:35], v[66:67], v[114:115]
    v_pk_mul_f32 v[36:37], v[68:69], v[116:117]
    v_pk_mul_f32 v[38:39], v[70:71], v[118:119]
    v_pk_mul_f32 v[96:97], v[64:65], v[96:97]
    v_pk_mul_f32 v[98:99], v[66:67], v[98:99]
    v_pk_mul_f32 v[100:101], v[68:69], v[100:101]
    v_pk_mul_f32 v[102:103], v[70:71], v[102:103]
    s_waitcnt vmcnt(9)
    v_lshlrev_b32 v40, 16, v168
    v_and_b32 v41, s70, v168
    v_lshlrev_b32 v42, 16, v169
    v_and_b32 v43, s70, v169
    v_lshlrev_b32 v44, 16, v170
    v_and_b32 v45, s70, v170
    v_lshlrev_b32 v46, 16, v171
    v_and_b32 v47, s70, v171
    v_lshlrev_b32 v112, 16, v172
    v_and_b32 v113, s70, v172
    v_lshlrev_b32 v114, 16, v173
    v_and_b32 v115, s70, v173
    v_lshlrev_b32 v116, 16, v174
    v_and_b32 v117, s70, v174
    v_lshlrev_b32 v118, 16, v175
    v_and_b32 v119, s70, v175
    v_pk_mul_f32 v[40:41], v[40:41], s[62:63]
    v_pk_mul_f32 v[42:43], v[42:43], s[62:63]
    v_pk_mul_f32 v[44:45], v[44:45], s[62:63]
    v_pk_mul_f32 v[46:47], v[46:47], s[62:63]
    v_pk_mul_f32 v[112:113], v[112:113], s[62:63]
    v_pk_mul_f32 v[114:115], v[114:115], s[62:63]
    v_pk_mul_f32 v[116:117], v[116:117], s[62:63]
    v_pk_mul_f32 v[118:119], v[118:119], s[62:63]
    v_exp_f32 v40, v40
    v_exp_f32 v41, v41
    v_exp_f32 v42, v42
    v_exp_f32 v43, v43
    v_exp_f32 v44, v44
    v_exp_f32 v45, v45
    v_exp_f32 v46, v46
    v_exp_f32 v47, v47
    v_exp_f32 v112, v112
    v_exp_f32 v113, v113
    v_exp_f32 v114, v114
    v_exp_f32 v115, v115
    v_exp_f32 v116, v116
    v_exp_f32 v117, v117
    v_exp_f32 v118, v118
    v_exp_f32 v119, v119
    v_pk_add_f32 v[40:41], v[40:41], s[66:67]
    v_pk_add_f32 v[42:43], v[42:43], s[66:67]
    v_pk_add_f32 v[44:45], v[44:45], s[66:67]
    v_pk_add_f32 v[46:47], v[46:47], s[66:67]
    v_pk_add_f32 v[112:113], v[112:113], s[66:67]
    v_pk_add_f32 v[114:115], v[114:115], s[66:67]
    v_pk_add_f32 v[116:117], v[116:117], s[66:67]
    v_pk_add_f32 v[118:119], v[118:119], s[66:67]
    v_pk_mul_f32 v[104:105], v[40:41], v[112:113]
    v_pk_mul_f32 v[106:107], v[42:43], v[114:115]
    v_pk_mul_f32 v[108:109], v[44:45], v[116:117]
    v_pk_mul_f32 v[110:111], v[46:47], v[118:119]
    v_pk_add_f32 v[120:121], v[104:105], s[68:69]
    v_pk_add_f32 v[122:123], v[106:107], s[68:69]
    v_pk_add_f32 v[124:125], v[108:109], s[68:69]
    v_pk_add_f32 v[126:127], v[110:111], s[68:69]
    v_add_f32_dpp v72, v120, v6 row_shl:1 row_mask:0xf bank_mask:0xf bound_ctrl:0
    v_add_f32_dpp v73, v121, v6 row_shl:1 row_mask:0xf bank_mask:0xf bound_ctrl:0
    v_add_f32_dpp v74, v122, v6 row_shl:1 row_mask:0xf bank_mask:0xf bound_ctrl:0
    v_add_f32_dpp v75, v123, v6 row_shl:1 row_mask:0xf bank_mask:0xf bound_ctrl:0
    v_add_f32_dpp v76, v124, v6 row_shl:1 row_mask:0xf bank_mask:0xf bound_ctrl:0
    v_add_f32_dpp v77, v125, v6 row_shl:1 row_mask:0xf bank_mask:0xf bound_ctrl:0
    v_add_f32_dpp v78, v126, v6 row_shl:1 row_mask:0xf bank_mask:0xf bound_ctrl:0
    v_add_f32_dpp v79, v127, v6 row_shl:1 row_mask:0xf bank_mask:0xf bound_ctrl:0
    v_mul_f32_dpp v72, v72, v72 row_shl:1 row_mask:0xf bank_mask:0xf
    v_mul_f32_dpp v73, v73, v73 row_shl:1 row_mask:0xf bank_mask:0xf
    v_mul_f32_dpp v74, v74, v74 row_shl:1 row_mask:0xf bank_mask:0xf
    v_mul_f32_dpp v75, v75, v75 row_shl:1 row_mask:0xf bank_mask:0xf
    v_mul_f32_dpp v76, v76, v76 row_shl:1 row_mask:0xf bank_mask:0xf
    v_mul_f32_dpp v77, v77, v77 row_shl:1 row_mask:0xf bank_mask:0xf
    v_mul_f32_dpp v78, v78, v78 row_shl:1 row_mask:0xf bank_mask:0xf
    v_mul_f32_dpp v79, v79, v79 row_shl:1 row_mask:0xf bank_mask:0xf
    v_mul_f32_dpp v72, v72, v72 row_shl:2 row_mask:0xf bank_mask:0xf
    v_mul_f32_dpp v73, v73, v73 row_shl:2 row_mask:0xf bank_mask:0xf
    v_mul_f32_dpp v74, v74, v74 row_shl:2 row_mask:0xf bank_mask:0xf
    v_mul_f32_dpp v75, v75, v75 row_shl:2 row_mask:0xf bank_mask:0xf
    v_mul_f32_dpp v76, v76, v76 row_shl:2 row_mask:0xf bank_mask:0xf
    v_mul_f32_dpp v77, v77, v77 row_shl:2 row_mask:0xf bank_mask:0xf
    v_mul_f32_dpp v78, v78, v78 row_shl:2 row_mask:0xf bank_mask:0xf
    v_mul_f32_dpp v79, v79, v79 row_shl:2 row_mask:0xf bank_mask:0xf
    v_mul_f32_dpp v72, v72, v72 row_shl:4 row_mask:0xf bank_mask:0xf
    v_mul_f32_dpp v73, v73, v73 row_shl:4 row_mask:0xf bank_mask:0xf
    v_mul_f32_dpp v74, v74, v74 row_shl:4 row_mask:0xf bank_mask:0xf
    v_mul_f32_dpp v75, v75, v75 row_shl:4 row_mask:0xf bank_mask:0xf
    v_mul_f32_dpp v76, v76, v76 row_shl:4 row_mask:0xf bank_mask:0xf
    v_mul_f32_dpp v77, v77, v77 row_shl:4 row_mask:0xf bank_mask:0xf
    v_mul_f32_dpp v78, v78, v78 row_shl:4 row_mask:0xf bank_mask:0xf
    v_mul_f32_dpp v79, v79, v79 row_shl:4 row_mask:0xf bank_mask:0xf
    v_mul_f32_dpp v72, v72, v72 row_shl:8 row_mask:0xf bank_mask:0xf
    v_mul_f32_dpp v73, v73, v73 row_shl:8 row_mask:0xf bank_mask:0xf
    v_mul_f32_dpp v74, v74, v74 row_shl:8 row_mask:0xf bank_mask:0xf
    v_mul_f32_dpp v75, v75, v75 row_shl:8 row_mask:0xf bank_mask:0xf
    v_mul_f32_dpp v76, v76, v76 row_shl:8 row_mask:0xf bank_mask:0xf
    v_mul_f32_dpp v77, v77, v77 row_shl:8 row_mask:0xf bank_mask:0xf
    v_mul_f32_dpp v78, v78, v78 row_shl:8 row_mask:0xf bank_mask:0xf
    v_mul_f32_dpp v79, v79, v79 row_shl:8 row_mask:0xf bank_mask:0xf
    v_pk_mul_f32 v[40:41], v[72:73], v[112:113]
    v_pk_mul_f32 v[42:43], v[74:75], v[114:115]
    v_pk_mul_f32 v[44:45], v[76:77], v[116:117]
    v_pk_mul_f32 v[46:47], v[78:79], v[118:119]
    v_pk_mul_f32 v[104:105], v[72:73], v[104:105]
    v_pk_mul_f32 v[106:107], v[74:75], v[106:107]
    v_pk_mul_f32 v[108:109], v[76:77], v[108:109]
    v_pk_mul_f32 v[110:111], v[78:79], v[110:111]
    s_lshl_b32 s38, s35, 9
    s_add_u32 s38, s38, 131072
    v_lshlrev_b32 v8, 5, v10
    v_add_u32 v8, s38, v8
    s_mov_b64 exec, s[60:61]
    ds_write_b128 v8, v[80:83] offset:0
    ds_write_b128 v8, v[84:87] offset:16
    ds_write_b128 v8, v[88:91] offset:128
    ds_write_b128 v8, v[92:95] offset:144
    ds_write_b128 v8, v[96:99] offset:256
    ds_write_b128 v8, v[100:103] offset:272
    ds_write_b128 v8, v[104:107] offset:384
    ds_write_b128 v8, v[108:111] offset:400
    s_mov_b64 exec, -1
    v_lshlrev_b32 v8, 3, v7
    v_add_u32 v8, s38, v8
    ds_read_b64 v[112:113], v8
    s_mov_b32 s38, 0x5f800000
    s_waitcnt lgkmcnt(0)
    v_cmp_nge_f32 s[72:73], s38, v112
    v_cmp_nge_f32 vcc, s38, v113
    v_rcp_f32 v112, v112
    v_rcp_f32 v113, v113
    s_or_b64 s[72:73], s[72:73], vcc
    ds_write_b64 v8, v[112:113]
    v_mov_b32 v12, 135168
    v_mov_b32 v13, 1
    s_mov_b64 exec, 1
    ds_add_u32 v12, v13 offset:4
    s_mov_b64 exec, -1
    v_rcp_f32 v80, v16
    v_rcp_f32 v81, v17
    v_rcp_f32 v82, v18
    v_rcp_f32 v83, v19
    v_rcp_f32 v84, v20
    v_rcp_f32 v85, v21
    v_rcp_f32 v86, v22
    v_rcp_f32 v87, v23
    v_rcp_f32 v88, v48
    v_rcp_f32 v89, v49
    v_rcp_f32 v90, v50
    v_rcp_f32 v91, v51
    v_rcp_f32 v92, v52
    v_rcp_f32 v93, v53
    v_rcp_f32 v94, v54
    v_rcp_f32 v95, v55
    v_rcp_f32 v96, v24
    v_rcp_f32 v97, v25
    v_rcp_f32 v98, v26
    v_rcp_f32 v99, v27
    v_rcp_f32 v100, v28
    v_rcp_f32 v101, v29
    v_rcp_f32 v102, v30
    v_rcp_f32 v103, v31
    v_rcp_f32 v104, v56
    v_rcp_f32 v105, v57
    v_rcp_f32 v106, v58
    v_rcp_f32 v107, v59
    v_rcp_f32 v108, v60
    v_rcp_f32 v109, v61
    v_rcp_f32 v110, v62
    v_rcp_f32 v111, v63
    v_rcp_f32 v112, v32
    v_rcp_f32 v113, v33
    v_rcp_f32 v114, v34
    v_rcp_f32 v115, v35
    v_rcp_f32 v116, v36
    v_rcp_f32 v117, v37
    v_rcp_f32 v118, v38
    v_rcp_f32 v119, v39
    v_rcp_f32 v120, v64
    v_rcp_f32 v121, v65
    v_rcp_f32 v122, v66
    v_rcp_f32 v123, v67
    v_rcp_f32 v124, v68
    v_rcp_f32 v125, v69
    v_rcp_f32 v126, v70
    v_rcp_f32 v127, v71
    v_rcp_f32 v128, v40
    v_rcp_f32 v129, v41
    v_rcp_f32 v130, v42
    v_rcp_f32 v131, v43
    v_rcp_f32 v132, v44
    v_rcp_f32 v133, v45
    v_rcp_f32 v134, v46
    v_rcp_f32 v135, v47
    v_rcp_f32 v136, v72
    v_rcp_f32 v137, v73
    v_rcp_f32 v138, v74
    v_rcp_f32 v139, v75
    v_rcp_f32 v140, v76
    v_rcp_f32 v141, v77
    v_rcp_f32 v142, v78
    v_rcp_f32 v143, v79
    v_pk_mul_f32 v[80:81], v[80:81], s[64:65]
    v_pk_mul_f32 v[82:83], v[82:83], s[64:65]
    v_pk_mul_f32 v[84:85], v[84:85], s[64:65]
    v_pk_mul_f32 v[86:87], v[86:87], s[64:65]
    v_pk_mul_f32 v[88:89], v[88:89], s[64:65]
    v_pk_mul_f32 v[90:91], v[90:91], s[64:65]
    v_pk_mul_f32 v[92:93], v[92:93], s[64:65]
    v_pk_mul_f32 v[94:95], v[94:95], s[64:65]
    v_pk_mul_f32 v[96:97], v[96:97], s[64:65]
    v_pk_mul_f32 v[98:99], v[98:99], s[64:65]
    v_pk_mul_f32 v[100:101], v[100:101], s[64:65]
    v_pk_mul_f32 v[102:103], v[102:103], s[64:65]
    v_pk_mul_f32 v[104:105], v[104:105], s[64:65]
    v_pk_mul_f32 v[106:107], v[106:107], s[64:65]
    v_pk_mul_f32 v[108:109], v[108:109], s[64:65]
    v_pk_mul_f32 v[110:111], v[110:111], s[64:65]
    v_pk_mul_f32 v[112:113], v[112:113], s[64:65]
    v_pk_mul_f32 v[114:115], v[114:115], s[64:65]
    v_pk_mul_f32 v[116:117], v[116:117], s[64:65]
    v_pk_mul_f32 v[118:119], v[118:119], s[64:65]
    v_pk_mul_f32 v[120:121], v[120:121], s[64:65]
    v_pk_mul_f32 v[122:123], v[122:123], s[64:65]
    v_pk_mul_f32 v[124:125], v[124:125], s[64:65]
    v_pk_mul_f32 v[126:127], v[126:127], s[64:65]
    v_pk_mul_f32 v[128:129], v[128:129], s[64:65]
    v_pk_mul_f32 v[130:131], v[130:131], s[64:65]
    v_pk_mul_f32 v[132:133], v[132:133], s[64:65]
    v_pk_mul_f32 v[134:135], v[134:135], s[64:65]
    v_pk_mul_f32 v[136:137], v[136:137], s[64:65]
    v_pk_mul_f32 v[138:139], v[138:139], s[64:65]
    v_pk_mul_f32 v[140:141], v[140:141], s[64:65]
    v_pk_mul_f32 v[142:143], v[142:143], s[64:65]
    s_lshl_b32 s38, s35, 13
    v_add_u32 v9, s38, v3
    s_and_b32 s71, s34, 3
    s_andn2_b32 s76, s36, 0xffff
    s_lshl_b32 s38, s71, 7
    s_add_u32 s76, s76, s38
    s_lshl_b32 s77, s71, 11
    s_add_u32 s77, s77, 65536
    s_add_u32 m0, s77, 0
    s_nop 0
    buffer_load_dwordx4 v2, s[12:15], s76 offen offset:0 nt lds
    s_add_u32 m0, s77, 960
    s_nop 0
    buffer_load_dwordx4 v2, s[12:15], s76 offen offset:64 nt lds
    s_add_u32 s76, s76, 8192
    s_add_u32 m0, s77, 8192
    s_nop 0
    buffer_load_dwordx4 v2, s[12:15], s76 offen offset:0 nt lds
    s_add_u32 m0, s77, 9152
    s_nop 0
    buffer_load_dwordx4 v2, s[12:15], s76 offen offset:64 nt lds
    s_add_u32 s76, s76, 8192
    s_add_u32 m0, s77, 16384
    s_nop 0
    buffer_load_dwordx4 v2, s[12:15], s76 offen offset:0 nt lds
    s_add_u32 m0, s77, 17344
    s_nop 0
    buffer_load_dwordx4 v2, s[12:15], s76 offen offset:64 nt lds
    s_add_u32 s76, s76, 8192
    s_add_u32 m0, s77, 24576
    s_nop 0
    buffer_load_dwordx4 v2, s[12:15], s76 offen offset:0 nt lds
    s_add_u32 m0, s77, 25536
    s_nop 0
    buffer_load_dwordx4 v2, s[12:15], s76 offen offset:64 nt lds
    s_waitcnt vmcnt(14)
    v_lshlrev_b32 v144, 16, v176
    v_and_b32 v145, s70, v176
    v_lshlrev_b32 v146, 16, v177
    v_and_b32 v147, s70, v177
    v_lshlrev_b32 v148, 16, v178
    v_and_b32 v149, s70, v178
    v_lshlrev_b32 v150, 16, v179
    v_and_b32 v151, s70, v179
    v_lshlrev_b32 v152, 16, v180
    v_and_b32 v153, s70, v180
    v_lshlrev_b32 v154, 16, v181
    v_and_b32 v155, s70, v181
    v_lshlrev_b32 v156, 16, v182
    v_and_b32 v157, s70, v182
    v_lshlrev_b32 v158, 16, v183
    v_and_b32 v159, s70, v183
    v_pk_mul_f32 v[144:145], v[144:145], v[80:81]
    v_pk_mul_f32 v[146:147], v[146:147], v[82:83]
    v_pk_mul_f32 v[148:149], v[148:149], v[84:85]
    v_pk_mul_f32 v[150:151], v[150:151], v[86:87]
    v_pk_mul_f32 v[152:153], v[152:153], v[88:89]
    v_pk_mul_f32 v[154:155], v[154:155], v[90:91]
    v_pk_mul_f32 v[156:157], v[156:157], v[92:93]
    v_pk_mul_f32 v[158:159], v[158:159], v[94:95]
    v_cvt_pk_bf16_f32 v176, v144, v145
    v_cvt_pk_bf16_f32 v177, v146, v147
    v_cvt_pk_bf16_f32 v178, v148, v149
    v_cvt_pk_bf16_f32 v179, v150, v151
    v_cvt_pk_bf16_f32 v180, v152, v153
    v_cvt_pk_bf16_f32 v181, v154, v155
    v_cvt_pk_bf16_f32 v182, v156, v157
    v_cvt_pk_bf16_f32 v183, v158, v159
    ds_write_b128 v9, v[176:179] offset:0
    ds_write_b128 v9, v[180:183] offset:4096
    s_waitcnt vmcnt(12)
    v_lshlrev_b32 v144, 16, v184
    v_and_b32 v145, s70, v184
    v_lshlrev_b32 v146, 16, v185
    v_and_b32 v147, s70, v185
    v_lshlrev_b32 v148, 16, v186
    v_and_b32 v149, s70, v186
    v_lshlrev_b32 v150, 16, v187
    v_and_b32 v151, s70, v187
    v_lshlrev_b32 v152, 16, v188
    v_and_b32 v153, s70, v188
    v_lshlrev_b32 v154, 16, v189
    v_and_b32 v155, s70, v189
    v_lshlrev_b32 v156, 16, v190
    v_and_b32 v157, s70, v190
    v_lshlrev_b32 v158, 16, v191
    v_and_b32 v159, s70, v191
    v_pk_mul_f32 v[144:145], v[144:145], v[96:97]
    v_pk_mul_f32 v[146:147], v[146:147], v[98:99]
    v_pk_mul_f32 v[148:149], v[148:149], v[100:101]
    v_pk_mul_f32 v[150:151], v[150:151], v[102:103]
    v_pk_mul_f32 v[152:153], v[152:153], v[104:105]
    v_pk_mul_f32 v[154:155], v[154:155], v[106:107]
    v_pk_mul_f32 v[156:157], v[156:157], v[108:109]
    v_pk_mul_f32 v[158:159], v[158:159], v[110:111]
    v_cvt_pk_bf16_f32 v184, v144, v145
    v_cvt_pk_bf16_f32 v185, v146, v147
    v_cvt_pk_bf16_f32 v186, v148, v149
    v_cvt_pk_bf16_f32 v187, v150, v151
    v_cvt_pk_bf16_f32 v188, v152, v153
    v_cvt_pk_bf16_f32 v189, v154, v155
    v_cvt_pk_bf16_f32 v190, v156, v157
    v_cvt_pk_bf16_f32 v191, v158, v159
    ds_write_b128 v9, v[184:187] offset:1024
    ds_write_b128 v9, v[188:191] offset:5120
    s_waitcnt vmcnt(10)
    v_lshlrev_b32 v144, 16, v192
    v_and_b32 v145, s70, v192
    v_lshlrev_b32 v146, 16, v193
    v_and_b32 v147, s70, v193
    v_lshlrev_b32 v148, 16, v194
    v_and_b32 v149, s70, v194
    v_lshlrev_b32 v150, 16, v195
    v_and_b32 v151, s70, v195
    v_lshlrev_b32 v152, 16, v196
    v_and_b32 v153, s70, v196
    v_lshlrev_b32 v154, 16, v197
    v_and_b32 v155, s70, v197
    v_lshlrev_b32 v156, 16, v198
    v_and_b32 v157, s70, v198
    v_lshlrev_b32 v158, 16, v199
    v_and_b32 v159, s70, v199
    v_pk_mul_f32 v[144:145], v[144:145], v[112:113]
    v_pk_mul_f32 v[146:147], v[146:147], v[114:115]
    v_pk_mul_f32 v[148:149], v[148:149], v[116:117]
    v_pk_mul_f32 v[150:151], v[150:151], v[118:119]
    v_pk_mul_f32 v[152:153], v[152:153], v[120:121]
    v_pk_mul_f32 v[154:155], v[154:155], v[122:123]
    v_pk_mul_f32 v[156:157], v[156:157], v[124:125]
    v_pk_mul_f32 v[158:159], v[158:159], v[126:127]
    v_cvt_pk_bf16_f32 v192, v144, v145
    v_cvt_pk_bf16_f32 v193, v146, v147
    v_cvt_pk_bf16_f32 v194, v148, v149
    v_cvt_pk_bf16_f32 v195, v150, v151
    v_cvt_pk_bf16_f32 v196, v152, v153
    v_cvt_pk_bf16_f32 v197, v154, v155
    v_cvt_pk_bf16_f32 v198, v156, v157
    v_cvt_pk_bf16_f32 v199, v158, v159
    ds_write_b128 v9, v[192:195] offset:2048
    ds_write_b128 v9, v[196:199] offset:6144
    s_waitcnt vmcnt(8)
    v_lshlrev_b32 v144, 16, v200
    v_and_b32 v145, s70, v200
    v_lshlrev_b32 v146, 16, v201
    v_and_b32 v147, s70, v201
    v_lshlrev_b32 v148, 16, v202
    v_and_b32 v149, s70, v202
    v_lshlrev_b32 v150, 16, v203
    v_and_b32 v151, s70, v203
    v_lshlrev_b32 v152, 16, v204
    v_and_b32 v153, s70, v204
    v_lshlrev_b32 v154, 16, v205
    v_and_b32 v155, s70, v205
    v_lshlrev_b32 v156, 16, v206
    v_and_b32 v157, s70, v206
    v_lshlrev_b32 v158, 16, v207
    v_and_b32 v159, s70, v207
    v_pk_mul_f32 v[144:145], v[144:145], v[128:129]
    v_pk_mul_f32 v[146:147], v[146:147], v[130:131]
    v_pk_mul_f32 v[148:149], v[148:149], v[132:133]
    v_pk_mul_f32 v[150:151], v[150:151], v[134:135]
    v_pk_mul_f32 v[152:153], v[152:153], v[136:137]
    v_pk_mul_f32 v[154:155], v[154:155], v[138:139]
    v_pk_mul_f32 v[156:157], v[156:157], v[140:141]
    v_pk_mul_f32 v[158:159], v[158:159], v[142:143]
    v_cvt_pk_bf16_f32 v200, v144, v145
    v_cvt_pk_bf16_f32 v201, v146, v147
    v_cvt_pk_bf16_f32 v202, v148, v149
    v_cvt_pk_bf16_f32 v203, v150, v151
    v_cvt_pk_bf16_f32 v204, v152, v153
    v_cvt_pk_bf16_f32 v205, v154, v155
    v_cvt_pk_bf16_f32 v206, v156, v157
    v_cvt_pk_bf16_f32 v207, v158, v159
    ds_write_b128 v9, v[200:203] offset:3072
    ds_write_b128 v9, v[204:207] offset:7168
    s_setprio 2
    s_cmp_eq_u32 s34, 0
    s_cbranch_scc0 L_nn
    v_readfirstlane_b32 s38, v14
    s_nop 1
    s_cmp_eq_u32 s38, 0
    s_cselect_b32 s37, s37, s38
    v_mov_b32 v14, s37
    v_mov_b32 v13, 135168
    ds_write_b32 v13, v14 offset:0
    s_nop 11
L_nn:
    s_lshl_b32 s38, s34, 10
    v_add_u32 v2, s38, v4
    v_add_u32 v3, s38, v5
    v_add_u32 v4, 65536, v4
    v_add_u32 v5, 65536, v5
    v_and_b32 v11, 1, v10
    v_lshlrev_b32 v11, 4, v11
    v_lshl_add_u32 v11, v10, 5, v11
    s_lshl_b32 s38, s34, 7
    s_add_u32 s38, s38, 131072
    v_add_u32 v6, s38, v11
    v_xor_b32 v8, 16, v6
    v_mov_b32 v12, 135168
L_spin13:
    ds_read_b32 v13, v12 offset:4
    s_waitcnt lgkmcnt(0)
    v_readfirstlane_b32 s38, v13
    s_nop 1
    s_cmp_ge_u32 s38, 8
    s_cbranch_scc1 L_spun14
    s_sleep 1
    s_branch L_spin13
L_spun14:
    ds_read_b128 v[248:251], v6 offset:0
    ds_read_b128 v[252:255], v8 offset:0
    s_mov_b32 s92, 0
    s_waitcnt vmcnt(6)
    v_mov_b32 v12, 135168
    v_mov_b32 v13, 1
    s_mov_b64 exec, 1
    ds_add_u32 v12, v13 offset:24
    s_mov_b64 exec, -1
    s_bitcmp1_b32 s92, 2
    s_cbranch_scc1 L_rdy15
    v_mov_b32 v12, 135168
L_spin16:
    ds_read_b32 v13, v12 offset:24
    s_waitcnt lgkmcnt(0)
    v_readfirstlane_b32 s38, v13
    s_nop 1
    s_bitcmp1_b32 s38, 2
    s_cbranch_scc1 L_spun17
    s_sleep 1
    s_branch L_spin16
L_spun17:
    s_mov_b32 s92, s38
L_rdy15:
    ds_read_b128 v[184:187], v6 offset:512
    ds_read_b128 v[188:191], v8 offset:512
    ds_read_b64_tr_b16 v[176:177], v2 offset:0
    ds_read_b64_tr_b16 v[178:179], v2 offset:4096
    ds_read_b64_tr_b16 v[180:181], v3 offset:0
    ds_read_b64_tr_b16 v[182:183], v3 offset:4096
    ds_read_b64_tr_b16 v[144:145], v4 offset:0
    ds_read_b64_tr_b16 v[146:147], v4 offset:4096
    ds_read_b64_tr_b16 v[148:149], v5 offset:0
    ds_read_b64_tr_b16 v[150:151], v5 offset:4096
    ds_read_b64_tr_b16 v[152:153], v4 offset:1024
    ds_read_b64_tr_b16 v[154:155], v4 offset:5120
    ds_read_b64_tr_b16 v[156:157], v5 offset:1024
    ds_read_b64_tr_b16 v[158:159], v5 offset:5120
    ds_read_b64_tr_b16 v[160:161], v4 offset:2048
    ds_read_b64_tr_b16 v[162:163], v4 offset:6144
    ds_read_b64_tr_b16 v[164:165], v5 offset:2048
    ds_read_b64_tr_b16 v[166:167], v5 offset:6144
    ds_read_b64_tr_b16 v[168:169], v4 offset:3072
    ds_read_b64_tr_b16 v[170:171], v4 offset:7168
    ds_read_b64_tr_b16 v[172:173], v5 offset:3072
    ds_read_b64_tr_b16 v[174:175], v5 offset:7168
    s_waitcnt lgkmcnt(14)
    v_mfma_f32_16x16x32_bf16 v[80:83], v[176:179], v[144:147], 0
    v_mul_f32 v248, v248, v184
    v_mul_f32 v249, v249, v185
    v_mul_f32 v250, v250, v186
    v_mul_f32 v251, v251, v187
    v_mfma_f32_16x16x32_bf16 v[112:115], v[180:183], v[144:147], 0
    v_mul_f32 v252, v252, v188
    v_mul_f32 v253, v253, v189
    v_mul_f32 v254, v254, v190
    v_mul_f32 v255, v255, v191
    s_waitcnt lgkmcnt(12)
    v_mfma_f32_16x16x32_bf16 v[84:87], v[176:179], v[148:151], 0
    v_mul_f32 v80, v80, v184
    v_mul_f32 v81, v81, v185
    v_mul_f32 v82, v82, v186
    v_mul_f32 v83, v83, v187
    v_mfma_f32_16x16x32_bf16 v[116:119], v[180:183], v[148:151], 0
    v_mul_f32 v112, v112, v188
    v_mul_f32 v113, v113, v189
    v_mul_f32 v114, v114, v190
    v_mul_f32 v115, v115, v191
    s_waitcnt lgkmcnt(10)
    v_mfma_f32_16x16x32_bf16 v[88:91], v[176:179], v[152:155], 0
    v_mul_f32 v84, v84, v184
    v_mul_f32 v85, v85, v185
    v_mul_f32 v86, v86, v186
    v_mul_f32 v87, v87, v187
    v_mfma_f32_16x16x32_bf16 v[120:123], v[180:183], v[152:155], 0
    v_mul_f32 v116, v116, v188
    v_mul_f32 v117, v117, v189
    v_mul_f32 v118, v118, v190
    v_mul_f32 v119, v119, v191
    s_waitcnt lgkmcnt(8)
    v_mfma_f32_16x16x32_bf16 v[92:95], v[176:179], v[156:159], 0
    v_mul_f32 v88, v88, v184
    v_mul_f32 v89, v89, v185
    v_mul_f32 v90, v90, v186
    v_mul_f32 v91, v91, v187
    v_mfma_f32_16x16x32_bf16 v[124:127], v[180:183], v[156:159], 0
    v_mul_f32 v120, v120, v188
    v_mul_f32 v121, v121, v189
    v_mul_f32 v122, v122, v190
    v_mul_f32 v123, v123, v191
    s_waitcnt lgkmcnt(0)
    v_mfma_f32_16x16x32_bf16 v[96:99], v[176:179], v[160:163], 0
    v_mul_f32 v92, v92, v184
    v_mul_f32 v93, v93, v185
    v_mul_f32 v94, v94, v186
    v_mul_f32 v95, v95, v187
    s_waitcnt vmcnt(4)
    v_mov_b32 v12, 135168
    v_mov_b32 v13, 16
    s_mov_b64 exec, 1
    ds_add_u32 v12, v13 offset:24
    s_mov_b64 exec, -1
    s_bitcmp1_b32 s92, 6
    s_cbranch_scc1 L_rdy18
    v_mov_b32 v12, 135168
L_spin19:
    ds_read_b32 v13, v12 offset:24
    s_waitcnt lgkmcnt(0)
    v_readfirstlane_b32 s38, v13
    s_nop 1
    s_bitcmp1_b32 s38, 6
    s_cbranch_scc1 L_spun20
    s_sleep 1
    s_branch L_spin19
L_spun20:
    s_mov_b32 s92, s38
L_rdy18:
    ds_read_b128 v[200:203], v6 offset:1024
    ds_read_b128 v[204:207], v8 offset:1024
    ds_read_b64_tr_b16 v[192:193], v2 offset:8192
    ds_read_b64_tr_b16 v[194:195], v2 offset:12288
    ds_read_b64_tr_b16 v[196:197], v3 offset:8192
    ds_read_b64_tr_b16 v[198:199], v3 offset:12288
    ds_read_b64_tr_b16 v[144:145], v4 offset:8192
    ds_read_b64_tr_b16 v[146:147], v4 offset:12288
    ds_read_b64_tr_b16 v[148:149], v5 offset:8192
    ds_read_b64_tr_b16 v[150:151], v5 offset:12288
    ds_read_b64_tr_b16 v[152:153], v4 offset:9216
    ds_read_b64_tr_b16 v[154:155], v4 offset:13312
    ds_read_b64_tr_b16 v[156:157], v5 offset:9216
    ds_read_b64_tr_b16 v[158:159], v5 offset:13312
    v_mfma_f32_16x16x32_bf16 v[128:131], v[180:183], v[160:163], 0
    v_mul_f32 v124, v124, v188
    v_mul_f32 v125, v125, v189
    v_mul_f32 v126, v126, v190
    v_mul_f32 v127, v127, v191
    v_mfma_f32_16x16x32_bf16 v[100:103], v[176:179], v[164:167], 0
    v_mul_f32 v96, v96, v184
    v_mul_f32 v97, v97, v185
    v_mul_f32 v98, v98, v186
    v_mul_f32 v99, v99, v187
    ds_read_b64_tr_b16 v[160:161], v4 offset:10240
    ds_read_b64_tr_b16 v[162:163], v4 offset:14336
    v_mfma_f32_16x16x32_bf16 v[132:135], v[180:183], v[164:167], 0
    v_mul_f32 v128, v128, v188
    v_mul_f32 v129, v129, v189
    v_mul_f32 v130, v130, v190
    v_mul_f32 v131, v131, v191
    v_mfma_f32_16x16x32_bf16 v[104:107], v[176:179], v[168:171], 0
    v_mul_f32 v100, v100, v184
    v_mul_f32 v101, v101, v185
    v_mul_f32 v102, v102, v186
    v_mul_f32 v103, v103, v187
    ds_read_b64_tr_b16 v[164:165], v5 offset:10240
    ds_read_b64_tr_b16 v[166:167], v5 offset:14336
    v_mfma_f32_16x16x32_bf16 v[136:139], v[180:183], v[168:171], 0
    v_mul_f32 v132, v132, v188
    v_mul_f32 v133, v133, v189
    v_mul_f32 v134, v134, v190
    v_mul_f32 v135, v135, v191
    v_mfma_f32_16x16x32_bf16 v[108:111], v[176:179], v[172:175], 0
    v_mul_f32 v104, v104, v184
    v_mul_f32 v105, v105, v185
    v_mul_f32 v106, v106, v186
    v_mul_f32 v107, v107, v187
    ds_read_b64_tr_b16 v[168:169], v4 offset:11264
    ds_read_b64_tr_b16 v[170:171], v4 offset:15360
    v_mfma_f32_16x16x32_bf16 v[140:143], v[180:183], v[172:175], 0
    v_mul_f32 v136, v136, v188
    v_mul_f32 v137, v137, v189
    v_mul_f32 v138, v138, v190
    v_mul_f32 v139, v139, v191
    v_mul_f32 v108, v108, v184
    v_mul_f32 v109, v109, v185
    v_mul_f32 v110, v110, v186
    v_mul_f32 v111, v111, v187
    ds_read_b64_tr_b16 v[172:173], v5 offset:11264
    ds_read_b64_tr_b16 v[174:175], v5 offset:15360
    v_mul_f32 v140, v140, v188
    v_mul_f32 v141, v141, v189
    v_mul_f32 v142, v142, v190
    v_mul_f32 v143, v143, v191
    s_waitcnt lgkmcnt(14)
    v_mfma_f32_16x16x32_bf16 v[80:83], v[192:195], v[144:147], v[80:83]
    v_mul_f32 v248, v248, v200
    v_mul_f32 v249, v249, v201
    v_mul_f32 v250, v250, v202
    v_mul_f32 v251, v251, v203
    v_mfma_f32_16x16x32_bf16 v[112:115], v[196:199], v[144:147], v[112:115]
    v_mul_f32 v252, v252, v204
    v_mul_f32 v253, v253, v205
    v_mul_f32 v254, v254, v206
    v_mul_f32 v255, v255, v207
    s_waitcnt lgkmcnt(12)
    v_mfma_f32_16x16x32_bf16 v[84:87], v[192:195], v[148:151], v[84:87]
    v_mul_f32 v80, v80, v200
    v_mul_f32 v81, v81, v201
    v_mul_f32 v82, v82, v202
    v_mul_f32 v83, v83, v203
    v_mfma_f32_16x16x32_bf16 v[116:119], v[196:199], v[148:151], v[116:119]
    v_mul_f32 v112, v112, v204
    v_mul_f32 v113, v113, v205
    v_mul_f32 v114, v114, v206
    v_mul_f32 v115, v115, v207
    s_waitcnt lgkmcnt(10)
    v_mfma_f32_16x16x32_bf16 v[88:91], v[192:195], v[152:155], v[88:91]
    v_mul_f32 v84, v84, v200
    v_mul_f32 v85, v85, v201
    v_mul_f32 v86, v86, v202
    v_mul_f32 v87, v87, v203
    v_mfma_f32_16x16x32_bf16 v[120:123], v[196:199], v[152:155], v[120:123]
    v_mul_f32 v116, v116, v204
    v_mul_f32 v117, v117, v205
    v_mul_f32 v118, v118, v206
    v_mul_f32 v119, v119, v207
    s_waitcnt lgkmcnt(8)
    v_mfma_f32_16x16x32_bf16 v[92:95], v[192:195], v[156:159], v[92:95]
    v_mul_f32 v88, v88, v200
    v_mul_f32 v89, v89, v201
    v_mul_f32 v90, v90, v202
    v_mul_f32 v91, v91, v203
    v_mfma_f32_16x16x32_bf16 v[124:127], v[196:199], v[156:159], v[124:127]
    v_mul_f32 v120, v120, v204
    v_mul_f32 v121, v121, v205
    v_mul_f32 v122, v122, v206
    v_mul_f32 v123, v123, v207
    s_waitcnt lgkmcnt(0)
    v_mfma_f32_16x16x32_bf16 v[96:99], v[192:195], v[160:163], v[96:99]
    v_mul_f32 v92, v92, v200
    v_mul_f32 v93, v93, v201
    v_mul_f32 v94, v94, v202
    v_mul_f32 v95, v95, v203
    s_waitcnt vmcnt(2)
    v_mov_b32 v12, 135168
    v_mov_b32 v13, 256
    s_mov_b64 exec, 1
    ds_add_u32 v12, v13 offset:24
    s_mov_b64 exec, -1
    s_bitcmp1_b32 s92, 10
    s_cbranch_scc1 L_rdy21
    v_mov_b32 v12, 135168
L_spin22:
    ds_read_b32 v13, v12 offset:24
    s_waitcnt lgkmcnt(0)
    v_readfirstlane_b32 s38, v13
    s_nop 1
    s_bitcmp1_b32 s38, 10
    s_cbranch_scc1 L_spun23
    s_sleep 1
    s_branch L_spin22
L_spun23:
    s_mov_b32 s92, s38
L_rdy21:
    ds_read_b128 v[184:187], v6 offset:1536
    ds_read_b128 v[188:191], v8 offset:1536
    ds_read_b64_tr_b16 v[176:177], v2 offset:16384
    ds_read_b64_tr_b16 v[178:179], v2 offset:20480
    ds_read_b64_tr_b16 v[180:181], v3 offset:16384
    ds_read_b64_tr_b16 v[182:183], v3 offset:20480
    ds_read_b64_tr_b16 v[144:145], v4 offset:16384
    ds_read_b64_tr_b16 v[146:147], v4 offset:20480
    ds_read_b64_tr_b16 v[148:149], v5 offset:16384
    ds_read_b64_tr_b16 v[150:151], v5 offset:20480
    ds_read_b64_tr_b16 v[152:153], v4 offset:17408
    ds_read_b64_tr_b16 v[154:155], v4 offset:21504
    ds_read_b64_tr_b16 v[156:157], v5 offset:17408
    ds_read_b64_tr_b16 v[158:159], v5 offset:21504
    v_mfma_f32_16x16x32_bf16 v[128:131], v[196:199], v[160:163], v[128:131]
    v_mul_f32 v124, v124, v204
    v_mul_f32 v125, v125, v205
    v_mul_f32 v126, v126, v206
    v_mul_f32 v127, v127, v207
    v_mfma_f32_16x16x32_bf16 v[100:103], v[192:195], v[164:167], v[100:103]
    v_mul_f32 v96, v96, v200
    v_mul_f32 v97, v97, v201
    v_mul_f32 v98, v98, v202
    v_mul_f32 v99, v99, v203
    ds_read_b64_tr_b16 v[160:161], v4 offset:18432
    ds_read_b64_tr_b16 v[162:163], v4 offset:22528
    v_mfma_f32_16x16x32_bf16 v[132:135], v[196:199], v[164:167], v[132:135]
    v_mul_f32 v128, v128, v204
    v_mul_f32 v129, v129, v205
    v_mul_f32 v130, v130, v206
    v_mul_f32 v131, v131, v207
    v_mfma_f32_16x16x32_bf16 v[104:107], v[192:195], v[168:171], v[104:107]
    v_mul_f32 v100, v100, v200
    v_mul_f32 v101, v101, v201
    v_mul_f32 v102, v102, v202
    v_mul_f32 v103, v103, v203
    ds_read_b64_tr_b16 v[164:165], v5 offset:18432
    ds_read_b64_tr_b16 v[166:167], v5 offset:22528
    v_mfma_f32_16x16x32_bf16 v[136:139], v[196:199], v[168:171], v[136:139]
    v_mul_f32 v132, v132, v204
    v_mul_f32 v133, v133, v205
    v_mul_f32 v134, v134, v206
    v_mul_f32 v135, v135, v207
    v_mfma_f32_16x16x32_bf16 v[108:111], v[192:195], v[172:175], v[108:111]
    v_mul_f32 v104, v104, v200
    v_mul_f32 v105, v105, v201
    v_mul_f32 v106, v106, v202
    v_mul_f32 v107, v107, v203
    ds_read_b64_tr_b16 v[168:169], v4 offset:19456
    ds_read_b64_tr_b16 v[170:171], v4 offset:23552
    v_mfma_f32_16x16x32_bf16 v[140:143], v[196:199], v[172:175], v[140:143]
    v_mul_f32 v136, v136, v204
    v_mul_f32 v137, v137, v205
    v_mul_f32 v138, v138, v206
    v_mul_f32 v139, v139, v207
    v_mul_f32 v108, v108, v200
    v_mul_f32 v109, v109, v201
    v_mul_f32 v110, v110, v202
    v_mul_f32 v111, v111, v203
    ds_read_b64_tr_b16 v[172:173], v5 offset:19456
    ds_read_b64_tr_b16 v[174:175], v5 offset:23552
    v_mul_f32 v140, v140, v204
    v_mul_f32 v141, v141, v205
    v_mul_f32 v142, v142, v206
    v_mul_f32 v143, v143, v207
    s_waitcnt lgkmcnt(14)
    v_mfma_f32_16x16x32_bf16 v[80:83], v[176:179], v[144:147], v[80:83]
    v_mul_f32 v248, v248, v184
    v_mul_f32 v249, v249, v185
    v_mul_f32 v250, v250, v186
    v_mul_f32 v251, v251, v187
    v_mfma_f32_16x16x32_bf16 v[112:115], v[180:183], v[144:147], v[112:115]
    v_mul_f32 v252, v252, v188
    v_mul_f32 v253, v253, v189
    v_mul_f32 v254, v254, v190
    v_mul_f32 v255, v255, v191
    s_waitcnt lgkmcnt(12)
    v_mfma_f32_16x16x32_bf16 v[84:87], v[176:179], v[148:151], v[84:87]
    v_mul_f32 v80, v80, v184
    v_mul_f32 v81, v81, v185
    v_mul_f32 v82, v82, v186
    v_mul_f32 v83, v83, v187
    v_mfma_f32_16x16x32_bf16 v[116:119], v[180:183], v[148:151], v[116:119]
    v_mul_f32 v112, v112, v188
    v_mul_f32 v113, v113, v189
    v_mul_f32 v114, v114, v190
    v_mul_f32 v115, v115, v191
    s_waitcnt lgkmcnt(10)
    v_mfma_f32_16x16x32_bf16 v[88:91], v[176:179], v[152:155], v[88:91]
    v_mul_f32 v84, v84, v184
    v_mul_f32 v85, v85, v185
    v_mul_f32 v86, v86, v186
    v_mul_f32 v87, v87, v187
    v_mfma_f32_16x16x32_bf16 v[120:123], v[180:183], v[152:155], v[120:123]
    v_mul_f32 v116, v116, v188
    v_mul_f32 v117, v117, v189
    v_mul_f32 v118, v118, v190
    v_mul_f32 v119, v119, v191
    s_waitcnt lgkmcnt(8)
    v_mfma_f32_16x16x32_bf16 v[92:95], v[176:179], v[156:159], v[92:95]
    v_mul_f32 v88, v88, v184
    v_mul_f32 v89, v89, v185
    v_mul_f32 v90, v90, v186
    v_mul_f32 v91, v91, v187
    v_mfma_f32_16x16x32_bf16 v[124:127], v[180:183], v[156:159], v[124:127]
    v_mul_f32 v120, v120, v188
    v_mul_f32 v121, v121, v189
    v_mul_f32 v122, v122, v190
    v_mul_f32 v123, v123, v191
    s_waitcnt lgkmcnt(0)
    v_mfma_f32_16x16x32_bf16 v[96:99], v[176:179], v[160:163], v[96:99]
    v_mul_f32 v92, v92, v184
    v_mul_f32 v93, v93, v185
    v_mul_f32 v94, v94, v186
    v_mul_f32 v95, v95, v187
    s_waitcnt vmcnt(0)
    v_mov_b32 v12, 135168
    v_mov_b32 v13, 4096
    s_mov_b64 exec, 1
    ds_add_u32 v12, v13 offset:24
    s_mov_b64 exec, -1
    s_bitcmp1_b32 s92, 14
    s_cbranch_scc1 L_rdy24
    v_mov_b32 v12, 135168
L_spin25:
    ds_read_b32 v13, v12 offset:24
    s_waitcnt lgkmcnt(0)
    v_readfirstlane_b32 s38, v13
    s_nop 1
    s_bitcmp1_b32 s38, 14
    s_cbranch_scc1 L_spun26
    s_sleep 1
    s_branch L_spin25
L_spun26:
    s_mov_b32 s92, s38
L_rdy24:
    ds_read_b128 v[200:203], v6 offset:2048
    ds_read_b128 v[204:207], v8 offset:2048
    ds_read_b64_tr_b16 v[192:193], v2 offset:24576
    ds_read_b64_tr_b16 v[194:195], v2 offset:28672
    ds_read_b64_tr_b16 v[196:197], v3 offset:24576
    ds_read_b64_tr_b16 v[198:199], v3 offset:28672
    ds_read_b64_tr_b16 v[144:145], v4 offset:24576
    ds_read_b64_tr_b16 v[146:147], v4 offset:28672
    ds_read_b64_tr_b16 v[148:149], v5 offset:24576
    ds_read_b64_tr_b16 v[150:151], v5 offset:28672
    ds_read_b64_tr_b16 v[152:153], v4 offset:25600
    ds_read_b64_tr_b16 v[154:155], v4 offset:29696
    ds_read_b64_tr_b16 v[156:157], v5 offset:25600
    ds_read_b64_tr_b16 v[158:159], v5 offset:29696
    v_mfma_f32_16x16x32_bf16 v[128:131], v[180:183], v[160:163], v[128:131]
    v_mul_f32 v124, v124, v188
    v_mul_f32 v125, v125, v189
    v_mul_f32 v126, v126, v190
    v_mul_f32 v127, v127, v191
    v_mfma_f32_16x16x32_bf16 v[100:103], v[176:179], v[164:167], v[100:103]
    v_mul_f32 v96, v96, v184
    v_mul_f32 v97, v97, v185
    v_mul_f32 v98, v98, v186
    v_mul_f32 v99, v99, v187
    ds_read_b64_tr_b16 v[160:161], v4 offset:26624
    ds_read_b64_tr_b16 v[162:163], v4 offset:30720
    v_mfma_f32_16x16x32_bf16 v[132:135], v[180:183], v[164:167], v[132:135]
    v_mul_f32 v128, v128, v188
    v_mul_f32 v129, v129, v189
    v_mul_f32 v130, v130, v190
    v_mul_f32 v131, v131, v191
    v_mfma_f32_16x16x32_bf16 v[104:107], v[176:179], v[168:171], v[104:107]
    v_mul_f32 v100, v100, v184
    v_mul_f32 v101, v101, v185
    v_mul_f32 v102, v102, v186
    v_mul_f32 v103, v103, v187
    ds_read_b64_tr_b16 v[164:165], v5 offset:26624
    ds_read_b64_tr_b16 v[166:167], v5 offset:30720
    v_mfma_f32_16x16x32_bf16 v[136:139], v[180:183], v[168:171], v[136:139]
    v_mul_f32 v132, v132, v188
    v_mul_f32 v133, v133, v189
    v_mul_f32 v134, v134, v190
    v_mul_f32 v135, v135, v191
    v_mfma_f32_16x16x32_bf16 v[108:111], v[176:179], v[172:175], v[108:111]
    v_mul_f32 v104, v104, v184
    v_mul_f32 v105, v105, v185
    v_mul_f32 v106, v106, v186
    v_mul_f32 v107, v107, v187
    ds_read_b64_tr_b16 v[168:169], v4 offset:27648
    ds_read_b64_tr_b16 v[170:171], v4 offset:31744
    v_mfma_f32_16x16x32_bf16 v[140:143], v[180:183], v[172:175], v[140:143]
    v_mul_f32 v136, v136, v188
    v_mul_f32 v137, v137, v189
    v_mul_f32 v138, v138, v190
    v_mul_f32 v139, v139, v191
    v_mul_f32 v108, v108, v184
    v_mul_f32 v109, v109, v185
    v_mul_f32 v110, v110, v186
    v_mul_f32 v111, v111, v187
    ds_read_b64_tr_b16 v[172:173], v5 offset:27648
    ds_read_b64_tr_b16 v[174:175], v5 offset:31744
    v_mul_f32 v140, v140, v188
    v_mul_f32 v141, v141, v189
    v_mul_f32 v142, v142, v190
    v_mul_f32 v143, v143, v191
    s_mov_b64 exec, s[60:61]
    ds_write_b128 v6, v[248:251] offset:28928
    ds_write_b128 v8, v[252:255] offset:28928
    s_mov_b64 exec, -1
    s_waitcnt lgkmcnt(15)
    v_mfma_f32_16x16x32_bf16 v[80:83], v[192:195], v[144:147], v[80:83]
    v_mul_f32 v248, v248, v200
    v_mul_f32 v249, v249, v201
    v_mul_f32 v250, v250, v202
    v_mul_f32 v251, v251, v203
    v_mfma_f32_16x16x32_bf16 v[112:115], v[196:199], v[144:147], v[112:115]
    v_mul_f32 v252, v252, v204
    v_mul_f32 v253, v253, v205
    v_mul_f32 v254, v254, v206
    v_mul_f32 v255, v255, v207
    s_waitcnt lgkmcnt(14)
    v_mfma_f32_16x16x32_bf16 v[84:87], v[192:195], v[148:151], v[84:87]
    v_mfma_f32_16x16x32_bf16 v[116:119], v[196:199], v[148:151], v[116:119]
    s_waitcnt lgkmcnt(12)
    v_mfma_f32_16x16x32_bf16 v[88:91], v[192:195], v[152:155], v[88:91]
    v_mfma_f32_16x16x32_bf16 v[120:123], v[196:199], v[152:155], v[120:123]
    s_waitcnt lgkmcnt(10)
    v_mfma_f32_16x16x32_bf16 v[92:95], v[192:195], v[156:159], v[92:95]
    v_mfma_f32_16x16x32_bf16 v[124:127], v[196:199], v[156:159], v[124:127]
    s_waitcnt lgkmcnt(0)
    v_mfma_f32_16x16x32_bf16 v[96:99], v[192:195], v[160:163], v[96:99]
    s_bitcmp1_b32 s92, 18
    s_cbranch_scc1 L_rdy27
    v_mov_b32 v12, 135168
L_spin28:
    ds_read_b32 v13, v12 offset:24
    s_waitcnt lgkmcnt(0)
    v_readfirstlane_b32 s38, v13
    s_nop 1
    s_bitcmp1_b32 s38, 18
    s_cbranch_scc1 L_spun29
    s_sleep 1
    s_branch L_spin28
L_spun29:
    s_mov_b32 s92, s38
L_rdy27:
    ds_read_b128 v[184:187], v6 offset:2560
    ds_read_b128 v[188:191], v8 offset:2560
    ds_read_b64_tr_b16 v[176:177], v2 offset:32768
    ds_read_b64_tr_b16 v[178:179], v2 offset:36864
    ds_read_b64_tr_b16 v[180:181], v3 offset:32768
    ds_read_b64_tr_b16 v[182:183], v3 offset:36864
    ds_read_b64_tr_b16 v[144:145], v4 offset:32768
    ds_read_b64_tr_b16 v[146:147], v4 offset:36864
    ds_read_b64_tr_b16 v[148:149], v5 offset:32768
    ds_read_b64_tr_b16 v[150:151], v5 offset:36864
    ds_read_b64_tr_b16 v[152:153], v4 offset:33792
    ds_read_b64_tr_b16 v[154:155], v4 offset:37888
    ds_read_b64_tr_b16 v[156:157], v5 offset:33792
    ds_read_b64_tr_b16 v[158:159], v5 offset:37888
    v_mfma_f32_16x16x32_bf16 v[128:131], v[196:199], v[160:163], v[128:131]
    v_mfma_f32_16x16x32_bf16 v[100:103], v[192:195], v[164:167], v[100:103]
    ds_read_b64_tr_b16 v[160:161], v4 offset:34816
    ds_read_b64_tr_b16 v[162:163], v4 offset:38912
    v_mfma_f32_16x16x32_bf16 v[132:135], v[196:199], v[164:167], v[132:135]
    v_mfma_f32_16x16x32_bf16 v[104:107], v[192:195], v[168:171], v[104:107]
    ds_read_b64_tr_b16 v[164:165], v5 offset:34816
    ds_read_b64_tr_b16 v[166:167], v5 offset:38912
    v_mfma_f32_16x16x32_bf16 v[136:139], v[196:199], v[168:171], v[136:139]
    v_mfma_f32_16x16x32_bf16 v[108:111], v[192:195], v[172:175], v[108:111]
    ds_read_b64_tr_b16 v[168:169], v4 offset:35840
    ds_read_b64_tr_b16 v[170:171], v4 offset:39936
    v_mfma_f32_16x16x32_bf16 v[140:143], v[196:199], v[172:175], v[140:143]
    s_nop 3
    ds_read_b64_tr_b16 v[172:173], v5 offset:35840
    ds_read_b64_tr_b16 v[174:175], v5 offset:39936
    s_mov_b64 exec, s[56:57]
    v_cvt_pk_bf16_f32 v208, v80, v81
    v_cvt_pk_bf16_f32 v209, v82, v83
    v_cvt_pk_bf16_f32 v210, v112, v113
    v_cvt_pk_bf16_f32 v211, v114, v115
    v_cvt_pk_bf16_f32 v212, v84, v85
    v_cvt_pk_bf16_f32 v213, v86, v87
    v_cvt_pk_bf16_f32 v214, v116, v117
    v_cvt_pk_bf16_f32 v215, v118, v119
    v_cvt_pk_bf16_f32 v216, v88, v89
    v_cvt_pk_bf16_f32 v217, v90, v91
    v_cvt_pk_bf16_f32 v218, v120, v121
    v_cvt_pk_bf16_f32 v219, v122, v123
    v_cvt_pk_bf16_f32 v220, v92, v93
    v_cvt_pk_bf16_f32 v221, v94, v95
    v_cvt_pk_bf16_f32 v222, v124, v125
    v_cvt_pk_bf16_f32 v223, v126, v127
    v_cvt_pk_bf16_f32 v224, v96, v97
    v_cvt_pk_bf16_f32 v225, v98, v99
    v_cvt_pk_bf16_f32 v226, v128, v129
    v_cvt_pk_bf16_f32 v227, v130, v131
    v_cvt_pk_bf16_f32 v228, v100, v101
    v_cvt_pk_bf16_f32 v229, v102, v103
    v_cvt_pk_bf16_f32 v230, v132, v133
    v_cvt_pk_bf16_f32 v231, v134, v135
    v_cvt_pk_bf16_f32 v240, v104, v105
    v_cvt_pk_bf16_f32 v241, v106, v107
    v_cvt_pk_bf16_f32 v242, v136, v137
    v_cvt_pk_bf16_f32 v243, v138, v139
    v_cvt_pk_bf16_f32 v244, v108, v109
    v_cvt_pk_bf16_f32 v245, v110, v111
    v_cvt_pk_bf16_f32 v246, v140, v141
    v_cvt_pk_bf16_f32 v247, v142, v143
    s_mov_b64 exec, s[58:59]
    v_cvt_pk_bf16_f32 v208, v112, v113
    v_cvt_pk_bf16_f32 v209, v114, v115
    v_cvt_pk_bf16_f32 v210, v80, v81
    v_cvt_pk_bf16_f32 v211, v82, v83
    v_cvt_pk_bf16_f32 v212, v116, v117
    v_cvt_pk_bf16_f32 v213, v118, v119
    v_cvt_pk_bf16_f32 v214, v84, v85
    v_cvt_pk_bf16_f32 v215, v86, v87
    v_cvt_pk_bf16_f32 v216, v120, v121
    v_cvt_pk_bf16_f32 v217, v122, v123
    v_cvt_pk_bf16_f32 v218, v88, v89
    v_cvt_pk_bf16_f32 v219, v90, v91
    v_cvt_pk_bf16_f32 v220, v124, v125
    v_cvt_pk_bf16_f32 v221, v126, v127
    v_cvt_pk_bf16_f32 v222, v92, v93
    v_cvt_pk_bf16_f32 v223, v94, v95
    v_cvt_pk_bf16_f32 v224, v128, v129
    v_cvt_pk_bf16_f32 v225, v130, v131
    v_cvt_pk_bf16_f32 v226, v96, v97
    v_cvt_pk_bf16_f32 v227, v98, v99
    v_cvt_pk_bf16_f32 v228, v132, v133
    v_cvt_pk_bf16_f32 v229, v134, v135
    v_cvt_pk_bf16_f32 v230, v100, v101
    v_cvt_pk_bf16_f32 v231, v102, v103
    v_cvt_pk_bf16_f32 v240, v136, v137
    v_cvt_pk_bf16_f32 v241, v138, v139
    v_cvt_pk_bf16_f32 v242, v104, v105
    v_cvt_pk_bf16_f32 v243, v106, v107
    v_cvt_pk_bf16_f32 v244, v140, v141
    v_cvt_pk_bf16_f32 v245, v142, v143
    v_cvt_pk_bf16_f32 v246, v108, v109
    v_cvt_pk_bf16_f32 v247, v110, v111
    s_mov_b64 exec, -1
    s_mul_i32 s38, s34, 6144
    s_add_u32 s38, s38, 135424
    v_lshlrev_b32 v11, 4, v7
    v_add_u32 v11, s38, v11
    ds_write_b128 v11, v[208:211] offset:0
    ds_write_b128 v11, v[212:215] offset:1024
    ds_write_b128 v11, v[216:219] offset:2048
    ds_write_b128 v11, v[220:223] offset:3072
    ds_write_b128 v11, v[224:227] offset:4096
    ds_write_b128 v11, v[228:231] offset:5120
    v_mul_f32 v80, v80, v200
    v_mul_f32 v81, v81, v201
    v_mul_f32 v82, v82, v202
    v_mul_f32 v83, v83, v203
    v_mul_f32 v112, v112, v204
    v_mul_f32 v113, v113, v205
    v_mul_f32 v114, v114, v206
    v_mul_f32 v115, v115, v207
    v_mul_f32 v84, v84, v200
    v_mul_f32 v85, v85, v201
    v_mul_f32 v86, v86, v202
    v_mul_f32 v87, v87, v203
    v_mul_f32 v116, v116, v204
    v_mul_f32 v117, v117, v205
    v_mul_f32 v118, v118, v206
    v_mul_f32 v119, v119, v207
    v_mul_f32 v88, v88, v200
    v_mul_f32 v89, v89, v201
    v_mul_f32 v90, v90, v202
    v_mul_f32 v91, v91, v203
    v_mul_f32 v120, v120, v204
    v_mul_f32 v121, v121, v205
    v_mul_f32 v122, v122, v206
    v_mul_f32 v123, v123, v207
    v_mul_f32 v92, v92, v200
    v_mul_f32 v93, v93, v201
    v_mul_f32 v94, v94, v202
    v_mul_f32 v95, v95, v203
    v_mul_f32 v124, v124, v204
    v_mul_f32 v125, v125, v205
    v_mul_f32 v126, v126, v206
    v_mul_f32 v127, v127, v207
    v_mul_f32 v96, v96, v200
    v_mul_f32 v97, v97, v201
    v_mul_f32 v98, v98, v202
    v_mul_f32 v99, v99, v203
    v_mul_f32 v128, v128, v204
    v_mul_f32 v129, v129, v205
    v_mul_f32 v130, v130, v206
    v_mul_f32 v131, v131, v207
    v_mul_f32 v100, v100, v200
    v_mul_f32 v101, v101, v201
    v_mul_f32 v102, v102, v202
    v_mul_f32 v103, v103, v203
    v_mul_f32 v132, v132, v204
    v_mul_f32 v133, v133, v205
    v_mul_f32 v134, v134, v206
    v_mul_f32 v135, v135, v207
    v_mul_f32 v104, v104, v200
    v_mul_f32 v105, v105, v201
    v_mul_f32 v106, v106, v202
    v_mul_f32 v107, v107, v203
    v_mul_f32 v136, v136, v204
    v_mul_f32 v137, v137, v205
    v_mul_f32 v138, v138, v206
    v_mul_f32 v139, v139, v207
    v_mul_f32 v108, v108, v200
    v_mul_f32 v109, v109, v201
    v_mul_f32 v110, v110, v202
    v_mul_f32 v111, v111, v203
    v_mul_f32 v140, v140, v204
    v_mul_f32 v141, v141, v205
    v_mul_f32 v142, v142, v206
    v_mul_f32 v143, v143, v207
    s_mov_b32 s95, 100
    s_cmp_eq_u32 s33, 7
    s_cbranch_scc1 L_nopub
    s_waitcnt lgkmcnt(15)
    v_mfma_f32_16x16x32_bf16 v[80:83], v[176:179], v[144:147], v[80:83]
    v_mul_f32 v248, v248, v184
    v_mul_f32 v249, v249, v185
    v_mul_f32 v250, v250, v186
    v_mul_f32 v251, v251, v187
    v_mfma_f32_16x16x32_bf16 v[112:115], v[180:183], v[144:147], v[112:115]
    v_mul_f32 v252, v252, v188
    v_mul_f32 v253, v253, v189
    v_mul_f32 v254, v254, v190
    v_mul_f32 v255, v255, v191
    s_waitcnt lgkmcnt(15)
    v_mfma_f32_16x16x32_bf16 v[84:87], v[176:179], v[148:151], v[84:87]
    v_mul_f32 v80, v80, v184
    v_mul_f32 v81, v81, v185
    v_mul_f32 v82, v82, v186
    v_mul_f32 v83, v83, v187
    v_mfma_f32_16x16x32_bf16 v[116:119], v[180:183], v[148:151], v[116:119]
    v_mul_f32 v112, v112, v188
    v_mul_f32 v113, v113, v189
    v_mul_f32 v114, v114, v190
    v_mul_f32 v115, v115, v191
    s_waitcnt lgkmcnt(15)
    v_mfma_f32_16x16x32_bf16 v[88:91], v[176:179], v[152:155], v[88:91]
    v_mul_f32 v84, v84, v184
    v_mul_f32 v85, v85, v185
    v_mul_f32 v86, v86, v186
    v_mul_f32 v87, v87, v187
    v_mfma_f32_16x16x32_bf16 v[120:123], v[180:183], v[152:155], v[120:123]
    v_mul_f32 v116, v116, v188
    v_mul_f32 v117, v117, v189
    v_mul_f32 v118, v118, v190
    v_mul_f32 v119, v119, v191
    s_waitcnt lgkmcnt(14)
    v_mfma_f32_16x16x32_bf16 v[92:95], v[176:179], v[156:159], v[92:95]
    v_mul_f32 v88, v88, v184
    v_mul_f32 v89, v89, v185
    v_mul_f32 v90, v90, v186
    v_mul_f32 v91, v91, v187
    v_mfma_f32_16x16x32_bf16 v[124:127], v[180:183], v[156:159], v[124:127]
    v_mul_f32 v120, v120, v188
    v_mul_f32 v121, v121, v189
    v_mul_f32 v122, v122, v190
    v_mul_f32 v123, v123, v191
    s_waitcnt lgkmcnt(0)
    v_mfma_f32_16x16x32_bf16 v[96:99], v[176:179], v[160:163], v[96:99]
    v_mul_f32 v92, v92, v184
    v_mul_f32 v93, v93, v185
    v_mul_f32 v94, v94, v186
    v_mul_f32 v95, v95, v187
    s_bitcmp1_b32 s92, 22
    s_cbranch_scc1 L_rdy30
    v_mov_b32 v12, 135168
L_spin31:
    ds_read_b32 v13, v12 offset:24
    s_waitcnt lgkmcnt(0)
    v_readfirstlane_b32 s38, v13
    s_nop 1
    s_bitcmp1_b32 s38, 22
    s_cbranch_scc1 L_spun32
    s_sleep 1
    s_branch L_spin31
L_spun32:
    s_mov_b32 s92, s38
L_rdy30:
    ds_read_b128 v[200:203], v6 offset:3072
    ds_read_b128 v[204:207], v8 offset:3072
    ds_read_b64_tr_b16 v[192:193], v2 offset:40960
    ds_read_b64_tr_b16 v[194:195], v2 offset:45056
    ds_read_b64_tr_b16 v[196:197], v3 offset:40960
    ds_read_b64_tr_b16 v[198:199], v3 offset:45056
    ds_read_b64_tr_b16 v[144:145], v4 offset:40960
    ds_read_b64_tr_b16 v[146:147], v4 offset:45056
    ds_read_b64_tr_b16 v[148:149], v5 offset:40960
    ds_read_b64_tr_b16 v[150:151], v5 offset:45056
    ds_read_b64_tr_b16 v[152:153], v4 offset:41984
    ds_read_b64_tr_b16 v[154:155], v4 offset:46080
    ds_read_b64_tr_b16 v[156:157], v5 offset:41984
    ds_read_b64_tr_b16 v[158:159], v5 offset:46080
    v_mfma_f32_16x16x32_bf16 v[128:131], v[180:183], v[160:163], v[128:131]
    v_mul_f32 v124, v124, v188
    v_mul_f32 v125, v125, v189
    v_mul_f32 v126, v126, v190
    v_mul_f32 v127, v127, v191
    v_mfma_f32_16x16x32_bf16 v[100:103], v[176:179], v[164:167], v[100:103]
    v_mul_f32 v96, v96, v184
    v_mul_f32 v97, v97, v185
    v_mul_f32 v98, v98, v186
    v_mul_f32 v99, v99, v187
    ds_read_b64_tr_b16 v[160:161], v4 offset:43008
    ds_read_b64_tr_b16 v[162:163], v4 offset:47104
    v_mfma_f32_16x16x32_bf16 v[132:135], v[180:183], v[164:167], v[132:135]
    v_mul_f32 v128, v128, v188
    v_mul_f32 v129, v129, v189
    v_mul_f32 v130, v130, v190
    v_mul_f32 v131, v131, v191
    v_mfma_f32_16x16x32_bf16 v[104:107], v[176:179], v[168:171], v[104:107]
    v_mul_f32 v100, v100, v184
    v_mul_f32 v101, v101, v185
    v_mul_f32 v102, v102, v186
    v_mul_f32 v103, v103, v187
    ds_read_b64_tr_b16 v[164:165], v5 offset:43008
    ds_read_b64_tr_b16 v[166:167], v5 offset:47104
    v_mfma_f32_16x16x32_bf16 v[136:139], v[180:183], v[168:171], v[136:139]
    v_mul_f32 v132, v132, v188
    v_mul_f32 v133, v133, v189
    v_mul_f32 v134, v134, v190
    v_mul_f32 v135, v135, v191
    v_mfma_f32_16x16x32_bf16 v[108:111], v[176:179], v[172:175], v[108:111]
    v_mul_f32 v104, v104, v184
    v_mul_f32 v105, v105, v185
    v_mul_f32 v106, v106, v186
    v_mul_f32 v107, v107, v187
    ds_read_b64_tr_b16 v[168:169], v4 offset:44032
    ds_read_b64_tr_b16 v[170:171], v4 offset:48128
    v_mfma_f32_16x16x32_bf16 v[140:143], v[180:183], v[172:175], v[140:143]
    v_mul_f32 v136, v136, v188
    v_mul_f32 v137, v137, v189
    v_mul_f32 v138, v138, v190
    v_mul_f32 v139, v139, v191
    v_mul_f32 v108, v108, v184
    v_mul_f32 v109, v109, v185
    v_mul_f32 v110, v110, v186
    v_mul_f32 v111, v111, v187
    ds_read_b64_tr_b16 v[172:173], v5 offset:44032
    ds_read_b64_tr_b16 v[174:175], v5 offset:48128
    v_mul_f32 v140, v140, v188
    v_mul_f32 v141, v141, v189
    v_mul_f32 v142, v142, v190
    v_mul_f32 v143, v143, v191
    s_waitcnt lgkmcnt(14)
    v_mfma_f32_16x16x32_bf16 v[80:83], v[192:195], v[144:147], v[80:83]
    v_mul_f32 v248, v248, v200
    v_mul_f32 v249, v249, v201
    v_mul_f32 v250, v250, v202
    v_mul_f32 v251, v251, v203
    v_mfma_f32_16x16x32_bf16 v[112:115], v[196:199], v[144:147], v[112:115]
    v_mul_f32 v252, v252, v204
    v_mul_f32 v253, v253, v205
    v_mul_f32 v254, v254, v206
    v_mul_f32 v255, v255, v207
    s_waitcnt lgkmcnt(12)
    v_mfma_f32_16x16x32_bf16 v[84:87], v[192:195], v[148:151], v[84:87]
    v_mul_f32 v80, v80, v200
    v_mul_f32 v81, v81, v201
    v_mul_f32 v82, v82, v202
    v_mul_f32 v83, v83, v203
    v_mfma_f32_16x16x32_bf16 v[116:119], v[196:199], v[148:151], v[116:119]
    v_mul_f32 v112, v112, v204
    v_mul_f32 v113, v113, v205
    v_mul_f32 v114, v114, v206
    v_mul_f32 v115, v115, v207
    s_waitcnt lgkmcnt(10)
    v_mfma_f32_16x16x32_bf16 v[88:91], v[192:195], v[152:155], v[88:91]
    v_mul_f32 v84, v84, v200
    v_mul_f32 v85, v85, v201
    v_mul_f32 v86, v86, v202
    v_mul_f32 v87, v87, v203
    v_mfma_f32_16x16x32_bf16 v[120:123], v[196:199], v[152:155], v[120:123]
    v_mul_f32 v116, v116, v204
    v_mul_f32 v117, v117, v205
    v_mul_f32 v118, v118, v206
    v_mul_f32 v119, v119, v207
    s_waitcnt lgkmcnt(8)
    v_mfma_f32_16x16x32_bf16 v[92:95], v[192:195], v[156:159], v[92:95]
    v_mul_f32 v88, v88, v200
    v_mul_f32 v89, v89, v201
    v_mul_f32 v90, v90, v202
    v_mul_f32 v91, v91, v203
    v_mfma_f32_16x16x32_bf16 v[124:127], v[196:199], v[156:159], v[124:127]
    v_mul_f32 v120, v120, v204
    v_mul_f32 v121, v121, v205
    v_mul_f32 v122, v122, v206
    v_mul_f32 v123, v123, v207
    s_waitcnt lgkmcnt(0)
    v_mfma_f32_16x16x32_bf16 v[96:99], v[192:195], v[160:163], v[96:99]
    v_mul_f32 v92, v92, v200
    v_mul_f32 v93, v93, v201
    v_mul_f32 v94, v94, v202
    v_mul_f32 v95, v95, v203
    s_bitcmp1_b32 s92, 26
    s_cbranch_scc1 L_rdy33
    v_mov_b32 v12, 135168
L_spin34:
    ds_read_b32 v13, v12 offset:24
    s_waitcnt lgkmcnt(0)
    v_readfirstlane_b32 s38, v13
    s_nop 1
    s_bitcmp1_b32 s38, 26
    s_cbranch_scc1 L_spun35
    s_sleep 1
    s_branch L_spin34
L_spun35:
    s_mov_b32 s92, s38
L_rdy33:
    ds_read_b128 v[184:187], v6 offset:3584
    ds_read_b128 v[188:191], v8 offset:3584
    ds_read_b64_tr_b16 v[176:177], v2 offset:49152
    ds_read_b64_tr_b16 v[178:179], v2 offset:53248
    ds_read_b64_tr_b16 v[180:181], v3 offset:49152
    ds_read_b64_tr_b16 v[182:183], v3 offset:53248
    ds_read_b64_tr_b16 v[144:145], v4 offset:49152
    ds_read_b64_tr_b16 v[146:147], v4 offset:53248
    ds_read_b64_tr_b16 v[148:149], v5 offset:49152
    ds_read_b64_tr_b16 v[150:151], v5 offset:53248
    ds_read_b64_tr_b16 v[152:153], v4 offset:50176
    ds_read_b64_tr_b16 v[154:155], v4 offset:54272
    ds_read_b64_tr_b16 v[156:157], v5 offset:50176
    ds_read_b64_tr_b16 v[158:159], v5 offset:54272
    v_mfma_f32_16x16x32_bf16 v[128:131], v[196:199], v[160:163], v[128:131]
    v_mul_f32 v124, v124, v204
    v_mul_f32 v125, v125, v205
    v_mul_f32 v126, v126, v206
    v_mul_f32 v127, v127, v207
    v_mfma_f32_16x16x32_bf16 v[100:103], v[192:195], v[164:167], v[100:103]
    v_mul_f32 v96, v96, v200
    v_mul_f32 v97, v97, v201
    v_mul_f32 v98, v98, v202
    v_mul_f32 v99, v99, v203
    ds_read_b64_tr_b16 v[160:161], v4 offset:51200
    ds_read_b64_tr_b16 v[162:163], v4 offset:55296
    v_mfma_f32_16x16x32_bf16 v[132:135], v[196:199], v[164:167], v[132:135]
    v_mul_f32 v128, v128, v204
    v_mul_f32 v129, v129, v205
    v_mul_f32 v130, v130, v206
    v_mul_f32 v131, v131, v207
    v_mfma_f32_16x16x32_bf16 v[104:107], v[192:195], v[168:171], v[104:107]
    v_mul_f32 v100, v100, v200
    v_mul_f32 v101, v101, v201
    v_mul_f32 v102, v102, v202
    v_mul_f32 v103, v103, v203
    ds_read_b64_tr_b16 v[164:165], v5 offset:51200
    ds_read_b64_tr_b16 v[166:167], v5 offset:55296
    v_mfma_f32_16x16x32_bf16 v[136:139], v[196:199], v[168:171], v[136:139]
    v_mul_f32 v132, v132, v204
    v_mul_f32 v133, v133, v205
    v_mul_f32 v134, v134, v206
    v_mul_f32 v135, v135, v207
    v_mfma_f32_16x16x32_bf16 v[108:111], v[192:195], v[172:175], v[108:111]
    v_mul_f32 v104, v104, v200
    v_mul_f32 v105, v105, v201
    v_mul_f32 v106, v106, v202
    v_mul_f32 v107, v107, v203
    ds_read_b64_tr_b16 v[168:169], v4 offset:52224
    ds_read_b64_tr_b16 v[170:171], v4 offset:56320
    v_mfma_f32_16x16x32_bf16 v[140:143], v[196:199], v[172:175], v[140:143]
    v_mul_f32 v136, v136, v204
    v_mul_f32 v137, v137, v205
    v_mul_f32 v138, v138, v206
    v_mul_f32 v139, v139, v207
    v_mul_f32 v108, v108, v200
    v_mul_f32 v109, v109, v201
    v_mul_f32 v110, v110, v202
    v_mul_f32 v111, v111, v203
    ds_read_b64_tr_b16 v[172:173], v5 offset:52224
    ds_read_b64_tr_b16 v[174:175], v5 offset:56320
    v_mul_f32 v140, v140, v204
    v_mul_f32 v141, v141, v205
    v_mul_f32 v142, v142, v206
    v_mul_f32 v143, v143, v207
    s_waitcnt lgkmcnt(14)
    v_mfma_f32_16x16x32_bf16 v[80:83], v[176:179], v[144:147], v[80:83]
    v_mul_f32 v248, v248, v184
    v_mul_f32 v249, v249, v185
    v_mul_f32 v250, v250, v186
    v_mul_f32 v251, v251, v187
    v_mfma_f32_16x16x32_bf16 v[112:115], v[180:183], v[144:147], v[112:115]
    v_mul_f32 v252, v252, v188
    v_mul_f32 v253, v253, v189
    v_mul_f32 v254, v254, v190
    v_mul_f32 v255, v255, v191
    s_waitcnt lgkmcnt(12)
    v_mfma_f32_16x16x32_bf16 v[84:87], v[176:179], v[148:151], v[84:87]
    v_mul_f32 v80, v80, v184
    v_mul_f32 v81, v81, v185
    v_mul_f32 v82, v82, v186
    v_mul_f32 v83, v83, v187
    v_mfma_f32_16x16x32_bf16 v[116:119], v[180:183], v[148:151], v[116:119]
    v_mul_f32 v112, v112, v188
    v_mul_f32 v113, v113, v189
    v_mul_f32 v114, v114, v190
    v_mul_f32 v115, v115, v191
    s_waitcnt lgkmcnt(10)
    v_mfma_f32_16x16x32_bf16 v[88:91], v[176:179], v[152:155], v[88:91]
    v_mul_f32 v84, v84, v184
    v_mul_f32 v85, v85, v185
    v_mul_f32 v86, v86, v186
    v_mul_f32 v87, v87, v187
    v_mfma_f32_16x16x32_bf16 v[120:123], v[180:183], v[152:155], v[120:123]
    v_mul_f32 v116, v116, v188
    v_mul_f32 v117, v117, v189
    v_mul_f32 v118, v118, v190
    v_mul_f32 v119, v119, v191
    s_waitcnt lgkmcnt(8)
    v_mfma_f32_16x16x32_bf16 v[92:95], v[176:179], v[156:159], v[92:95]
    v_mul_f32 v88, v88, v184
    v_mul_f32 v89, v89, v185
    v_mul_f32 v90, v90, v186
    v_mul_f32 v91, v91, v187
    v_mfma_f32_16x16x32_bf16 v[124:127], v[180:183], v[156:159], v[124:127]
    v_mul_f32 v120, v120, v188
    v_mul_f32 v121, v121, v189
    v_mul_f32 v122, v122, v190
    v_mul_f32 v123, v123, v191
    s_waitcnt lgkmcnt(0)
    v_mfma_f32_16x16x32_bf16 v[96:99], v[176:179], v[160:163], v[96:99]
    v_mul_f32 v92, v92, v184
    v_mul_f32 v93, v93, v185
    v_mul_f32 v94, v94, v186
    v_mul_f32 v95, v95, v187
    s_bitcmp1_b32 s92, 30
    s_cbranch_scc1 L_rdy36
    v_mov_b32 v12, 135168
L_spin37:
    ds_read_b32 v13, v12 offset:24
    s_waitcnt lgkmcnt(0)
    v_readfirstlane_b32 s38, v13
    s_nop 1
    s_bitcmp1_b32 s38, 30
    s_cbranch_scc1 L_spun38
    s_sleep 1
    s_branch L_spin37
L_spun38:
    s_mov_b32 s92, s38
L_rdy36:
    ds_read_b64_tr_b16 v[192:193], v2 offset:57344
    ds_read_b64_tr_b16 v[194:195], v2 offset:61440
    ds_read_b64_tr_b16 v[196:197], v3 offset:57344
    ds_read_b64_tr_b16 v[198:199], v3 offset:61440
    ds_read_b64_tr_b16 v[144:145], v4 offset:57344
    ds_read_b64_tr_b16 v[146:147], v4 offset:61440
    ds_read_b64_tr_b16 v[148:149], v5 offset:57344
    ds_read_b64_tr_b16 v[150:151], v5 offset:61440
    ds_read_b64_tr_b16 v[152:153], v4 offset:58368
    ds_read_b64_tr_b16 v[154:155], v4 offset:62464
    ds_read_b64_tr_b16 v[156:157], v5 offset:58368
    ds_read_b64_tr_b16 v[158:159], v5 offset:62464
    v_mfma_f32_16x16x32_bf16 v[128:131], v[180:183], v[160:163], v[128:131]
    v_mul_f32 v124, v124, v188
    v_mul_f32 v125, v125, v189
    v_mul_f32 v126, v126, v190
    v_mul_f32 v127, v127, v191
    v_mfma_f32_16x16x32_bf16 v[100:103], v[176:179], v[164:167], v[100:103]
    v_mul_f32 v96, v96, v184
    v_mul_f32 v97, v97, v185
    v_mul_f32 v98, v98, v186
    v_mul_f32 v99, v99, v187
    ds_read_b64_tr_b16 v[160:161], v4 offset:59392
    ds_read_b64_tr_b16 v[162:163], v4 offset:63488
    v_mfma_f32_16x16x32_bf16 v[132:135], v[180:183], v[164:167], v[132:135]
    v_mul_f32 v128, v128, v188
    v_mul_f32 v129, v129, v189
    v_mul_f32 v130, v130, v190
    v_mul_f32 v131, v131, v191
    v_mfma_f32_16x16x32_bf16 v[104:107], v[176:179], v[168:171], v[104:107]
    v_mul_f32 v100, v100, v184
    v_mul_f32 v101, v101, v185
    v_mul_f32 v102, v102, v186
    v_mul_f32 v103, v103, v187
    ds_read_b64_tr_b16 v[164:165], v5 offset:59392
    ds_read_b64_tr_b16 v[166:167], v5 offset:63488
    v_mfma_f32_16x16x32_bf16 v[136:139], v[180:183], v[168:171], v[136:139]
    v_mul_f32 v132, v132, v188
    v_mul_f32 v133, v133, v189
    v_mul_f32 v134, v134, v190
    v_mul_f32 v135, v135, v191
    v_mfma_f32_16x16x32_bf16 v[108:111], v[176:179], v[172:175], v[108:111]
    v_mul_f32 v104, v104, v184
    v_mul_f32 v105, v105, v185
    v_mul_f32 v106, v106, v186
    v_mul_f32 v107, v107, v187
    ds_read_b64_tr_b16 v[168:169], v4 offset:60416
    ds_read_b64_tr_b16 v[170:171], v4 offset:64512
    v_mfma_f32_16x16x32_bf16 v[140:143], v[180:183], v[172:175], v[140:143]
    v_mul_f32 v136, v136, v188
    v_mul_f32 v137, v137, v189
    v_mul_f32 v138, v138, v190
    v_mul_f32 v139, v139, v191
    v_mul_f32 v108, v108, v184
    v_mul_f32 v109, v109, v185
    v_mul_f32 v110, v110, v186
    v_mul_f32 v111, v111, v187
    ds_read_b64_tr_b16 v[172:173], v5 offset:60416
    ds_read_b64_tr_b16 v[174:175], v5 offset:64512
    v_mul_f32 v140, v140, v188
    v_mul_f32 v141, v141, v189
    v_mul_f32 v142, v142, v190
    v_mul_f32 v143, v143, v191
    s_waitcnt lgkmcnt(14)
    v_mfma_f32_16x16x32_bf16 v[80:83], v[192:195], v[144:147], v[80:83]
    v_mfma_f32_16x16x32_bf16 v[112:115], v[196:199], v[144:147], v[112:115]
    s_waitcnt lgkmcnt(12)
    v_mfma_f32_16x16x32_bf16 v[84:87], v[192:195], v[148:151], v[84:87]
    v_mfma_f32_16x16x32_bf16 v[116:119], v[196:199], v[148:151], v[116:119]
    s_waitcnt lgkmcnt(10)
    v_mfma_f32_16x16x32_bf16 v[88:91], v[192:195], v[152:155], v[88:91]
    v_mfma_f32_16x16x32_bf16 v[120:123], v[196:199], v[152:155], v[120:123]
    s_waitcnt lgkmcnt(8)
    v_mfma_f32_16x16x32_bf16 v[92:95], v[192:195], v[156:159], v[92:95]
    v_mfma_f32_16x16x32_bf16 v[124:127], v[196:199], v[156:159], v[124:127]
    s_waitcnt lgkmcnt(0)
    v_mfma_f32_16x16x32_bf16 v[96:99], v[192:195], v[160:163], v[96:99]
    v_mfma_f32_16x16x32_bf16 v[128:131], v[196:199], v[160:163], v[128:131]
    v_mfma_f32_16x16x32_bf16 v[100:103], v[192:195], v[164:167], v[100:103]
    v_mfma_f32_16x16x32_bf16 v[132:135], v[196:199], v[164:167], v[132:135]
    v_mfma_f32_16x16x32_bf16 v[104:107], v[192:195], v[168:171], v[104:107]
    v_mfma_f32_16x16x32_bf16 v[136:139], v[196:199], v[168:171], v[136:139]
    v_mfma_f32_16x16x32_bf16 v[108:111], v[192:195], v[172:175], v[108:111]
    v_mfma_f32_16x16x32_bf16 v[140:143], v[196:199], v[172:175], v[140:143]
    v_mov_b32 v12, 135168
    v_mov_b32 v13, 1
    s_mov_b64 exec, 1
    ds_add_u32 v12, v13 offset:16
    s_mov_b64 exec, -1
    s_mov_b64 exec, s[56:57]
    v_cvt_pk_bf16_f32 v144, v80, v81
    v_cvt_pk_bf16_f32 v145, v82, v83
    v_cvt_pk_bf16_f32 v146, v112, v113
    v_cvt_pk_bf16_f32 v147, v114, v115
    v_cvt_pk_bf16_f32 v148, v84, v85
    v_cvt_pk_bf16_f32 v149, v86, v87
    v_cvt_pk_bf16_f32 v150, v116, v117
    v_cvt_pk_bf16_f32 v151, v118, v119
    v_cvt_pk_bf16_f32 v152, v88, v89
    v_cvt_pk_bf16_f32 v153, v90, v91
    v_cvt_pk_bf16_f32 v154, v120, v121
    v_cvt_pk_bf16_f32 v155, v122, v123
    v_cvt_pk_bf16_f32 v156, v92, v93
    v_cvt_pk_bf16_f32 v157, v94, v95
    v_cvt_pk_bf16_f32 v158, v124, v125
    v_cvt_pk_bf16_f32 v159, v126, v127
    v_cvt_pk_bf16_f32 v160, v96, v97
    v_cvt_pk_bf16_f32 v161, v98, v99
    v_cvt_pk_bf16_f32 v162, v128, v129
    v_cvt_pk_bf16_f32 v163, v130, v131
    v_cvt_pk_bf16_f32 v164, v100, v101
    v_cvt_pk_bf16_f32 v165, v102, v103
    v_cvt_pk_bf16_f32 v166, v132, v133
    v_cvt_pk_bf16_f32 v167, v134, v135
    v_cvt_pk_bf16_f32 v168, v104, v105
    v_cvt_pk_bf16_f32 v169, v106, v107
    v_cvt_pk_bf16_f32 v170, v136, v137
    v_cvt_pk_bf16_f32 v171, v138, v139
    v_cvt_pk_bf16_f32 v172, v108, v109
    v_cvt_pk_bf16_f32 v173, v110, v111
    v_cvt_pk_bf16_f32 v174, v140, v141
    v_cvt_pk_bf16_f32 v175, v142, v143
    s_mov_b64 exec, s[58:59]
    v_cvt_pk_bf16_f32 v144, v112, v113
    v_cvt_pk_bf16_f32 v145, v114, v115
    v_cvt_pk_bf16_f32 v146, v80, v81
    v_cvt_pk_bf16_f32 v147, v82, v83
    v_cvt_pk_bf16_f32 v148, v116, v117
    v_cvt_pk_bf16_f32 v149, v118, v119
    v_cvt_pk_bf16_f32 v150, v84, v85
    v_cvt_pk_bf16_f32 v151, v86, v87
    v_cvt_pk_bf16_f32 v152, v120, v121
    v_cvt_pk_bf16_f32 v153, v122, v123
    v_cvt_pk_bf16_f32 v154, v88, v89
    v_cvt_pk_bf16_f32 v155, v90, v91
    v_cvt_pk_bf16_f32 v156, v124, v125
    v_cvt_pk_bf16_f32 v157, v126, v127
    v_cvt_pk_bf16_f32 v158, v92, v93
    v_cvt_pk_bf16_f32 v159, v94, v95
    v_cvt_pk_bf16_f32 v160, v128, v129
    v_cvt_pk_bf16_f32 v161, v130, v131
    v_cvt_pk_bf16_f32 v162, v96, v97
    v_cvt_pk_bf16_f32 v163, v98, v99
    v_cvt_pk_bf16_f32 v164, v132, v133
    v_cvt_pk_bf16_f32 v165, v134, v135
    v_cvt_pk_bf16_f32 v166, v100, v101
    v_cvt_pk_bf16_f32 v167, v102, v103
    v_cvt_pk_bf16_f32 v168, v136, v137
    v_cvt_pk_bf16_f32 v169, v138, v139
    v_cvt_pk_bf16_f32 v170, v104, v105
    v_cvt_pk_bf16_f32 v171, v106, v107
    v_cvt_pk_bf16_f32 v172, v140, v141
    v_cvt_pk_bf16_f32 v173, v142, v143
    v_cvt_pk_bf16_f32 v174, v108, v109
    v_cvt_pk_bf16_f32 v175, v110, v111
    s_mov_b64 exec, -1
    v_mov_b32 v12, 135168
L_spin39:
    ds_read_b32 v13, v12 offset:16
    s_waitcnt lgkmcnt(0)
    v_readfirstlane_b32 s38, v13
    s_nop 1
    s_cmp_ge_u32 s38, 4
    s_cbranch_scc1 L_spun40
    s_sleep 1
    s_branch L_spin39
L_spun40:
    s_lshl_b32 s38, s34, 11
    s_add_u32 s38, s38, 57344
    v_lshlrev_b32 v11, 4, v7
    v_add_u32 v11, s38, v11
    ds_write_b128 v11, v[240:243] offset:0
    ds_write_b128 v11, v[244:247] offset:1024
    v_mov_b32 v12, 135168
    v_mov_b32 v13, 1
    s_mov_b64 exec, 1
    ds_add_u32 v12, v13 offset:20
    s_mov_b64 exec, -1
    v_mov_b32 v12, 135168
    v_mov_b32 v13, 2
    s_mov_b64 exec, 1
    ds_add_u32 v12, v13 offset:8
    s_mov_b64 exec, -1
    s_lshl_b32 s38, s32, 3
    s_add_u32 s38, s38, s33
    s_mul_i32 s76, s38, 33792
    s_lshl_b32 s38, s34, 13
    s_add_u32 s38, s38, s76
    s_add_u32 s77, s38, 4096
    v_lshlrev_b32 v11, 4, v7
    buffer_store_dwordx4 v[144:147], v11, s[28:31], s38 offen offset:0 sc0 sc1
    buffer_store_dwordx4 v[148:151], v11, s[28:31], s38 offen offset:1024 sc0 sc1
    buffer_store_dwordx4 v[152:155], v11, s[28:31], s38 offen offset:2048 sc0 sc1
    buffer_store_dwordx4 v[156:159], v11, s[28:31], s38 offen offset:3072 sc0 sc1
    buffer_store_dwordx4 v[160:163], v11, s[28:31], s77 offen offset:0 sc0 sc1
    buffer_store_dwordx4 v[164:167], v11, s[28:31], s77 offen offset:1024 sc0 sc1
    buffer_store_dwordx4 v[168:171], v11, s[28:31], s77 offen offset:2048 sc0 sc1
    buffer_store_dwordx4 v[172:175], v11, s[28:31], s77 offen offset:3072 sc0 sc1
    v_subrev_u32 v6, 131072, v6
    v_subrev_u32 v8, 131072, v8
    s_add_u32 s38, s76, 32768
    s_mov_b64 exec, s[60:61]
    buffer_store_dwordx4 v[248:251], v6, s[28:31], s38 offen sc0 sc1
    buffer_store_dwordx4 v[252:255], v8, s[28:31], s38 offen sc0 sc1
    s_mov_b64 exec, -1
    s_cmp_lt_u32 s34, 4
    s_cbranch_scc0 L_qearly
    buffer_load_dwordx4 v[208:211], v1, s[4:7], s36 offen offset:0 nt
    buffer_load_dwordx4 v[212:215], v1, s[4:7], s36 offen offset:256 nt
    buffer_load_dwordx4 v[216:219], v1, s[4:7], s36 offen offset:64 nt
    buffer_load_dwordx4 v[220:223], v1, s[4:7], s36 offen offset:320 nt
    buffer_load_dwordx4 v[224:227], v1, s[4:7], s36 offen offset:128 nt
    buffer_load_dwordx4 v[228:231], v1, s[4:7], s36 offen offset:384 nt
    buffer_load_dwordx4 v[232:235], v1, s[4:7], s36 offen offset:192 nt
    buffer_load_dwordx4 v[236:239], v1, s[4:7], s36 offen offset:448 nt
L_qearly:
    v_mov_b32 v12, 135168
L_spin41:
    ds_read_b32 v13, v12 offset:0
    s_waitcnt lgkmcnt(0)
    v_readfirstlane_b32 s38, v13
    s_nop 1
    s_cmp_ge_u32 s38, 1
    s_cbranch_scc1 L_spun42
    s_sleep 1
    s_branch L_spin41
L_spun42:
    s_mov_b32 s37, s38
    s_lshl_b32 s38, s34, 7
    s_add_u32 s38, s38, s39
    s_lshl_b32 s77, s33, 2
    s_add_u32 s94, s38, s77
    s_cmp_lt_u32 s34, 4
    s_cselect_b32 s95, 100, 0
    s_branch L_pubdone
    s_nop 11
L_nopub:
    v_mov_b32 v12, 135168
L_spin43:
    ds_read_b32 v13, v12 offset:24
    s_waitcnt lgkmcnt(0)
    v_readfirstlane_b32 s38, v13
    s_nop 1
    s_bitcmp1_b32 s38, 30
    s_cbranch_scc1 L_spun44
    s_sleep 1
    s_branch L_spin43
L_spun44:
    v_mov_b32 v12, 135168
    v_mov_b32 v13, 1
    s_mov_b64 exec, 1
    ds_add_u32 v12, v13 offset:16
    s_mov_b64 exec, -1
    v_mov_b32 v12, 135168
L_spin45:
    ds_read_b32 v13, v12 offset:16
    s_waitcnt lgkmcnt(0)
    v_readfirstlane_b32 s38, v13
    s_nop 1
    s_cmp_ge_u32 s38, 4
    s_cbranch_scc1 L_spun46
    s_sleep 1
    s_branch L_spin45
L_spun46:
    s_lshl_b32 s38, s34, 11
    s_add_u32 s38, s38, 57344
    v_lshlrev_b32 v11, 4, v7
    v_add_u32 v11, s38, v11
    ds_write_b128 v11, v[240:243] offset:0
    ds_write_b128 v11, v[244:247] offset:1024
    v_mov_b32 v12, 135168
    v_mov_b32 v13, 1
    s_mov_b64 exec, 1
    ds_add_u32 v12, v13 offset:20
    s_mov_b64 exec, -1
    v_mov_b32 v12, 135168
    v_mov_b32 v13, 2
    s_mov_b64 exec, 1
    ds_add_u32 v12, v13 offset:8
    s_mov_b64 exec, -1
    v_mov_b32 v12, 135168
L_spin47:
    ds_read_b32 v13, v12 offset:32
    s_waitcnt lgkmcnt(0)
    v_readfirstlane_b32 s38, v13
    s_nop 1
    s_cmp_ge_u32 s38, 7
    s_cbranch_scc1 L_spun48
    s_sleep 1
    s_branch L_spin47
L_spun48:
    buffer_load_dwordx4 v[208:211], v1, s[4:7], s36 offen offset:0 nt
    buffer_load_dwordx4 v[212:215], v1, s[4:7], s36 offen offset:256 nt
    buffer_load_dwordx4 v[216:219], v1, s[4:7], s36 offen offset:64 nt
    buffer_load_dwordx4 v[220:223], v1, s[4:7], s36 offen offset:320 nt
    buffer_load_dwordx4 v[224:227], v1, s[4:7], s36 offen offset:128 nt
    buffer_load_dwordx4 v[228:231], v1, s[4:7], s36 offen offset:384 nt
    buffer_load_dwordx4 v[232:235], v1, s[4:7], s36 offen offset:192 nt
    buffer_load_dwordx4 v[236:239], v1, s[4:7], s36 offen offset:448 nt
L_pubdone:
    s_setprio 0
    v_and_b32 v9, 15, v7
    v_lshrrev_b32 v10, 4, v7
    v_lshlrev_b32 v11, 4, v10
    v_lshl_add_u32 v1, v9, 9, v11
    v_lshrrev_b32 v12, 1, v10
    v_lshlrev_b32 v12, 3, v12
    v_xor_b32 v12, v12, v9
    v_lshl_add_u32 v2, v12, 9, v11
    v_lshlrev_b32 v13, 8, v10
    v_lshl_add_u32 v3, v12, 4, v13
    v_lshrrev_b32 v11, 2, v7
    v_and_b32 v12, 3, v7
    v_lshrrev_b32 v13, 1, v12
    v_lshlrev_b32 v13, 3, v13
    v_xor_b32 v11, v11, v13
    v_lshlrev_b32 v11, 4, v11
    v_lshl_add_u32 v11, v12, 8, v11
    v_and_b32 v12, 1, v12
    v_lshl_add_u32 v4, v12, 3, v11
    v_xor_b32 v5, 8, v4
    s_lshl_b32 s38, s35, 13
    v_add_u32 v9, s38, v3
    s_cmp_eq_u32 s33, 7
    s_cbranch_scc0 L_qw
    s_waitcnt vmcnt(0)
    s_branch L_qw2
L_qw:
    s_cmp_lt_u32 s34, 4
    s_cbranch_scc0 L_qw2
    v_mov_b32 v3, 0
    v_mov_b32 v6, s37
    s_waitcnt vmcnt(8)
    s_mov_b64 exec, 1
    buffer_store_dword v6, v3, s[28:31], s94 offen sc0 sc1
    s_mov_b64 exec, -1
    s_waitcnt vmcnt(1)
L_qw2:
    s_waitcnt vmcnt(10)
    v_lshlrev_b32 v112, 16, v208
    v_and_b32 v113, s70, v208
    v_lshlrev_b32 v114, 16, v209
    v_and_b32 v115, s70, v209
    v_lshlrev_b32 v116, 16, v210
    v_and_b32 v117, s70, v210
    v_lshlrev_b32 v118, 16, v211
    v_and_b32 v119, s70, v211
    v_pk_mul_f32 v[16:17], v[16:17], v[112:113]
    v_pk_mul_f32 v[18:19], v[18:19], v[114:115]
    v_pk_mul_f32 v[20:21], v[20:21], v[116:117]
    v_pk_mul_f32 v[22:23], v[22:23], v[118:119]
    v_lshlrev_b32 v112, 16, v212
    v_and_b32 v113, s70, v212
    v_lshlrev_b32 v114, 16, v213
    v_and_b32 v115, s70, v213
    v_lshlrev_b32 v116, 16, v214
    v_and_b32 v117, s70, v214
    v_lshlrev_b32 v118, 16, v215
    v_and_b32 v119, s70, v215
    v_pk_mul_f32 v[48:49], v[48:49], v[112:113]
    v_pk_mul_f32 v[50:51], v[50:51], v[114:115]
    v_pk_mul_f32 v[52:53], v[52:53], v[116:117]
    v_pk_mul_f32 v[54:55], v[54:55], v[118:119]
    v_lshlrev_b32 v112, 16, v216
    v_and_b32 v113, s70, v216
    v_lshlrev_b32 v114, 16, v217
    v_and_b32 v115, s70, v217
    v_lshlrev_b32 v116, 16, v218
    v_and_b32 v117, s70, v218
    v_lshlrev_b32 v118, 16, v219
    v_and_b32 v119, s70, v219
    v_pk_mul_f32 v[24:25], v[24:25], v[112:113]
    v_pk_mul_f32 v[26:27], v[26:27], v[114:115]
    v_pk_mul_f32 v[28:29], v[28:29], v[116:117]
    v_pk_mul_f32 v[30:31], v[30:31], v[118:119]
    v_lshlrev_b32 v112, 16, v220
    v_and_b32 v113, s70, v220
    v_lshlrev_b32 v114, 16, v221
    v_and_b32 v115, s70, v221
    v_lshlrev_b32 v116, 16, v222
    v_and_b32 v117, s70, v222
    v_lshlrev_b32 v118, 16, v223
    v_and_b32 v119, s70, v223
    v_pk_mul_f32 v[56:57], v[56:57], v[112:113]
    v_pk_mul_f32 v[58:59], v[58:59], v[114:115]
    v_pk_mul_f32 v[60:61], v[60:61], v[116:117]
    v_pk_mul_f32 v[62:63], v[62:63], v[118:119]
    v_lshlrev_b32 v112, 16, v224
    v_and_b32 v113, s70, v224
    v_lshlrev_b32 v114, 16, v225
    v_and_b32 v115, s70, v225
    v_lshlrev_b32 v116, 16, v226
    v_and_b32 v117, s70, v226
    v_lshlrev_b32 v118, 16, v227
    v_and_b32 v119, s70, v227
    v_pk_mul_f32 v[32:33], v[32:33], v[112:113]
    v_pk_mul_f32 v[34:35], v[34:35], v[114:115]
    v_pk_mul_f32 v[36:37], v[36:37], v[116:117]
    v_pk_mul_f32 v[38:39], v[38:39], v[118:119]
    v_lshlrev_b32 v112, 16, v228
    v_and_b32 v113, s70, v228
    v_lshlrev_b32 v114, 16, v229
    v_and_b32 v115, s70, v229
    v_lshlrev_b32 v116, 16, v230
    v_and_b32 v117, s70, v230
    v_lshlrev_b32 v118, 16, v231
    v_and_b32 v119, s70, v231
    v_pk_mul_f32 v[64:65], v[64:65], v[112:113]
    v_pk_mul_f32 v[66:67], v[66:67], v[114:115]
    v_pk_mul_f32 v[68:69], v[68:69], v[116:117]
    v_pk_mul_f32 v[70:71], v[70:71], v[118:119]
    v_lshlrev_b32 v112, 16, v232
    v_and_b32 v113, s70, v232
    v_lshlrev_b32 v114, 16, v233
    v_and_b32 v115, s70, v233
    v_lshlrev_b32 v116, 16, v234
    v_and_b32 v117, s70, v234
    v_lshlrev_b32 v118, 16, v235
    v_and_b32 v119, s70, v235
    v_pk_mul_f32 v[40:41], v[40:41], v[112:113]
    v_pk_mul_f32 v[42:43], v[42:43], v[114:115]
    v_pk_mul_f32 v[44:45], v[44:45], v[116:117]
    v_pk_mul_f32 v[46:47], v[46:47], v[118:119]
    v_lshlrev_b32 v112, 16, v236
    v_and_b32 v113, s70, v236
    v_lshlrev_b32 v114, 16, v237
    v_and_b32 v115, s70, v237
    v_lshlrev_b32 v116, 16, v238
    v_and_b32 v117, s70, v238
    v_lshlrev_b32 v118, 16, v239
    v_and_b32 v119, s70, v239
    v_pk_mul_f32 v[72:73], v[72:73], v[112:113]
    v_pk_mul_f32 v[74:75], v[74:75], v[114:115]
    v_pk_mul_f32 v[76:77], v[76:77], v[116:117]
    v_pk_mul_f32 v[78:79], v[78:79], v[118:119]
    s_cmp_eq_u32 s95, 0
    s_cbranch_scc0 L_nofl49
    v_mov_b32 v3, 0
    v_mov_b32 v6, s37
    s_waitcnt vmcnt(0)
    s_mov_b64 exec, 1
    buffer_store_dword v6, v3, s[28:31], s94 offen sc0 sc1
    s_mov_b64 exec, -1
L_nofl49:
    s_sub_u32 s95, s95, 1
    s_nop 11
L_phase2:
    v_lshrrev_b32 v10, 4, v7
    s_lshl_b32 s38, s35, 13
    s_add_u32 s38, s38, 65536
    v_add_u32 v4, s38, v4
    v_add_u32 v5, s38, v5
    s_lshl_b32 s38, s35, 9
    s_add_u32 s38, s38, 131072
    v_lshlrev_b32 v2, 5, v10
    v_add_u32 v2, s38, v2
    v_mov_b32 v0, v9
    s_and_b32 s78, s35, 3
    s_cmp_lg_u64 s[72:73], 0
    s_cbranch_scc1 L_slow
    s_waitcnt lgkmcnt(0)
    s_cmp_lt_u32 s34, 4
    s_cbranch_scc0 L_havek
    ds_read_b128 v[176:179], v0 offset:0
    ds_read_b128 v[180:183], v0 offset:4096
    ds_read_b128 v[184:187], v0 offset:1024
    ds_read_b128 v[188:191], v0 offset:5120
    ds_read_b128 v[192:195], v0 offset:2048
    ds_read_b128 v[196:199], v0 offset:6144
    ds_read_b128 v[200:203], v0 offset:3072
    ds_read_b128 v[204:207], v0 offset:7168
L_havek:
    ds_read_b64_tr_b16 v[208:209], v4 offset:0
    ds_read_b64_tr_b16 v[210:211], v4 offset:4096
    ds_read_b64_tr_b16 v[212:213], v5 offset:0
    ds_read_b64_tr_b16 v[214:215], v5 offset:4096
    ds_read_b64_tr_b16 v[216:217], v4 offset:1024
    ds_read_b64_tr_b16 v[218:219], v4 offset:5120
    ds_read_b64_tr_b16 v[220:221], v5 offset:1024
    ds_read_b64_tr_b16 v[222:223], v5 offset:5120
    ds_read_b64_tr_b16 v[224:225], v4 offset:2048
    ds_read_b64_tr_b16 v[226:227], v4 offset:6144
    ds_read_b64_tr_b16 v[228:229], v5 offset:2048
    ds_read_b64_tr_b16 v[230:231], v5 offset:6144
    ds_read_b64_tr_b16 v[232:233], v4 offset:3072
    ds_read_b64_tr_b16 v[234:235], v4 offset:7168
    ds_read_b64_tr_b16 v[236:237], v5 offset:3072
    ds_read_b64_tr_b16 v[238:239], v5 offset:7168
    v_cvt_pk_bf16_f32 v144, v16, v17
    v_cvt_pk_bf16_f32 v145, v18, v19
    v_cvt_pk_bf16_f32 v146, v20, v21
    v_cvt_pk_bf16_f32 v147, v22, v23
    v_cvt_pk_bf16_f32 v160, v48, v49
    v_cvt_pk_bf16_f32 v161, v50, v51
    v_cvt_pk_bf16_f32 v162, v52, v53
    v_cvt_pk_bf16_f32 v163, v54, v55
    v_cvt_pk_bf16_f32 v148, v24, v25
    v_cvt_pk_bf16_f32 v149, v26, v27
    v_cvt_pk_bf16_f32 v150, v28, v29
    v_cvt_pk_bf16_f32 v151, v30, v31
    v_cvt_pk_bf16_f32 v164, v56, v57
    v_cvt_pk_bf16_f32 v165, v58, v59
    v_cvt_pk_bf16_f32 v166, v60, v61
    v_cvt_pk_bf16_f32 v167, v62, v63
    v_cvt_pk_bf16_f32 v152, v32, v33
    v_cvt_pk_bf16_f32 v153, v34, v35
    v_cvt_pk_bf16_f32 v154, v36, v37
    v_cvt_pk_bf16_f32 v155, v38, v39
    v_cvt_pk_bf16_f32 v168, v64, v65
    v_cvt_pk_bf16_f32 v169, v66, v67
    v_cvt_pk_bf16_f32 v170, v68, v69
    v_cvt_pk_bf16_f32 v171, v70, v71
    v_cvt_pk_bf16_f32 v156, v40, v41
    v_cvt_pk_bf16_f32 v157, v42, v43
    v_cvt_pk_bf16_f32 v158, v44, v45
    v_cvt_pk_bf16_f32 v159, v46, v47
    v_cvt_pk_bf16_f32 v172, v72, v73
    v_cvt_pk_bf16_f32 v173, v74, v75
    v_cvt_pk_bf16_f32 v174, v76, v77
    v_cvt_pk_bf16_f32 v175, v78, v79
    s_waitcnt lgkmcnt(15)
    v_mfma_f32_16x16x32_bf16 v[240:243], v[176:179], v[144:147], 0
    v_mfma_f32_16x16x32_bf16 v[248:251], v[180:183], v[144:147], 0
    v_mfma_f32_16x16x32_bf16 v[244:247], v[176:179], v[160:163], 0
    v_mfma_f32_16x16x32_bf16 v[252:255], v[180:183], v[160:163], 0
    ds_read_b128 v[176:179], v2 offset:0
    ds_read_b128 v[180:183], v2 offset:16
    v_mfma_f32_16x16x32_bf16 v[240:243], v[184:187], v[148:151], v[240:243]
    v_mfma_f32_16x16x32_bf16 v[248:251], v[188:191], v[148:151], v[248:251]
    v_mfma_f32_16x16x32_bf16 v[244:247], v[184:187], v[164:167], v[244:247]
    v_mfma_f32_16x16x32_bf16 v[252:255], v[188:191], v[164:167], v[252:255]
    ds_read_b128 v[184:187], v2 offset:128
    ds_read_b128 v[188:191], v2 offset:144
    v_mfma_f32_16x16x32_bf16 v[240:243], v[192:195], v[152:155], v[240:243]
    v_subrev_u32 v0, 0x2000, v0
    v_subrev_u32 v4, 0x2000, v4
    v_subrev_u32 v5, 0x2000, v5
    v_mfma_f32_16x16x32_bf16 v[248:251], v[196:199], v[152:155], v[248:251]
    s_waitcnt lgkmcnt(2)
    v_mul_f32 v16, v16, v176
    v_mul_f32 v17, v17, v177
    v_mul_f32 v18, v18, v178
    v_mfma_f32_16x16x32_bf16 v[244:247], v[192:195], v[168:171], v[244:247]
    v_mul_f32 v19, v19, v179
    v_mul_f32 v20, v20, v180
    v_mul_f32 v21, v21, v181
    v_mfma_f32_16x16x32_bf16 v[252:255], v[196:199], v[168:171], v[252:255]
    v_mul_f32 v22, v22, v182
    v_mul_f32 v23, v23, v183
    v_mul_f32 v48, v48, v176
    ds_read_b128 v[192:195], v2 offset:256
    ds_read_b128 v[196:199], v2 offset:272
    v_mfma_f32_16x16x32_bf16 v[240:243], v[200:203], v[156:159], v[240:243]
    v_mul_f32 v49, v49, v177
    v_mul_f32 v50, v50, v178
    v_mul_f32 v51, v51, v179
    v_mfma_f32_16x16x32_bf16 v[248:251], v[204:207], v[156:159], v[248:251]
    v_mul_f32 v52, v52, v180
    v_mul_f32 v53, v53, v181
    v_mul_f32 v54, v54, v182
    v_mfma_f32_16x16x32_bf16 v[244:247], v[200:203], v[172:175], v[244:247]
    v_mfma_f32_16x16x32_bf16 v[252:255], v[204:207], v[172:175], v[252:255]
    ds_read_b128 v[200:203], v2 offset:384
    ds_read_b128 v[204:207], v2 offset:400
    v_mul_f32 v55, v55, v183
    ds_read_b128 v[176:179], v0 offset:0
    ds_read_b128 v[180:183], v0 offset:4096
    v_cvt_pk_bf16_f32 v144, v16, v17
    v_cvt_pk_bf16_f32 v145, v18, v19
    v_cvt_pk_bf16_f32 v146, v20, v21
    v_cvt_pk_bf16_f32 v147, v22, v23
    v_cvt_pk_bf16_f32 v160, v48, v49
    v_cvt_pk_bf16_f32 v161, v50, v51
    v_cvt_pk_bf16_f32 v162, v52, v53
    v_cvt_pk_bf16_f32 v163, v54, v55
    v_cndmask_b32 v240, 0, v240, s[40:41]
    v_cndmask_b32 v241, 0, v241, s[42:43]
    v_cndmask_b32 v242, 0, v242, s[44:45]
    v_cndmask_b32 v243, 0, v243, s[46:47]
    v_cndmask_b32 v248, 0, v248, s[48:49]
    v_cndmask_b32 v249, 0, v249, s[50:51]
    v_cndmask_b32 v250, 0, v250, s[52:53]
    v_cndmask_b32 v251, 0, v251, s[54:55]
    v_cvt_pk_bf16_f32 v8, v240, v241
    v_cvt_pk_bf16_f32 v9, v242, v243
    v_cvt_pk_bf16_f32 v10, v248, v249
    v_cvt_pk_bf16_f32 v11, v250, v251
    s_nop 1
    v_mfma_f32_16x16x32_bf16 v[80:83], v[208:211], v[8:11], 0
    v_cndmask_b32 v244, 0, v244, s[40:41]
    v_cndmask_b32 v245, 0, v245, s[42:43]
    v_cndmask_b32 v246, 0, v246, s[44:45]
    v_cndmask_b32 v247, 0, v247, s[46:47]
    v_mfma_f32_16x16x32_bf16 v[88:91], v[212:215], v[8:11], 0
    v_cndmask_b32 v252, 0, v252, s[40:41]
    v_cndmask_b32 v253, 0, v253, s[42:43]
    v_cndmask_b32 v254, 0, v254, s[44:45]
    v_cndmask_b32 v255, 0, v255, s[46:47]
    v_mfma_f32_16x16x32_bf16 v[96:99], v[216:219], v[8:11], 0
    v_cvt_pk_bf16_f32 v12, v244, v245
    v_cvt_pk_bf16_f32 v13, v246, v247
    v_cvt_pk_bf16_f32 v14, v252, v253
    v_cvt_pk_bf16_f32 v15, v254, v255
    v_mfma_f32_16x16x32_bf16 v[104:107], v[220:223], v[8:11], 0
    s_waitcnt lgkmcnt(6)
    v_mul_f32 v24, v24, v184
    v_mul_f32 v25, v25, v185
    v_mul_f32 v26, v26, v186
    v_mul_f32 v27, v27, v187
    v_mfma_f32_16x16x32_bf16 v[112:115], v[224:227], v[8:11], 0
    v_mul_f32 v28, v28, v188
    v_mul_f32 v29, v29, v189
    v_mul_f32 v30, v30, v190
    v_mul_f32 v31, v31, v191
    v_mfma_f32_16x16x32_bf16 v[120:123], v[228:231], v[8:11], 0
    v_mul_f32 v56, v56, v184
    v_mul_f32 v57, v57, v185
    v_mul_f32 v58, v58, v186
    v_mul_f32 v59, v59, v187
    v_mfma_f32_16x16x32_bf16 v[128:131], v[232:235], v[8:11], 0
    v_mul_f32 v60, v60, v188
    v_mul_f32 v61, v61, v189
    v_mul_f32 v62, v62, v190
    v_mul_f32 v63, v63, v191
    ds_read_b128 v[184:187], v0 offset:1024
    ds_read_b128 v[188:191], v0 offset:5120
    v_mfma_f32_16x16x32_bf16 v[136:139], v[236:239], v[8:11], 0
    v_cvt_pk_bf16_f32 v148, v24, v25
    v_cvt_pk_bf16_f32 v149, v26, v27
    v_cvt_pk_bf16_f32 v150, v28, v29
    v_cvt_pk_bf16_f32 v151, v30, v31
    v_mfma_f32_16x16x32_bf16 v[84:87], v[208:211], v[12:15], 0
    ds_read_b64_tr_b16 v[208:209], v4 offset:0
    ds_read_b64_tr_b16 v[210:211], v4 offset:4096
    v_cvt_pk_bf16_f32 v164, v56, v57
    v_cvt_pk_bf16_f32 v165, v58, v59
    v_cvt_pk_bf16_f32 v166, v60, v61
    v_cvt_pk_bf16_f32 v167, v62, v63
    v_mfma_f32_16x16x32_bf16 v[92:95], v[212:215], v[12:15], 0
    ds_read_b64_tr_b16 v[212:213], v5 offset:0
    ds_read_b64_tr_b16 v[214:215], v5 offset:4096
    s_waitcnt lgkmcnt(10)
    v_mul_f32 v32, v32, v192
    v_mul_f32 v33, v33, v193
    v_mul_f32 v34, v34, v194
    v_mul_f32 v35, v35, v195
    v_mfma_f32_16x16x32_bf16 v[100:103], v[216:219], v[12:15], 0
    ds_read_b64_tr_b16 v[216:217], v4 offset:1024
    ds_read_b64_tr_b16 v[218:219], v4 offset:5120
    v_mul_f32 v36, v36, v196
    v_mul_f32 v37, v37, v197
    v_mul_f32 v38, v38, v198
    v_mul_f32 v39, v39, v199
    v_mfma_f32_16x16x32_bf16 v[108:111], v[220:223], v[12:15], 0
    ds_read_b64_tr_b16 v[220:221], v5 offset:1024
    ds_read_b64_tr_b16 v[222:223], v5 offset:5120
    v_mul_f32 v64, v64, v192
    v_mul_f32 v65, v65, v193
    v_mul_f32 v66, v66, v194
    v_mul_f32 v67, v67, v195
    v_mfma_f32_16x16x32_bf16 v[116:119], v[224:227], v[12:15], 0
    ds_read_b64_tr_b16 v[224:225], v4 offset:2048
    ds_read_b64_tr_b16 v[226:227], v4 offset:6144
    v_mul_f32 v68, v68, v196
    v_mul_f32 v69, v69, v197
    v_mul_f32 v70, v70, v198
    v_mul_f32 v71, v71, v199
    ds_read_b128 v[192:195], v0 offset:2048
    ds_read_b128 v[196:199], v0 offset:6144
    v_mfma_f32_16x16x32_bf16 v[124:127], v[228:231], v[12:15], 0
    ds_read_b64_tr_b16 v[228:229], v5 offset:2048
    ds_read_b64_tr_b16 v[230:231], v5 offset:6144
    v_cvt_pk_bf16_f32 v152, v32, v33
    v_cvt_pk_bf16_f32 v153, v34, v35
    v_cvt_pk_bf16_f32 v154, v36, v37
    v_cvt_pk_bf16_f32 v155, v38, v39
    v_mfma_f32_16x16x32_bf16 v[132:135], v[232:235], v[12:15], 0
    ds_read_b64_tr_b16 v[232:233], v4 offset:3072
    ds_read_b64_tr_b16 v[234:235], v4 offset:7168
    v_cvt_pk_bf16_f32 v168, v64, v65
    v_cvt_pk_bf16_f32 v169, v66, v67
    v_cvt_pk_bf16_f32 v170, v68, v69
    v_cvt_pk_bf16_f32 v171, v70, v71
    v_mfma_f32_16x16x32_bf16 v[140:143], v[236:239], v[12:15], 0
    ds_read_b64_tr_b16 v[236:237], v5 offset:3072
    ds_read_b64_tr_b16 v[238:239], v5 offset:7168
    v_subrev_u32 v2, 0x200, v2
    s_nop 11
L_first_done:
    s_cmp_eq_u32 s78, 0
    s_cbranch_scc1 L_loop_done
    s_waitcnt lgkmcnt(4)
    s_nop 11
L_loop:
    s_waitcnt lgkmcnt(15)
    v_mfma_f32_16x16x32_bf16 v[240:243], v[176:179], v[144:147], 0
    v_mul_f32 v40, v40, v200
    v_mul_f32 v41, v41, v201
    v_mul_f32 v42, v42, v202
    v_mfma_f32_16x16x32_bf16 v[248:251], v[180:183], v[144:147], 0
    v_mul_f32 v43, v43, v203
    v_mul_f32 v44, v44, v204
    v_mul_f32 v45, v45, v205
    v_mfma_f32_16x16x32_bf16 v[244:247], v[176:179], v[160:163], 0
    v_mul_f32 v46, v46, v206
    v_mul_f32 v47, v47, v207
    v_mul_f32 v72, v72, v200
    v_mfma_f32_16x16x32_bf16 v[252:255], v[180:183], v[160:163], 0
    v_mul_f32 v73, v73, v201
    v_mul_f32 v74, v74, v202
    v_mul_f32 v75, v75, v203
    ds_read_b128 v[176:179], v2 offset:0
    ds_read_b128 v[180:183], v2 offset:16
    v_mfma_f32_16x16x32_bf16 v[240:243], v[184:187], v[148:151], v[240:243]
    v_mul_f32 v76, v76, v204
    v_mul_f32 v77, v77, v205
    v_mul_f32 v78, v78, v206
    v_mfma_f32_16x16x32_bf16 v[248:251], v[188:191], v[148:151], v[248:251]
    v_mul_f32 v79, v79, v207
    ds_read_b128 v[200:203], v0 offset:3072
    ds_read_b128 v[204:207], v0 offset:7168
    v_cvt_pk_bf16_f32 v156, v40, v41
    v_cvt_pk_bf16_f32 v157, v42, v43
    v_mfma_f32_16x16x32_bf16 v[244:247], v[184:187], v[164:167], v[244:247]
    v_cvt_pk_bf16_f32 v158, v44, v45
    v_cvt_pk_bf16_f32 v159, v46, v47
    v_cvt_pk_bf16_f32 v172, v72, v73
    v_mfma_f32_16x16x32_bf16 v[252:255], v[188:191], v[164:167], v[252:255]
    v_cvt_pk_bf16_f32 v173, v74, v75
    v_cvt_pk_bf16_f32 v174, v76, v77
    v_cvt_pk_bf16_f32 v175, v78, v79
    ds_read_b128 v[184:187], v2 offset:128
    ds_read_b128 v[188:191], v2 offset:144
    s_waitcnt lgkmcnt(10)
    v_mfma_f32_16x16x32_bf16 v[240:243], v[192:195], v[152:155], v[240:243]
    v_subrev_u32 v0, 0x2000, v0
    v_subrev_u32 v4, 0x2000, v4
    v_subrev_u32 v5, 0x2000, v5
    v_mfma_f32_16x16x32_bf16 v[248:251], v[196:199], v[152:155], v[248:251]
    s_waitcnt lgkmcnt(4)
    v_mul_f32 v16, v16, v176
    v_mul_f32 v17, v17, v177
    v_mul_f32 v18, v18, v178
    v_mfma_f32_16x16x32_bf16 v[244:247], v[192:195], v[168:171], v[244:247]
    v_mul_f32 v19, v19, v179
    v_mul_f32 v20, v20, v180
    v_mul_f32 v21, v21, v181
    v_mfma_f32_16x16x32_bf16 v[252:255], v[196:199], v[168:171], v[252:255]
    v_mul_f32 v22, v22, v182
    v_mul_f32 v23, v23, v183
    v_mul_f32 v48, v48, v176
    ds_read_b128 v[192:195], v2 offset:256
    ds_read_b128 v[196:199], v2 offset:272
    s_waitcnt lgkmcnt(4)
    v_mfma_f32_16x16x32_bf16 v[240:243], v[200:203], v[156:159], v[240:243]
    v_mul_f32 v49, v49, v177
    v_mul_f32 v50, v50, v178
    v_mul_f32 v51, v51, v179
    v_mfma_f32_16x16x32_bf16 v[248:251], v[204:207], v[156:159], v[248:251]
    v_mul_f32 v52, v52, v180
    v_mul_f32 v53, v53, v181
    v_mul_f32 v54, v54, v182
    v_mfma_f32_16x16x32_bf16 v[244:247], v[200:203], v[172:175], v[244:247]
    v_mfma_f32_16x16x32_bf16 v[252:255], v[204:207], v[172:175], v[252:255]
    ds_read_b128 v[200:203], v2 offset:384
    ds_read_b128 v[204:207], v2 offset:400
    v_mul_f32 v55, v55, v183
    ds_read_b128 v[176:179], v0 offset:0
    ds_read_b128 v[180:183], v0 offset:4096
    v_cvt_pk_bf16_f32 v144, v16, v17
    v_cvt_pk_bf16_f32 v145, v18, v19
    v_cvt_pk_bf16_f32 v146, v20, v21
    v_cvt_pk_bf16_f32 v147, v22, v23
    v_cvt_pk_bf16_f32 v160, v48, v49
    v_cvt_pk_bf16_f32 v161, v50, v51
    v_cvt_pk_bf16_f32 v162, v52, v53
    v_cvt_pk_bf16_f32 v163, v54, v55
    v_cvt_pk_bf16_f32 v8, v240, v241
    v_cvt_pk_bf16_f32 v9, v242, v243
    v_cvt_pk_bf16_f32 v10, v248, v249
    v_cvt_pk_bf16_f32 v11, v250, v251
    s_nop 1
    v_mfma_f32_16x16x32_bf16 v[80:83], v[208:211], v[8:11], v[80:83]
    v_cvt_pk_bf16_f32 v12, v244, v245
    v_cvt_pk_bf16_f32 v13, v246, v247
    v_cvt_pk_bf16_f32 v14, v252, v253
    v_cvt_pk_bf16_f32 v15, v254, v255
    v_mfma_f32_16x16x32_bf16 v[88:91], v[212:215], v[8:11], v[88:91]
    s_waitcnt lgkmcnt(6)
    v_mul_f32 v24, v24, v184
    v_mul_f32 v25, v25, v185
    v_mul_f32 v26, v26, v186
    v_mul_f32 v27, v27, v187
    v_mfma_f32_16x16x32_bf16 v[96:99], v[216:219], v[8:11], v[96:99]
    v_mul_f32 v28, v28, v188
    v_mul_f32 v29, v29, v189
    v_mul_f32 v30, v30, v190
    v_mul_f32 v31, v31, v191
    v_mfma_f32_16x16x32_bf16 v[104:107], v[220:223], v[8:11], v[104:107]
    v_mul_f32 v56, v56, v184
    v_mul_f32 v57, v57, v185
    v_mul_f32 v58, v58, v186
    v_mul_f32 v59, v59, v187
    v_mfma_f32_16x16x32_bf16 v[112:115], v[224:227], v[8:11], v[112:115]
    v_mul_f32 v60, v60, v188
    v_mul_f32 v61, v61, v189
    v_mul_f32 v62, v62, v190
    v_mfma_f32_16x16x32_bf16 v[120:123], v[228:231], v[8:11], v[120:123]
    v_mul_f32 v63, v63, v191
    ds_read_b128 v[184:187], v0 offset:1024
    ds_read_b128 v[188:191], v0 offset:5120
    v_cvt_pk_bf16_f32 v148, v24, v25
    v_cvt_pk_bf16_f32 v149, v26, v27
    v_mfma_f32_16x16x32_bf16 v[128:131], v[232:235], v[8:11], v[128:131]
    v_cvt_pk_bf16_f32 v150, v28, v29
    v_cvt_pk_bf16_f32 v151, v30, v31
    v_cvt_pk_bf16_f32 v164, v56, v57
    v_mfma_f32_16x16x32_bf16 v[136:139], v[236:239], v[8:11], v[136:139]
    v_cvt_pk_bf16_f32 v165, v58, v59
    v_cvt_pk_bf16_f32 v166, v60, v61
    v_cvt_pk_bf16_f32 v167, v62, v63
    v_mfma_f32_16x16x32_bf16 v[84:87], v[208:211], v[12:15], v[84:87]
    ds_read_b64_tr_b16 v[208:209], v4 offset:0
    ds_read_b64_tr_b16 v[210:211], v4 offset:4096
    s_waitcnt lgkmcnt(8)
    v_mul_f32 v32, v32, v192
    v_mul_f32 v33, v33, v193
    v_mul_f32 v34, v34, v194
    v_mfma_f32_16x16x32_bf16 v[92:95], v[212:215], v[12:15], v[92:95]
    ds_read_b64_tr_b16 v[212:213], v5 offset:0
    ds_read_b64_tr_b16 v[214:215], v5 offset:4096
    v_mul_f32 v35, v35, v195
    v_mul_f32 v36, v36, v196
    v_mul_f32 v37, v37, v197
    v_mfma_f32_16x16x32_bf16 v[100:103], v[216:219], v[12:15], v[100:103]
    ds_read_b64_tr_b16 v[216:217], v4 offset:1024
    ds_read_b64_tr_b16 v[218:219], v4 offset:5120
    v_mul_f32 v38, v38, v198
    v_mul_f32 v39, v39, v199
    v_mul_f32 v64, v64, v192
    v_mfma_f32_16x16x32_bf16 v[108:111], v[220:223], v[12:15], v[108:111]
    ds_read_b64_tr_b16 v[220:221], v5 offset:1024
    ds_read_b64_tr_b16 v[222:223], v5 offset:5120
    v_mul_f32 v65, v65, v193
    v_mul_f32 v66, v66, v194
    v_mul_f32 v67, v67, v195
    v_mfma_f32_16x16x32_bf16 v[116:119], v[224:227], v[12:15], v[116:119]
    ds_read_b64_tr_b16 v[224:225], v4 offset:2048
    ds_read_b64_tr_b16 v[226:227], v4 offset:6144
    v_mul_f32 v68, v68, v196
    v_mul_f32 v69, v69, v197
    v_mul_f32 v70, v70, v198
    v_mfma_f32_16x16x32_bf16 v[124:127], v[228:231], v[12:15], v[124:127]
    ds_read_b64_tr_b16 v[228:229], v5 offset:2048
    ds_read_b64_tr_b16 v[230:231], v5 offset:6144
    v_mul_f32 v71, v71, v199
    ds_read_b128 v[192:195], v0 offset:2048
    ds_read_b128 v[196:199], v0 offset:6144
    v_cvt_pk_bf16_f32 v152, v32, v33
    v_cvt_pk_bf16_f32 v153, v34, v35
    v_mfma_f32_16x16x32_bf16 v[132:135], v[232:235], v[12:15], v[132:135]
    ds_read_b64_tr_b16 v[232:233], v4 offset:3072
    ds_read_b64_tr_b16 v[234:235], v4 offset:7168
    v_cvt_pk_bf16_f32 v154, v36, v37
    v_cvt_pk_bf16_f32 v155, v38, v39
    v_cvt_pk_bf16_f32 v168, v64, v65
    v_mfma_f32_16x16x32_bf16 v[140:143], v[236:239], v[12:15], v[140:143]
    ds_read_b64_tr_b16 v[236:237], v5 offset:3072
    ds_read_b64_tr_b16 v[238:239], v5 offset:7168
    v_cvt_pk_bf16_f32 v169, v66, v67
    v_cvt_pk_bf16_f32 v170, v68, v69
    v_cvt_pk_bf16_f32 v171, v70, v71
    v_subrev_u32 v2, 0x200, v2
    s_sub_u32 s78, s78, 1
    s_cmp_gt_i32 s78, 0
    s_cbranch_scc1 L_loop
    s_nop 11
L_loop_done:
    s_waitcnt lgkmcnt(0)
    v_mul_f32 v40, v40, v200
    v_mul_f32 v41, v41, v201
    v_mul_f32 v42, v42, v202
    v_mul_f32 v43, v43, v203
    v_mul_f32 v44, v44, v204
    v_mul_f32 v45, v45, v205
    v_mul_f32 v46, v46, v206
    v_mul_f32 v47, v47, v207
    v_mul_f32 v72, v72, v200
    v_mul_f32 v73, v73, v201
    v_mul_f32 v74, v74, v202
    v_mul_f32 v75, v75, v203
    v_mul_f32 v76, v76, v204
    v_mul_f32 v77, v77, v205
    v_mul_f32 v78, v78, v206
    v_mul_f32 v79, v79, v207
    v_cvt_pk_bf16_f32 v156, v40, v41
    v_cvt_pk_bf16_f32 v157, v42, v43
    v_cvt_pk_bf16_f32 v158, v44, v45
    v_cvt_pk_bf16_f32 v159, v46, v47
    v_cvt_pk_bf16_f32 v172, v72, v73
    v_cvt_pk_bf16_f32 v173, v74, v75
    v_cvt_pk_bf16_f32 v174, v76, v77
    v_cvt_pk_bf16_f32 v175, v78, v79
    s_cmp_lt_u32 s34, 4
    s_cbranch_scc0 L_heavy2
    s_cmp_eq_u32 s33, 0
    s_cbranch_scc1 L_epi
    s_branch L_corr
    s_nop 11
L_heavy2:
    v_mov_b32 v12, 135168
    v_mov_b32 v13, 1
    s_mov_b64 exec, 1
    ds_add_u32 v12, v13 offset:8
    s_mov_b64 exec, -1
    v_mov_b32 v12, 135168
L_spin50:
    ds_read_b32 v13, v12 offset:20
    s_waitcnt lgkmcnt(0)
    v_readfirstlane_b32 s38, v13
    s_nop 1
    s_cmp_ge_u32 s38, 4
    s_cbranch_scc1 L_spun51
    s_sleep 1
    s_branch L_spin50
L_spun51:
    v_lshlrev_b32 v6, 4, v7
    v_add_u32 v8, 135424, v6
    v_add_u32 v9, 57344, v6
    ds_read_b128 v[176:179], v8 offset:0
    ds_read_b128 v[180:183], v8 offset:1024
    ds_read_b128 v[184:187], v8 offset:6144
    ds_read_b128 v[188:191], v8 offset:7168
    ds_read_b128 v[192:195], v8 offset:12288
    ds_read_b128 v[196:199], v8 offset:13312
    ds_read_b128 v[200:203], v8 offset:18432
    ds_read_b128 v[204:207], v8 offset:19456
    ds_read_b128 v[208:211], v8 offset:2048
    ds_read_b128 v[212:215], v8 offset:3072
    ds_read_b128 v[216:219], v8 offset:8192
    ds_read_b128 v[220:223], v8 offset:9216
    ds_read_b128 v[224:227], v8 offset:14336
    s_waitcnt lgkmcnt(12)
    v_mfma_f32_16x16x32_bf16 v[80:83], v[176:179], v[144:147], v[80:83]
    v_mfma_f32_16x16x32_bf16 v[84:87], v[176:179], v[160:163], v[84:87]
    ds_read_b128 v[228:231], v8 offset:15360
    s_waitcnt lgkmcnt(12)
    v_mfma_f32_16x16x32_bf16 v[88:91], v[180:183], v[144:147], v[88:91]
    v_mfma_f32_16x16x32_bf16 v[92:95], v[180:183], v[160:163], v[92:95]
    ds_read_b128 v[232:235], v8 offset:20480
    s_waitcnt lgkmcnt(12)
    v_mfma_f32_16x16x32_bf16 v[80:83], v[184:187], v[148:151], v[80:83]
    v_mfma_f32_16x16x32_bf16 v[84:87], v[184:187], v[164:167], v[84:87]
    ds_read_b128 v[236:239], v8 offset:21504
    s_waitcnt lgkmcnt(12)
    v_mfma_f32_16x16x32_bf16 v[88:91], v[188:191], v[148:151], v[88:91]
    v_mfma_f32_16x16x32_bf16 v[92:95], v[188:191], v[164:167], v[92:95]
    ds_read_b128 v[176:179], v8 offset:4096
    s_waitcnt lgkmcnt(12)
    v_mfma_f32_16x16x32_bf16 v[80:83], v[192:195], v[152:155], v[80:83]
    v_mfma_f32_16x16x32_bf16 v[84:87], v[192:195], v[168:171], v[84:87]
    ds_read_b128 v[180:183], v8 offset:5120
    s_waitcnt lgkmcnt(12)
    v_mfma_f32_16x16x32_bf16 v[88:91], v[196:199], v[152:155], v[88:91]
    v_mfma_f32_16x16x32_bf16 v[92:95], v[196:199], v[168:171], v[92:95]
    ds_read_b128 v[184:187], v8 offset:10240
    s_waitcnt lgkmcnt(12)
    v_mfma_f32_16x16x32_bf16 v[80:83], v[200:203], v[156:159], v[80:83]
    v_mfma_f32_16x16x32_bf16 v[84:87], v[200:203], v[172:175], v[84:87]
    ds_read_b128 v[188:191], v8 offset:11264
    s_waitcnt lgkmcnt(12)
    v_mfma_f32_16x16x32_bf16 v[88:91], v[204:207], v[156:159], v[88:91]
    v_mfma_f32_16x16x32_bf16 v[92:95], v[204:207], v[172:175], v[92:95]
    ds_read_b128 v[192:195], v8 offset:16384
    s_waitcnt lgkmcnt(12)
    v_mfma_f32_16x16x32_bf16 v[96:99], v[208:211], v[144:147], v[96:99]
    v_mfma_f32_16x16x32_bf16 v[100:103], v[208:211], v[160:163], v[100:103]
    ds_read_b128 v[196:199], v8 offset:17408
    s_waitcnt lgkmcnt(12)
    v_mfma_f32_16x16x32_bf16 v[104:107], v[212:215], v[144:147], v[104:107]
    v_mfma_f32_16x16x32_bf16 v[108:111], v[212:215], v[160:163], v[108:111]
    ds_read_b128 v[200:203], v8 offset:22528
    s_waitcnt lgkmcnt(12)
    v_mfma_f32_16x16x32_bf16 v[96:99], v[216:219], v[148:151], v[96:99]
    v_mfma_f32_16x16x32_bf16 v[100:103], v[216:219], v[164:167], v[100:103]
    ds_read_b128 v[204:207], v8 offset:23552
    s_waitcnt lgkmcnt(12)
    v_mfma_f32_16x16x32_bf16 v[104:107], v[220:223], v[148:151], v[104:107]
    v_mfma_f32_16x16x32_bf16 v[108:111], v[220:223], v[164:167], v[108:111]
    ds_read_b128 v[208:211], v9 offset:0
    s_waitcnt lgkmcnt(12)
    v_mfma_f32_16x16x32_bf16 v[96:99], v[224:227], v[152:155], v[96:99]
    v_mfma_f32_16x16x32_bf16 v[100:103], v[224:227], v[168:171], v[100:103]
    ds_read_b128 v[212:215], v9 offset:1024
    s_waitcnt lgkmcnt(12)
    v_mfma_f32_16x16x32_bf16 v[104:107], v[228:231], v[152:155], v[104:107]
    v_mfma_f32_16x16x32_bf16 v[108:111], v[228:231], v[168:171], v[108:111]
    ds_read_b128 v[216:219], v9 offset:2048
    s_waitcnt lgkmcnt(12)
    v_mfma_f32_16x16x32_bf16 v[96:99], v[232:235], v[156:159], v[96:99]
    v_mfma_f32_16x16x32_bf16 v[100:103], v[232:235], v[172:175], v[100:103]
    ds_read_b128 v[220:223], v9 offset:3072
    s_waitcnt lgkmcnt(12)
    v_mfma_f32_16x16x32_bf16 v[104:107], v[236:239], v[156:159], v[104:107]
    v_mfma_f32_16x16x32_bf16 v[108:111], v[236:239], v[172:175], v[108:111]
    ds_read_b128 v[224:227], v9 offset:4096
    s_waitcnt lgkmcnt(12)
    v_mfma_f32_16x16x32_bf16 v[112:115], v[176:179], v[144:147], v[112:115]
    v_mfma_f32_16x16x32_bf16 v[116:119], v[176:179], v[160:163], v[116:119]
    ds_read_b128 v[228:231], v9 offset:5120
    s_waitcnt lgkmcnt(12)
    v_mfma_f32_16x16x32_bf16 v[120:123], v[180:183], v[144:147], v[120:123]
    v_mfma_f32_16x16x32_bf16 v[124:127], v[180:183], v[160:163], v[124:127]
    ds_read_b128 v[232:235], v9 offset:6144
    s_waitcnt lgkmcnt(12)
    v_mfma_f32_16x16x32_bf16 v[112:115], v[184:187], v[148:151], v[112:115]
    v_mfma_f32_16x16x32_bf16 v[116:119], v[184:187], v[164:167], v[116:119]
    ds_read_b128 v[236:239], v9 offset:7168
    s_waitcnt lgkmcnt(12)
    v_mfma_f32_16x16x32_bf16 v[120:123], v[188:191], v[148:151], v[120:123]
    v_mfma_f32_16x16x32_bf16 v[124:127], v[188:191], v[164:167], v[124:127]
    s_waitcnt lgkmcnt(11)
    v_mfma_f32_16x16x32_bf16 v[112:115], v[192:195], v[152:155], v[112:115]
    v_mfma_f32_16x16x32_bf16 v[116:119], v[192:195], v[168:171], v[116:119]
    s_waitcnt lgkmcnt(10)
    v_mfma_f32_16x16x32_bf16 v[120:123], v[196:199], v[152:155], v[120:123]
    v_mfma_f32_16x16x32_bf16 v[124:127], v[196:199], v[168:171], v[124:127]
    s_waitcnt lgkmcnt(9)
    v_mfma_f32_16x16x32_bf16 v[112:115], v[200:203], v[156:159], v[112:115]
    v_mfma_f32_16x16x32_bf16 v[116:119], v[200:203], v[172:175], v[116:119]
    s_waitcnt lgkmcnt(8)
    v_mfma_f32_16x16x32_bf16 v[120:123], v[204:207], v[156:159], v[120:123]
    v_mfma_f32_16x16x32_bf16 v[124:127], v[204:207], v[172:175], v[124:127]
    s_waitcnt lgkmcnt(7)
    v_mfma_f32_16x16x32_bf16 v[128:131], v[208:211], v[144:147], v[128:131]
    v_mfma_f32_16x16x32_bf16 v[132:135], v[208:211], v[160:163], v[132:135]
    s_waitcnt lgkmcnt(6)
    v_mfma_f32_16x16x32_bf16 v[136:139], v[212:215], v[144:147], v[136:139]
    v_mfma_f32_16x16x32_bf16 v[140:143], v[212:215], v[160:163], v[140:143]
    s_waitcnt lgkmcnt(5)
    v_mfma_f32_16x16x32_bf16 v[128:131], v[216:219], v[148:151], v[128:131]
    v_mfma_f32_16x16x32_bf16 v[132:135], v[216:219], v[164:167], v[132:135]
    s_waitcnt lgkmcnt(4)
    v_mfma_f32_16x16x32_bf16 v[136:139], v[220:223], v[148:151], v[136:139]
    v_mfma_f32_16x16x32_bf16 v[140:143], v[220:223], v[164:167], v[140:143]
    s_waitcnt lgkmcnt(3)
    v_mfma_f32_16x16x32_bf16 v[128:131], v[224:227], v[152:155], v[128:131]
    v_mfma_f32_16x16x32_bf16 v[132:135], v[224:227], v[168:171], v[132:135]
    s_waitcnt lgkmcnt(2)
    v_mfma_f32_16x16x32_bf16 v[136:139], v[228:231], v[152:155], v[136:139]
    v_mfma_f32_16x16x32_bf16 v[140:143], v[228:231], v[168:171], v[140:143]
    s_waitcnt lgkmcnt(1)
    v_mfma_f32_16x16x32_bf16 v[128:131], v[232:235], v[156:159], v[128:131]
    v_mfma_f32_16x16x32_bf16 v[132:135], v[232:235], v[172:175], v[132:135]
    s_waitcnt lgkmcnt(0)
    v_mfma_f32_16x16x32_bf16 v[136:139], v[236:239], v[156:159], v[136:139]
    v_mfma_f32_16x16x32_bf16 v[140:143], v[236:239], v[172:175], v[140:143]
    s_cmp_eq_u32 s33, 0
    s_cbranch_scc1 L_epi
    v_lshrrev_b32 v10, 4, v7
    v_lshlrev_b32 v0, 5, v10
    v_add_u32 v2, 160000, v0
    s_nop 7
    ds_read_b128 v[176:179], v2 offset:0
    ds_read_b128 v[180:183], v2 offset:16
    ds_read_b128 v[184:187], v2 offset:128
    ds_read_b128 v[188:191], v2 offset:144
    ds_read_b128 v[192:195], v2 offset:256
    ds_read_b128 v[196:199], v2 offset:272
    ds_read_b128 v[200:203], v2 offset:384
    ds_read_b128 v[204:207], v2 offset:400
    s_waitcnt lgkmcnt(6)
    v_mul_f32 v16, v16, v176
    v_mul_f32 v17, v17, v177
    v_mul_f32 v18, v18, v178
    v_mul_f32 v19, v19, v179
    v_mul_f32 v20, v20, v180
    v_mul_f32 v21, v21, v181
    v_mul_f32 v22, v22, v182
    v_mul_f32 v23, v23, v183
    v_mul_f32 v48, v48, v176
    v_mul_f32 v49, v49, v177
    v_mul_f32 v50, v50, v178
    v_mul_f32 v51, v51, v179
    v_mul_f32 v52, v52, v180
    v_mul_f32 v53, v53, v181
    v_mul_f32 v54, v54, v182
    v_mul_f32 v55, v55, v183
    v_cvt_pk_bf16_f32 v144, v16, v17
    v_cvt_pk_bf16_f32 v145, v18, v19
    v_cvt_pk_bf16_f32 v146, v20, v21
    v_cvt_pk_bf16_f32 v147, v22, v23
    v_cvt_pk_bf16_f32 v160, v48, v49
    v_cvt_pk_bf16_f32 v161, v50, v51
    v_cvt_pk_bf16_f32 v162, v52, v53
    v_cvt_pk_bf16_f32 v163, v54, v55
    s_waitcnt lgkmcnt(4)
    v_mul_f32 v24, v24, v184
    v_mul_f32 v25, v25, v185
    v_mul_f32 v26, v26, v186
    v_mul_f32 v27, v27, v187
    v_mul_f32 v28, v28, v188
    v_mul_f32 v29, v29, v189
    v_mul_f32 v30, v30, v190
    v_mul_f32 v31, v31, v191
    v_mul_f32 v56, v56, v184
    v_mul_f32 v57, v57, v185
    v_mul_f32 v58, v58, v186
    v_mul_f32 v59, v59, v187
    v_mul_f32 v60, v60, v188
    v_mul_f32 v61, v61, v189
    v_mul_f32 v62, v62, v190
    v_mul_f32 v63, v63, v191
    v_cvt_pk_bf16_f32 v148, v24, v25
    v_cvt_pk_bf16_f32 v149, v26, v27
    v_cvt_pk_bf16_f32 v150, v28, v29
    v_cvt_pk_bf16_f32 v151, v30, v31
    v_cvt_pk_bf16_f32 v164, v56, v57
    v_cvt_pk_bf16_f32 v165, v58, v59
    v_cvt_pk_bf16_f32 v166, v60, v61
    v_cvt_pk_bf16_f32 v167, v62, v63
    s_waitcnt lgkmcnt(2)
    v_mul_f32 v32, v32, v192
    v_mul_f32 v33, v33, v193
    v_mul_f32 v34, v34, v194
    v_mul_f32 v35, v35, v195
    v_mul_f32 v36, v36, v196
    v_mul_f32 v37, v37, v197
    v_mul_f32 v38, v38, v198
    v_mul_f32 v39, v39, v199
    v_mul_f32 v64, v64, v192
    v_mul_f32 v65, v65, v193
    v_mul_f32 v66, v66, v194
    v_mul_f32 v67, v67, v195
    v_mul_f32 v68, v68, v196
    v_mul_f32 v69, v69, v197
    v_mul_f32 v70, v70, v198
    v_mul_f32 v71, v71, v199
    v_cvt_pk_bf16_f32 v152, v32, v33
    v_cvt_pk_bf16_f32 v153, v34, v35
    v_cvt_pk_bf16_f32 v154, v36, v37
    v_cvt_pk_bf16_f32 v155, v38, v39
    v_cvt_pk_bf16_f32 v168, v64, v65
    v_cvt_pk_bf16_f32 v169, v66, v67
    v_cvt_pk_bf16_f32 v170, v68, v69
    v_cvt_pk_bf16_f32 v171, v70, v71
    s_waitcnt lgkmcnt(0)
    v_mul_f32 v40, v40, v200
    v_mul_f32 v41, v41, v201
    v_mul_f32 v42, v42, v202
    v_mul_f32 v43, v43, v203
    v_mul_f32 v44, v44, v204
    v_mul_f32 v45, v45, v205
    v_mul_f32 v46, v46, v206
    v_mul_f32 v47, v47, v207
    v_mul_f32 v72, v72, v200
    v_mul_f32 v73, v73, v201
    v_mul_f32 v74, v74, v202
    v_mul_f32 v75, v75, v203
    v_mul_f32 v76, v76, v204
    v_mul_f32 v77, v77, v205
    v_mul_f32 v78, v78, v206
    v_mul_f32 v79, v79, v207
    v_cvt_pk_bf16_f32 v156, v40, v41
    v_cvt_pk_bf16_f32 v157, v42, v43
    v_cvt_pk_bf16_f32 v158, v44, v45
    v_cvt_pk_bf16_f32 v159, v46, v47
    v_cvt_pk_bf16_f32 v172, v72, v73
    v_cvt_pk_bf16_f32 v173, v74, v75
    v_cvt_pk_bf16_f32 v174, v76, v77
    v_cvt_pk_bf16_f32 v175, v78, v79
    v_or3_b32 v2, v144, v145, v146
    v_or3_b32 v3, v147, v148, v149
    v_or3_b32 v2, v2, v150, v151
    v_or3_b32 v3, v3, v152, v153
    v_or3_b32 v2, v2, v154, v155
    v_or3_b32 v3, v3, v156, v157
    v_or3_b32 v2, v2, v158, v159
    v_or3_b32 v3, v3, v160, v161
    v_or3_b32 v2, v2, v162, v163
    v_or3_b32 v3, v3, v164, v165
    v_or3_b32 v2, v2, v166, v167
    v_or3_b32 v3, v3, v168, v169
    v_or3_b32 v2, v2, v170, v171
    v_or3_b32 v3, v3, v172, v173
    v_or3_b32 v2, v2, v174, v175
    v_or_b32 v2, v2, v3
    v_and_b32 v2, 0x7fff7fff, v2
    v_cmp_ne_u32 s[74:75], 0, v2
    s_cmp_ge_u32 s34, 6
    s_cbranch_scc0 L_fetched
    s_setprio 2
    v_mov_b32 v12, 135168
L_spin52:
    ds_read_b32 v13, v12 offset:0
    s_waitcnt lgkmcnt(0)
    v_readfirstlane_b32 s38, v13
    s_nop 1
    s_cmp_ge_u32 s38, 1
    s_cbranch_scc1 L_spun53
    s_sleep 1
    s_branch L_spin52
L_spun53:
    s_mov_b32 s37, s38
    s_and_b32 s71, s34, 1
    s_lshl_b32 s71, s71, 1
    s_lshl_b32 s94, -1, s33
    s_not_b32 s95, s94
    v_lshlrev_b32 v6, 4, v7
    s_lshl_b32 s92, s71, 7
    s_add_u32 s92, s92, s39
    s_mov_b32 s93, 0
    s_sub_u32 s78, s33, 1
    s_lshl_b32 s38, s32, 3
    s_add_u32 s38, s38, s78
    s_mul_i32 s76, s38, 33792
    s_lshl_b32 s38, s71, 13
    s_add_u32 s77, s76, s38
    s_lshl_b32 s38, s71, 7
    s_add_u32 s76, s76, s38
    s_add_u32 s76, s76, 32768
    s_add_u32 s79, s77, 4096
    s_mul_i32 s94, s71, 6144
    s_lshl_b32 s91, s71, 11
    s_add_u32 s38, s94, 98304
    v_add_u32 v10, s38, v6
    s_add_u32 s38, s91, 122880
    v_add_u32 v11, s38, v6
    s_lshl_b32 s38, s78, 2
    s_add_u32 s92, s92, s38
    v_lshlrev_b32 v2, 7, v7
L_p2s:
    s_mov_b64 exec, 3
    buffer_load_dword v3, v2, s[28:31], s92 offen sc0 sc1
    s_waitcnt vmcnt(0)
    v_cmp_eq_u32 vcc, s37, v3
    s_mov_b64 exec, -1
    s_cmp_eq_u32 vcc_lo, 3
    s_cbranch_scc0 L_p2s
    buffer_load_dwordx4 v[240:243], v0, s[28:31], s76 offen offset:0 sc0 sc1
    buffer_load_dwordx4 v[244:247], v0, s[28:31], s76 offen offset:16 sc0 sc1
    buffer_load_dwordx4 v[248:251], v0, s[28:31], s76 offen offset:128 sc0 sc1
    buffer_load_dwordx4 v[252:255], v0, s[28:31], s76 offen offset:144 sc0 sc1
    buffer_load_dwordx4 v[176:179], v6, s[28:31], s77 offen offset:0 sc0 sc1
    buffer_load_dwordx4 v[180:183], v6, s[28:31], s77 offen offset:1024 sc0 sc1
    buffer_load_dwordx4 v[184:187], v6, s[28:31], s77 offen offset:2048 sc0 sc1
    buffer_load_dwordx4 v[188:191], v6, s[28:31], s77 offen offset:3072 sc0 sc1
    s_add_u32 s77, s77, 4096
    buffer_load_dwordx4 v[192:195], v6, s[28:31], s77 offen offset:0 sc0 sc1
    buffer_load_dwordx4 v[196:199], v6, s[28:31], s77 offen offset:1024 sc0 sc1
    buffer_load_dwordx4 v[200:203], v6, s[28:31], s77 offen offset:2048 sc0 sc1
    buffer_load_dwordx4 v[204:207], v6, s[28:31], s77 offen offset:3072 sc0 sc1
    s_add_u32 s77, s77, 4096
    buffer_load_dwordx4 v[208:211], v6, s[28:31], s77 offen offset:0 sc0 sc1
    buffer_load_dwordx4 v[212:215], v6, s[28:31], s77 offen offset:1024 sc0 sc1
    buffer_load_dwordx4 v[216:219], v6, s[28:31], s77 offen offset:2048 sc0 sc1
    buffer_load_dwordx4 v[220:223], v6, s[28:31], s77 offen offset:3072 sc0 sc1
    s_add_u32 s77, s77, 4096
    buffer_load_dwordx4 v[224:227], v6, s[28:31], s77 offen offset:0 sc0 sc1
    buffer_load_dwordx4 v[228:231], v6, s[28:31], s77 offen offset:1024 sc0 sc1
    buffer_load_dwordx4 v[232:235], v6, s[28:31], s77 offen offset:2048 sc0 sc1
    buffer_load_dwordx4 v[236:239], v6, s[28:31], s77 offen offset:3072 sc0 sc1
    v_mov_b32 v12, 135168
L_spin54:
    ds_read_b32 v13, v12 offset:8
    s_waitcnt lgkmcnt(0)
    v_readfirstlane_b32 s38, v13
    s_nop 1
    s_cmp_ge_u32 s38, 12
    s_cbranch_scc1 L_spun55
    s_sleep 1
    s_branch L_spin54
L_spun55:
    s_cmp_eq_u32 s78, 0
    s_cbranch_scc1 L_one
    s_waitcnt vmcnt(16)
    v_or3_b32 v2, v240, v241, v242
    v_or3_b32 v3, v243, v244, v245
    v_or3_b32 v3, v3, v246, v247
    v_or3_b32 v2, v2, v248, v249
    v_or3_b32 v3, v3, v250, v251
    v_or3_b32 v2, v2, v252, v253
    v_or3_b32 v3, v3, v254, v255
    v_or_b32 v2, v2, v3
    v_cmp_ne_u32 vcc, 0, v2
    s_nop 4
    s_cbranch_vccnz L_general
L_one:
    s_waitcnt vmcnt(15)
    ds_write_b128 v10, v[176:179] offset:0
    s_waitcnt vmcnt(14)
    ds_write_b128 v10, v[180:183] offset:1024
    s_waitcnt vmcnt(13)
    ds_write_b128 v10, v[184:187] offset:2048
    s_waitcnt vmcnt(12)
    ds_write_b128 v10, v[188:191] offset:3072
    s_waitcnt vmcnt(11)
    ds_write_b128 v10, v[192:195] offset:4096
    s_waitcnt vmcnt(10)
    ds_write_b128 v10, v[196:199] offset:5120
    s_waitcnt vmcnt(9)
    ds_write_b128 v11, v[200:203] offset:0
    s_waitcnt vmcnt(8)
    ds_write_b128 v11, v[204:207] offset:1024
    s_waitcnt vmcnt(7)
    ds_write_b128 v10, v[208:211] offset:6144
    s_waitcnt vmcnt(6)
    ds_write_b128 v10, v[212:215] offset:7168
    s_waitcnt vmcnt(5)
    ds_write_b128 v10, v[216:219] offset:8192
    s_waitcnt vmcnt(4)
    ds_write_b128 v10, v[220:223] offset:9216
    s_waitcnt vmcnt(3)
    ds_write_b128 v10, v[224:227] offset:10240
    s_waitcnt vmcnt(2)
    ds_write_b128 v10, v[228:231] offset:11264
    s_waitcnt vmcnt(1)
    ds_write_b128 v11, v[232:235] offset:2048
    s_waitcnt vmcnt(0)
    ds_write_b128 v11, v[236:239] offset:3072
    v_mov_b32 v12, 135168
    v_mov_b32 v13, 2
    s_mov_b64 exec, 1
    ds_add_u32 v12, v13 offset:12
    s_mov_b64 exec, -1
    s_branch L_fetched
    s_nop 11
L_general:
    s_waitcnt vmcnt(0)
    s_lshl_b32 s92, s71, 7
    s_add_u32 s92, s92, s39
    s_mov_b32 s93, 0
    s_sub_u32 s78, s33, 1
    s_lshl_b32 s38, s32, 3
    s_add_u32 s38, s38, s78
    s_mul_i32 s76, s38, 33792
    s_lshl_b32 s38, s71, 13
    s_add_u32 s77, s76, s38
    s_lshl_b32 s38, s71, 7
    s_add_u32 s76, s76, s38
    s_add_u32 s76, s76, 32768
    s_add_u32 s79, s77, 4096
L_p0:
    s_bitcmp1_b32 s93, s78
    s_cbranch_scc1 L_g0
    v_lshlrev_b32 v2, 2, v7
    s_mov_b32 exec_lo, s95
    s_mov_b32 exec_hi, 0
    buffer_load_dword v3, v2, s[28:31], s92 offen sc0 sc1
    s_waitcnt vmcnt(0)
    v_cmp_eq_u32 vcc, s37, v3
    s_mov_b64 exec, -1
    s_mov_b32 s93, vcc_lo
    s_branch L_p0
L_g0:
    buffer_load_dwordx4 v[240:243], v0, s[28:31], s76 offen offset:0 sc0 sc1
    buffer_load_dwordx4 v[244:247], v0, s[28:31], s76 offen offset:16 sc0 sc1
    buffer_load_dwordx4 v[176:179], v6, s[28:31], s77 offen offset:0 sc0 sc1
    buffer_load_dwordx4 v[180:183], v6, s[28:31], s77 offen offset:1024 sc0 sc1
    buffer_load_dwordx4 v[184:187], v6, s[28:31], s77 offen offset:2048 sc0 sc1
    buffer_load_dwordx4 v[188:191], v6, s[28:31], s77 offen offset:3072 sc0 sc1
    buffer_load_dwordx4 v[192:195], v6, s[28:31], s79 offen offset:0 sc0 sc1
    buffer_load_dwordx4 v[196:199], v6, s[28:31], s79 offen offset:1024 sc0 sc1
    buffer_load_dwordx4 v[200:203], v6, s[28:31], s79 offen offset:2048 sc0 sc1
    buffer_load_dwordx4 v[204:207], v6, s[28:31], s79 offen offset:3072 sc0 sc1
    s_sub_u32 s77, s77, 33792
    s_sub_u32 s79, s79, 33792
    s_sub_u32 s76, s76, 33792
    s_sub_u32 s78, s78, 1
L_p1:
    s_bitcmp1_b32 s93, s78
    s_cbranch_scc1 L_g1
    v_lshlrev_b32 v2, 2, v7
    s_mov_b32 exec_lo, s95
    s_mov_b32 exec_hi, 0
    buffer_load_dword v3, v2, s[28:31], s92 offen sc0 sc1
    s_waitcnt vmcnt(0)
    v_cmp_eq_u32 vcc, s37, v3
    s_mov_b64 exec, -1
    s_mov_b32 s93, vcc_lo
    s_branch L_p1
L_g1:
    buffer_load_dwordx4 v[248:251], v0, s[28:31], s76 offen offset:0 sc0 sc1
    buffer_load_dwordx4 v[252:255], v0, s[28:31], s76 offen offset:16 sc0 sc1
    buffer_load_dwordx4 v[208:211], v6, s[28:31], s77 offen offset:0 sc0 sc1
    buffer_load_dwordx4 v[212:215], v6, s[28:31], s77 offen offset:1024 sc0 sc1
    buffer_load_dwordx4 v[216:219], v6, s[28:31], s77 offen offset:2048 sc0 sc1
    buffer_load_dwordx4 v[220:223], v6, s[28:31], s77 offen offset:3072 sc0 sc1
    buffer_load_dwordx4 v[224:227], v6, s[28:31], s79 offen offset:0 sc0 sc1
    buffer_load_dwordx4 v[228:231], v6, s[28:31], s79 offen offset:1024 sc0 sc1
    buffer_load_dwordx4 v[232:235], v6, s[28:31], s79 offen offset:2048 sc0 sc1
    buffer_load_dwordx4 v[236:239], v6, s[28:31], s79 offen offset:3072 sc0 sc1
    s_sub_u32 s77, s77, 33792
    s_sub_u32 s79, s79, 33792
    s_sub_u32 s76, s76, 33792
    s_waitcnt vmcnt(10)
    v_lshlrev_b32 v16, 16, v176
    v_and_b32 v17, s70, v176
    v_lshlrev_b32 v18, 16, v177
    v_and_b32 v19, s70, v177
    v_lshlrev_b32 v20, 16, v178
    v_and_b32 v21, s70, v178
    v_lshlrev_b32 v22, 16, v179
    v_and_b32 v23, s70, v179
    v_lshlrev_b32 v24, 16, v180
    v_and_b32 v25, s70, v180
    v_lshlrev_b32 v26, 16, v181
    v_and_b32 v27, s70, v181
    v_lshlrev_b32 v28, 16, v182
    v_and_b32 v29, s70, v182
    v_lshlrev_b32 v30, 16, v183
    v_and_b32 v31, s70, v183
    v_lshlrev_b32 v32, 16, v184
    v_and_b32 v33, s70, v184
    v_lshlrev_b32 v34, 16, v185
    v_and_b32 v35, s70, v185
    v_lshlrev_b32 v36, 16, v186
    v_and_b32 v37, s70, v186
    v_lshlrev_b32 v38, 16, v187
    v_and_b32 v39, s70, v187
    v_lshlrev_b32 v40, 16, v188
    v_and_b32 v41, s70, v188
    v_lshlrev_b32 v42, 16, v189
    v_and_b32 v43, s70, v189
    v_lshlrev_b32 v44, 16, v190
    v_and_b32 v45, s70, v190
    v_lshlrev_b32 v46, 16, v191
    v_and_b32 v47, s70, v191
    v_lshlrev_b32 v48, 16, v192
    v_and_b32 v49, s70, v192
    v_lshlrev_b32 v50, 16, v193
    v_and_b32 v51, s70, v193
    v_lshlrev_b32 v52, 16, v194
    v_and_b32 v53, s70, v194
    v_lshlrev_b32 v54, 16, v195
    v_and_b32 v55, s70, v195
    v_lshlrev_b32 v56, 16, v196
    v_and_b32 v57, s70, v196
    v_lshlrev_b32 v58, 16, v197
    v_and_b32 v59, s70, v197
    v_lshlrev_b32 v60, 16, v198
    v_and_b32 v61, s70, v198
    v_lshlrev_b32 v62, 16, v199
    v_and_b32 v63, s70, v199
    v_lshlrev_b32 v64, 16, v200
    v_and_b32 v65, s70, v200
    v_lshlrev_b32 v66, 16, v201
    v_and_b32 v67, s70, v201
    v_lshlrev_b32 v68, 16, v202
    v_and_b32 v69, s70, v202
    v_lshlrev_b32 v70, 16, v203
    v_and_b32 v71, s70, v203
    v_lshlrev_b32 v72, 16, v204
    v_and_b32 v73, s70, v204
    v_lshlrev_b32 v74, 16, v205
    v_and_b32 v75, s70, v205
    v_lshlrev_b32 v76, 16, v206
    v_and_b32 v77, s70, v206
    v_lshlrev_b32 v78, 16, v207
    v_and_b32 v79, s70, v207
    s_waitcnt vmcnt(8)
    s_cmp_eq_u32 s78, 0
    s_cbranch_scc1 L_last0
    v_mul_f32 v248, v248, v240
    v_mul_f32 v249, v249, v241
    v_mul_f32 v250, v250, v242
    v_mul_f32 v251, v251, v243
    v_mul_f32 v252, v252, v244
    v_mul_f32 v253, v253, v245
    v_mul_f32 v254, v254, v246
    v_mul_f32 v255, v255, v247
    v_or3_b32 v2, v248, v249, v250
    v_or3_b32 v3, v251, v252, v253
    v_or3_b32 v3, v3, v254, v255
    v_or_b32 v2, v2, v3
    v_cmp_ne_u32 vcc, 0, v2
    s_nop 4
    s_cbranch_vccnz L_more0
L_last0:
    s_waitcnt vmcnt(0)
    v_lshlrev_b32 v2, 16, v208
    v_and_b32 v3, s70, v208
    v_pk_fma_f32 v[16:17], v[2:3], v[240:241], v[16:17]
    v_lshlrev_b32 v4, 16, v209
    v_and_b32 v5, s70, v209
    v_pk_fma_f32 v[18:19], v[4:5], v[242:243], v[18:19]
    v_lshlrev_b32 v2, 16, v210
    v_and_b32 v3, s70, v210
    v_pk_fma_f32 v[20:21], v[2:3], v[244:245], v[20:21]
    v_lshlrev_b32 v4, 16, v211
    v_and_b32 v5, s70, v211
    v_pk_fma_f32 v[22:23], v[4:5], v[246:247], v[22:23]
    v_lshlrev_b32 v2, 16, v212
    v_and_b32 v3, s70, v212
    v_pk_fma_f32 v[24:25], v[2:3], v[240:241], v[24:25]
    v_lshlrev_b32 v4, 16, v213
    v_and_b32 v5, s70, v213
    v_pk_fma_f32 v[26:27], v[4:5], v[242:243], v[26:27]
    v_lshlrev_b32 v2, 16, v214
    v_and_b32 v3, s70, v214
    v_pk_fma_f32 v[28:29], v[2:3], v[244:245], v[28:29]
    v_lshlrev_b32 v4, 16, v215
    v_and_b32 v5, s70, v215
    v_pk_fma_f32 v[30:31], v[4:5], v[246:247], v[30:31]
    v_lshlrev_b32 v2, 16, v216
    v_and_b32 v3, s70, v216
    v_pk_fma_f32 v[32:33], v[2:3], v[240:241], v[32:33]
    v_lshlrev_b32 v4, 16, v217
    v_and_b32 v5, s70, v217
    v_pk_fma_f32 v[34:35], v[4:5], v[242:243], v[34:35]
    v_lshlrev_b32 v2, 16, v218
    v_and_b32 v3, s70, v218
    v_pk_fma_f32 v[36:37], v[2:3], v[244:245], v[36:37]
    v_lshlrev_b32 v4, 16, v219
    v_and_b32 v5, s70, v219
    v_pk_fma_f32 v[38:39], v[4:5], v[246:247], v[38:39]
    v_lshlrev_b32 v2, 16, v220
    v_and_b32 v3, s70, v220
    v_pk_fma_f32 v[40:41], v[2:3], v[240:241], v[40:41]
    v_lshlrev_b32 v4, 16, v221
    v_and_b32 v5, s70, v221
    v_pk_fma_f32 v[42:43], v[4:5], v[242:243], v[42:43]
    v_lshlrev_b32 v2, 16, v222
    v_and_b32 v3, s70, v222
    v_pk_fma_f32 v[44:45], v[2:3], v[244:245], v[44:45]
    v_lshlrev_b32 v4, 16, v223
    v_and_b32 v5, s70, v223
    v_pk_fma_f32 v[46:47], v[4:5], v[246:247], v[46:47]
    v_lshlrev_b32 v2, 16, v224
    v_and_b32 v3, s70, v224
    v_pk_fma_f32 v[48:49], v[2:3], v[240:241], v[48:49]
    v_lshlrev_b32 v4, 16, v225
    v_and_b32 v5, s70, v225
    v_pk_fma_f32 v[50:51], v[4:5], v[242:243], v[50:51]
    v_lshlrev_b32 v2, 16, v226
    v_and_b32 v3, s70, v226
    v_pk_fma_f32 v[52:53], v[2:3], v[244:245], v[52:53]
    v_lshlrev_b32 v4, 16, v227
    v_and_b32 v5, s70, v227
    v_pk_fma_f32 v[54:55], v[4:5], v[246:247], v[54:55]
    v_lshlrev_b32 v2, 16, v228
    v_and_b32 v3, s70, v228
    v_pk_fma_f32 v[56:57], v[2:3], v[240:241], v[56:57]
    v_lshlrev_b32 v4, 16, v229
    v_and_b32 v5, s70, v229
    v_pk_fma_f32 v[58:59], v[4:5], v[242:243], v[58:59]
    v_lshlrev_b32 v2, 16, v230
    v_and_b32 v3, s70, v230
    v_pk_fma_f32 v[60:61], v[2:3], v[244:245], v[60:61]
    v_lshlrev_b32 v4, 16, v231
    v_and_b32 v5, s70, v231
    v_pk_fma_f32 v[62:63], v[4:5], v[246:247], v[62:63]
    v_lshlrev_b32 v2, 16, v232
    v_and_b32 v3, s70, v232
    v_pk_fma_f32 v[64:65], v[2:3], v[240:241], v[64:65]
    v_lshlrev_b32 v4, 16, v233
    v_and_b32 v5, s70, v233
    v_pk_fma_f32 v[66:67], v[4:5], v[242:243], v[66:67]
    v_lshlrev_b32 v2, 16, v234
    v_and_b32 v3, s70, v234
    v_pk_fma_f32 v[68:69], v[2:3], v[244:245], v[68:69]
    v_lshlrev_b32 v4, 16, v235
    v_and_b32 v5, s70, v235
    v_pk_fma_f32 v[70:71], v[4:5], v[246:247], v[70:71]
    v_lshlrev_b32 v2, 16, v236
    v_and_b32 v3, s70, v236
    v_pk_fma_f32 v[72:73], v[2:3], v[240:241], v[72:73]
    v_lshlrev_b32 v4, 16, v237
    v_and_b32 v5, s70, v237
    v_pk_fma_f32 v[74:75], v[4:5], v[242:243], v[74:75]
    v_lshlrev_b32 v2, 16, v238
    v_and_b32 v3, s70, v238
    v_pk_fma_f32 v[76:77], v[2:3], v[244:245], v[76:77]
    v_lshlrev_b32 v4, 16, v239
    v_and_b32 v5, s70, v239
    v_pk_fma_f32 v[78:79], v[4:5], v[246:247], v[78:79]
    s_branch L_comb_done
    s_nop 11
L_more0:
    s_sub_u32 s78, s78, 1
L_p2:
    s_bitcmp1_b32 s93, s78
    s_cbranch_scc1 L_g2
    v_lshlrev_b32 v2, 2, v7
    s_mov_b32 exec_lo, s95
    s_mov_b32 exec_hi, 0
    buffer_load_dword v3, v2, s[28:31], s92 offen sc0 sc1
    s_waitcnt vmcnt(0)
    v_cmp_eq_u32 vcc, s37, v3
    s_mov_b64 exec, -1
    s_mov_b32 s93, vcc_lo
    s_branch L_p2
L_g2:
    buffer_load_dwordx4 v[8:11], v0, s[28:31], s76 offen offset:0 sc0 sc1
    buffer_load_dwordx4 v[12:15], v0, s[28:31], s76 offen offset:16 sc0 sc1
    buffer_load_dwordx4 v[176:179], v6, s[28:31], s77 offen offset:0 sc0 sc1
    buffer_load_dwordx4 v[180:183], v6, s[28:31], s77 offen offset:1024 sc0 sc1
    buffer_load_dwordx4 v[184:187], v6, s[28:31], s77 offen offset:2048 sc0 sc1
    buffer_load_dwordx4 v[188:191], v6, s[28:31], s77 offen offset:3072 sc0 sc1
    buffer_load_dwordx4 v[192:195], v6, s[28:31], s79 offen offset:0 sc0 sc1
    buffer_load_dwordx4 v[196:199], v6, s[28:31], s79 offen offset:1024 sc0 sc1
    buffer_load_dwordx4 v[200:203], v6, s[28:31], s79 offen offset:2048 sc0 sc1
    buffer_load_dwordx4 v[204:207], v6, s[28:31], s79 offen offset:3072 sc0 sc1
    s_sub_u32 s77, s77, 33792
    s_sub_u32 s79, s79, 33792
    s_sub_u32 s76, s76, 33792
    s_waitcnt vmcnt(10)
    v_lshlrev_b32 v2, 16, v208
    v_and_b32 v3, s70, v208
    v_pk_fma_f32 v[16:17], v[2:3], v[240:241], v[16:17]
    v_lshlrev_b32 v4, 16, v209
    v_and_b32 v5, s70, v209
    v_pk_fma_f32 v[18:19], v[4:5], v[242:243], v[18:19]
    v_lshlrev_b32 v2, 16, v210
    v_and_b32 v3, s70, v210
    v_pk_fma_f32 v[20:21], v[2:3], v[244:245], v[20:21]
    v_lshlrev_b32 v4, 16, v211
    v_and_b32 v5, s70, v211
    v_pk_fma_f32 v[22:23], v[4:5], v[246:247], v[22:23]
    v_lshlrev_b32 v2, 16, v212
    v_and_b32 v3, s70, v212
    v_pk_fma_f32 v[24:25], v[2:3], v[240:241], v[24:25]
    v_lshlrev_b32 v4, 16, v213
    v_and_b32 v5, s70, v213
    v_pk_fma_f32 v[26:27], v[4:5], v[242:243], v[26:27]
    v_lshlrev_b32 v2, 16, v214
    v_and_b32 v3, s70, v214
    v_pk_fma_f32 v[28:29], v[2:3], v[244:245], v[28:29]
    v_lshlrev_b32 v4, 16, v215
    v_and_b32 v5, s70, v215
    v_pk_fma_f32 v[30:31], v[4:5], v[246:247], v[30:31]
    v_lshlrev_b32 v2, 16, v216
    v_and_b32 v3, s70, v216
    v_pk_fma_f32 v[32:33], v[2:3], v[240:241], v[32:33]
    v_lshlrev_b32 v4, 16, v217
    v_and_b32 v5, s70, v217
    v_pk_fma_f32 v[34:35], v[4:5], v[242:243], v[34:35]
    v_lshlrev_b32 v2, 16, v218
    v_and_b32 v3, s70, v218
    v_pk_fma_f32 v[36:37], v[2:3], v[244:245], v[36:37]
    v_lshlrev_b32 v4, 16, v219
    v_and_b32 v5, s70, v219
    v_pk_fma_f32 v[38:39], v[4:5], v[246:247], v[38:39]
    v_lshlrev_b32 v2, 16, v220
    v_and_b32 v3, s70, v220
    v_pk_fma_f32 v[40:41], v[2:3], v[240:241], v[40:41]
    v_lshlrev_b32 v4, 16, v221
    v_and_b32 v5, s70, v221
    v_pk_fma_f32 v[42:43], v[4:5], v[242:243], v[42:43]
    v_lshlrev_b32 v2, 16, v222
    v_and_b32 v3, s70, v222
    v_pk_fma_f32 v[44:45], v[2:3], v[244:245], v[44:45]
    v_lshlrev_b32 v4, 16, v223
    v_and_b32 v5, s70, v223
    v_pk_fma_f32 v[46:47], v[4:5], v[246:247], v[46:47]
    v_lshlrev_b32 v2, 16, v224
    v_and_b32 v3, s70, v224
    v_pk_fma_f32 v[48:49], v[2:3], v[240:241], v[48:49]
    v_lshlrev_b32 v4, 16, v225
    v_and_b32 v5, s70, v225
    v_pk_fma_f32 v[50:51], v[4:5], v[242:243], v[50:51]
    v_lshlrev_b32 v2, 16, v226
    v_and_b32 v3, s70, v226
    v_pk_fma_f32 v[52:53], v[2:3], v[244:245], v[52:53]
    v_lshlrev_b32 v4, 16, v227
    v_and_b32 v5, s70, v227
    v_pk_fma_f32 v[54:55], v[4:5], v[246:247], v[54:55]
    v_lshlrev_b32 v2, 16, v228
    v_and_b32 v3, s70, v228
    v_pk_fma_f32 v[56:57], v[2:3], v[240:241], v[56:57]
    v_lshlrev_b32 v4, 16, v229
    v_and_b32 v5, s70, v229
    v_pk_fma_f32 v[58:59], v[4:5], v[242:243], v[58:59]
    v_lshlrev_b32 v2, 16, v230
    v_and_b32 v3, s70, v230
    v_pk_fma_f32 v[60:61], v[2:3], v[244:245], v[60:61]
    v_lshlrev_b32 v4, 16, v231
    v_and_b32 v5, s70, v231
    v_pk_fma_f32 v[62:63], v[4:5], v[246:247], v[62:63]
    v_lshlrev_b32 v2, 16, v232
    v_and_b32 v3, s70, v232
    v_pk_fma_f32 v[64:65], v[2:3], v[240:241], v[64:65]
    v_lshlrev_b32 v4, 16, v233
    v_and_b32 v5, s70, v233
    v_pk_fma_f32 v[66:67], v[4:5], v[242:243], v[66:67]
    v_lshlrev_b32 v2, 16, v234
    v_and_b32 v3, s70, v234
    v_pk_fma_f32 v[68:69], v[2:3], v[244:245], v[68:69]
    v_lshlrev_b32 v4, 16, v235
    v_and_b32 v5, s70, v235
    v_pk_fma_f32 v[70:71], v[4:5], v[246:247], v[70:71]
    v_lshlrev_b32 v2, 16, v236
    v_and_b32 v3, s70, v236
    v_pk_fma_f32 v[72:73], v[2:3], v[240:241], v[72:73]
    v_lshlrev_b32 v4, 16, v237
    v_and_b32 v5, s70, v237
    v_pk_fma_f32 v[74:75], v[4:5], v[242:243], v[74:75]
    v_lshlrev_b32 v2, 16, v238
    v_and_b32 v3, s70, v238
    v_pk_fma_f32 v[76:77], v[2:3], v[244:245], v[76:77]
    v_lshlrev_b32 v4, 16, v239
    v_and_b32 v5, s70, v239
    v_pk_fma_f32 v[78:79], v[4:5], v[246:247], v[78:79]
    s_waitcnt vmcnt(8)
    s_cmp_eq_u32 s78, 0
    s_cbranch_scc1 L_last1
    v_mul_f32 v8, v8, v248
    v_mul_f32 v9, v9, v249
    v_mul_f32 v10, v10, v250
    v_mul_f32 v11, v11, v251
    v_mul_f32 v12, v12, v252
    v_mul_f32 v13, v13, v253
    v_mul_f32 v14, v14, v254
    v_mul_f32 v15, v15, v255
    v_or3_b32 v2, v8, v9, v10
    v_or3_b32 v3, v11, v12, v13
    v_or3_b32 v3, v3, v14, v15
    v_or_b32 v2, v2, v3
    v_cmp_ne_u32 vcc, 0, v2
    s_nop 4
    s_cbranch_vccnz L_more1
L_last1:
    s_waitcnt vmcnt(0)
    v_lshlrev_b32 v2, 16, v176
    v_and_b32 v3, s70, v176
    v_pk_fma_f32 v[16:17], v[2:3], v[248:249], v[16:17]
    v_lshlrev_b32 v4, 16, v177
    v_and_b32 v5, s70, v177
    v_pk_fma_f32 v[18:19], v[4:5], v[250:251], v[18:19]
    v_lshlrev_b32 v2, 16, v178
    v_and_b32 v3, s70, v178
    v_pk_fma_f32 v[20:21], v[2:3], v[252:253], v[20:21]
    v_lshlrev_b32 v4, 16, v179
    v_and_b32 v5, s70, v179
    v_pk_fma_f32 v[22:23], v[4:5], v[254:255], v[22:23]
    v_lshlrev_b32 v2, 16, v180
    v_and_b32 v3, s70, v180
    v_pk_fma_f32 v[24:25], v[2:3], v[248:249], v[24:25]
    v_lshlrev_b32 v4, 16, v181
    v_and_b32 v5, s70, v181
    v_pk_fma_f32 v[26:27], v[4:5], v[250:251], v[26:27]
    v_lshlrev_b32 v2, 16, v182
    v_and_b32 v3, s70, v182
    v_pk_fma_f32 v[28:29], v[2:3], v[252:253], v[28:29]
    v_lshlrev_b32 v4, 16, v183
    v_and_b32 v5, s70, v183
    v_pk_fma_f32 v[30:31], v[4:5], v[254:255], v[30:31]
    v_lshlrev_b32 v2, 16, v184
    v_and_b32 v3, s70, v184
    v_pk_fma_f32 v[32:33], v[2:3], v[248:249], v[32:33]
    v_lshlrev_b32 v4, 16, v185
    v_and_b32 v5, s70, v185
    v_pk_fma_f32 v[34:35], v[4:5], v[250:251], v[34:35]
    v_lshlrev_b32 v2, 16, v186
    v_and_b32 v3, s70, v186
    v_pk_fma_f32 v[36:37], v[2:3], v[252:253], v[36:37]
    v_lshlrev_b32 v4, 16, v187
    v_and_b32 v5, s70, v187
    v_pk_fma_f32 v[38:39], v[4:5], v[254:255], v[38:39]
    v_lshlrev_b32 v2, 16, v188
    v_and_b32 v3, s70, v188
    v_pk_fma_f32 v[40:41], v[2:3], v[248:249], v[40:41]
    v_lshlrev_b32 v4, 16, v189
    v_and_b32 v5, s70, v189
    v_pk_fma_f32 v[42:43], v[4:5], v[250:251], v[42:43]
    v_lshlrev_b32 v2, 16, v190
    v_and_b32 v3, s70, v190
    v_pk_fma_f32 v[44:45], v[2:3], v[252:253], v[44:45]
    v_lshlrev_b32 v4, 16, v191
    v_and_b32 v5, s70, v191
    v_pk_fma_f32 v[46:47], v[4:5], v[254:255], v[46:47]
    v_lshlrev_b32 v2, 16, v192
    v_and_b32 v3, s70, v192
    v_pk_fma_f32 v[48:49], v[2:3], v[248:249], v[48:49]
    v_lshlrev_b32 v4, 16, v193
    v_and_b32 v5, s70, v193
    v_pk_fma_f32 v[50:51], v[4:5], v[250:251], v[50:51]
    v_lshlrev_b32 v2, 16, v194
    v_and_b32 v3, s70, v194
    v_pk_fma_f32 v[52:53], v[2:3], v[252:253], v[52:53]
    v_lshlrev_b32 v4, 16, v195
    v_and_b32 v5, s70, v195
    v_pk_fma_f32 v[54:55], v[4:5], v[254:255], v[54:55]
    v_lshlrev_b32 v2, 16, v196
    v_and_b32 v3, s70, v196
    v_pk_fma_f32 v[56:57], v[2:3], v[248:249], v[56:57]
    v_lshlrev_b32 v4, 16, v197
    v_and_b32 v5, s70, v197
    v_pk_fma_f32 v[58:59], v[4:5], v[250:251], v[58:59]
    v_lshlrev_b32 v2, 16, v198
    v_and_b32 v3, s70, v198
    v_pk_fma_f32 v[60:61], v[2:3], v[252:253], v[60:61]
    v_lshlrev_b32 v4, 16, v199
    v_and_b32 v5, s70, v199
    v_pk_fma_f32 v[62:63], v[4:5], v[254:255], v[62:63]
    v_lshlrev_b32 v2, 16, v200
    v_and_b32 v3, s70, v200
    v_pk_fma_f32 v[64:65], v[2:3], v[248:249], v[64:65]
    v_lshlrev_b32 v4, 16, v201
    v_and_b32 v5, s70, v201
    v_pk_fma_f32 v[66:67], v[4:5], v[250:251], v[66:67]
    v_lshlrev_b32 v2, 16, v202
    v_and_b32 v3, s70, v202
    v_pk_fma_f32 v[68:69], v[2:3], v[252:253], v[68:69]
    v_lshlrev_b32 v4, 16, v203
    v_and_b32 v5, s70, v203
    v_pk_fma_f32 v[70:71], v[4:5], v[254:255], v[70:71]
    v_lshlrev_b32 v2, 16, v204
    v_and_b32 v3, s70, v204
    v_pk_fma_f32 v[72:73], v[2:3], v[248:249], v[72:73]
    v_lshlrev_b32 v4, 16, v205
    v_and_b32 v5, s70, v205
    v_pk_fma_f32 v[74:75], v[4:5], v[250:251], v[74:75]
    v_lshlrev_b32 v2, 16, v206
    v_and_b32 v3, s70, v206
    v_pk_fma_f32 v[76:77], v[2:3], v[252:253], v[76:77]
    v_lshlrev_b32 v4, 16, v207
    v_and_b32 v5, s70, v207
    v_pk_fma_f32 v[78:79], v[4:5], v[254:255], v[78:79]
    s_branch L_comb_done
    s_nop 11
L_more1:
    s_sub_u32 s78, s78, 1
L_p3:
    s_bitcmp1_b32 s93, s78
    s_cbranch_scc1 L_g3
    v_lshlrev_b32 v2, 2, v7
    s_mov_b32 exec_lo, s95
    s_mov_b32 exec_hi, 0
    buffer_load_dword v3, v2, s[28:31], s92 offen sc0 sc1
    s_waitcnt vmcnt(0)
    v_cmp_eq_u32 vcc, s37, v3
    s_mov_b64 exec, -1
    s_mov_b32 s93, vcc_lo
    s_branch L_p3
L_g3:
    buffer_load_dwordx4 v[240:243], v0, s[28:31], s76 offen offset:0 sc0 sc1
    buffer_load_dwordx4 v[244:247], v0, s[28:31], s76 offen offset:16 sc0 sc1
    buffer_load_dwordx4 v[208:211], v6, s[28:31], s77 offen offset:0 sc0 sc1
    buffer_load_dwordx4 v[212:215], v6, s[28:31], s77 offen offset:1024 sc0 sc1
    buffer_load_dwordx4 v[216:219], v6, s[28:31], s77 offen offset:2048 sc0 sc1
    buffer_load_dwordx4 v[220:223], v6, s[28:31], s77 offen offset:3072 sc0 sc1
    buffer_load_dwordx4 v[224:227], v6, s[28:31], s79 offen offset:0 sc0 sc1
    buffer_load_dwordx4 v[228:231], v6, s[28:31], s79 offen offset:1024 sc0 sc1
    buffer_load_dwordx4 v[232:235], v6, s[28:31], s79 offen offset:2048 sc0 sc1
    buffer_load_dwordx4 v[236:239], v6, s[28:31], s79 offen offset:3072 sc0 sc1
    s_sub_u32 s77, s77, 33792
    s_sub_u32 s79, s79, 33792
    s_sub_u32 s76, s76, 33792
    s_waitcnt vmcnt(10)
    v_lshlrev_b32 v2, 16, v176
    v_and_b32 v3, s70, v176
    v_pk_fma_f32 v[16:17], v[2:3], v[248:249], v[16:17]
    v_lshlrev_b32 v4, 16, v177
    v_and_b32 v5, s70, v177
    v_pk_fma_f32 v[18:19], v[4:5], v[250:251], v[18:19]
    v_lshlrev_b32 v2, 16, v178
    v_and_b32 v3, s70, v178
    v_pk_fma_f32 v[20:21], v[2:3], v[252:253], v[20:21]
    v_lshlrev_b32 v4, 16, v179
    v_and_b32 v5, s70, v179
    v_pk_fma_f32 v[22:23], v[4:5], v[254:255], v[22:23]
    v_lshlrev_b32 v2, 16, v180
    v_and_b32 v3, s70, v180
    v_pk_fma_f32 v[24:25], v[2:3], v[248:249], v[24:25]
    v_lshlrev_b32 v4, 16, v181
    v_and_b32 v5, s70, v181
    v_pk_fma_f32 v[26:27], v[4:5], v[250:251], v[26:27]
    v_lshlrev_b32 v2, 16, v182
    v_and_b32 v3, s70, v182
    v_pk_fma_f32 v[28:29], v[2:3], v[252:253], v[28:29]
    v_lshlrev_b32 v4, 16, v183
    v_and_b32 v5, s70, v183
    v_pk_fma_f32 v[30:31], v[4:5], v[254:255], v[30:31]
    v_lshlrev_b32 v2, 16, v184
    v_and_b32 v3, s70, v184
    v_pk_fma_f32 v[32:33], v[2:3], v[248:249], v[32:33]
    v_lshlrev_b32 v4, 16, v185
    v_and_b32 v5, s70, v185
    v_pk_fma_f32 v[34:35], v[4:5], v[250:251], v[34:35]
    v_lshlrev_b32 v2, 16, v186
    v_and_b32 v3, s70, v186
    v_pk_fma_f32 v[36:37], v[2:3], v[252:253], v[36:37]
    v_lshlrev_b32 v4, 16, v187
    v_and_b32 v5, s70, v187
    v_pk_fma_f32 v[38:39], v[4:5], v[254:255], v[38:39]
    v_lshlrev_b32 v2, 16, v188
    v_and_b32 v3, s70, v188
    v_pk_fma_f32 v[40:41], v[2:3], v[248:249], v[40:41]
    v_lshlrev_b32 v4, 16, v189
    v_and_b32 v5, s70, v189
    v_pk_fma_f32 v[42:43], v[4:5], v[250:251], v[42:43]
    v_lshlrev_b32 v2, 16, v190
    v_and_b32 v3, s70, v190
    v_pk_fma_f32 v[44:45], v[2:3], v[252:253], v[44:45]
    v_lshlrev_b32 v4, 16, v191
    v_and_b32 v5, s70, v191
    v_pk_fma_f32 v[46:47], v[4:5], v[254:255], v[46:47]
    v_lshlrev_b32 v2, 16, v192
    v_and_b32 v3, s70, v192
    v_pk_fma_f32 v[48:49], v[2:3], v[248:249], v[48:49]
    v_lshlrev_b32 v4, 16, v193
    v_and_b32 v5, s70, v193
    v_pk_fma_f32 v[50:51], v[4:5], v[250:251], v[50:51]
    v_lshlrev_b32 v2, 16, v194
    v_and_b32 v3, s70, v194
    v_pk_fma_f32 v[52:53], v[2:3], v[252:253], v[52:53]
    v_lshlrev_b32 v4, 16, v195
    v_and_b32 v5, s70, v195
    v_pk_fma_f32 v[54:55], v[4:5], v[254:255], v[54:55]
    v_lshlrev_b32 v2, 16, v196
    v_and_b32 v3, s70, v196
    v_pk_fma_f32 v[56:57], v[2:3], v[248:249], v[56:57]
    v_lshlrev_b32 v4, 16, v197
    v_and_b32 v5, s70, v197
    v_pk_fma_f32 v[58:59], v[4:5], v[250:251], v[58:59]
    v_lshlrev_b32 v2, 16, v198
    v_and_b32 v3, s70, v198
    v_pk_fma_f32 v[60:61], v[2:3], v[252:253], v[60:61]
    v_lshlrev_b32 v4, 16, v199
    v_and_b32 v5, s70, v199
    v_pk_fma_f32 v[62:63], v[4:5], v[254:255], v[62:63]
    v_lshlrev_b32 v2, 16, v200
    v_and_b32 v3, s70, v200
    v_pk_fma_f32 v[64:65], v[2:3], v[248:249], v[64:65]
    v_lshlrev_b32 v4, 16, v201
    v_and_b32 v5, s70, v201
    v_pk_fma_f32 v[66:67], v[4:5], v[250:251], v[66:67]
    v_lshlrev_b32 v2, 16, v202
    v_and_b32 v3, s70, v202
    v_pk_fma_f32 v[68:69], v[2:3], v[252:253], v[68:69]
    v_lshlrev_b32 v4, 16, v203
    v_and_b32 v5, s70, v203
    v_pk_fma_f32 v[70:71], v[4:5], v[254:255], v[70:71]
    v_lshlrev_b32 v2, 16, v204
    v_and_b32 v3, s70, v204
    v_pk_fma_f32 v[72:73], v[2:3], v[248:249], v[72:73]
    v_lshlrev_b32 v4, 16, v205
    v_and_b32 v5, s70, v205
    v_pk_fma_f32 v[74:75], v[4:5], v[250:251], v[74:75]
    v_lshlrev_b32 v2, 16, v206
    v_and_b32 v3, s70, v206
    v_pk_fma_f32 v[76:77], v[2:3], v[252:253], v[76:77]
    v_lshlrev_b32 v4, 16, v207
    v_and_b32 v5, s70, v207
    v_pk_fma_f32 v[78:79], v[4:5], v[254:255], v[78:79]
    s_waitcnt vmcnt(8)
    s_cmp_eq_u32 s78, 0
    s_cbranch_scc1 L_last2
    v_mul_f32 v240, v240, v8
    v_mul_f32 v241, v241, v9
    v_mul_f32 v242, v242, v10
    v_mul_f32 v243, v243, v11
    v_mul_f32 v244, v244, v12
    v_mul_f32 v245, v245, v13
    v_mul_f32 v246, v246, v14
    v_mul_f32 v247, v247, v15
    v_or3_b32 v2, v240, v241, v242
    v_or3_b32 v3, v243, v244, v245
    v_or3_b32 v3, v3, v246, v247
    v_or_b32 v2, v2, v3
    v_cmp_ne_u32 vcc, 0, v2
    s_nop 4
    s_cbranch_vccnz L_more2
L_last2:
    s_waitcnt vmcnt(0)
    v_lshlrev_b32 v2, 16, v208
    v_and_b32 v3, s70, v208
    v_pk_fma_f32 v[16:17], v[2:3], v[8:9], v[16:17]
    v_lshlrev_b32 v4, 16, v209
    v_and_b32 v5, s70, v209
    v_pk_fma_f32 v[18:19], v[4:5], v[10:11], v[18:19]
    v_lshlrev_b32 v2, 16, v210
    v_and_b32 v3, s70, v210
    v_pk_fma_f32 v[20:21], v[2:3], v[12:13], v[20:21]
    v_lshlrev_b32 v4, 16, v211
    v_and_b32 v5, s70, v211
    v_pk_fma_f32 v[22:23], v[4:5], v[14:15], v[22:23]
    v_lshlrev_b32 v2, 16, v212
    v_and_b32 v3, s70, v212
    v_pk_fma_f32 v[24:25], v[2:3], v[8:9], v[24:25]
    v_lshlrev_b32 v4, 16, v213
    v_and_b32 v5, s70, v213
    v_pk_fma_f32 v[26:27], v[4:5], v[10:11], v[26:27]
    v_lshlrev_b32 v2, 16, v214
    v_and_b32 v3, s70, v214
    v_pk_fma_f32 v[28:29], v[2:3], v[12:13], v[28:29]
    v_lshlrev_b32 v4, 16, v215
    v_and_b32 v5, s70, v215
    v_pk_fma_f32 v[30:31], v[4:5], v[14:15], v[30:31]
    v_lshlrev_b32 v2, 16, v216
    v_and_b32 v3, s70, v216
    v_pk_fma_f32 v[32:33], v[2:3], v[8:9], v[32:33]
    v_lshlrev_b32 v4, 16, v217
    v_and_b32 v5, s70, v217
    v_pk_fma_f32 v[34:35], v[4:5], v[10:11], v[34:35]
    v_lshlrev_b32 v2, 16, v218
    v_and_b32 v3, s70, v218
    v_pk_fma_f32 v[36:37], v[2:3], v[12:13], v[36:37]
    v_lshlrev_b32 v4, 16, v219
    v_and_b32 v5, s70, v219
    v_pk_fma_f32 v[38:39], v[4:5], v[14:15], v[38:39]
    v_lshlrev_b32 v2, 16, v220
    v_and_b32 v3, s70, v220
    v_pk_fma_f32 v[40:41], v[2:3], v[8:9], v[40:41]
    v_lshlrev_b32 v4, 16, v221
    v_and_b32 v5, s70, v221
    v_pk_fma_f32 v[42:43], v[4:5], v[10:11], v[42:43]
    v_lshlrev_b32 v2, 16, v222
    v_and_b32 v3, s70, v222
    v_pk_fma_f32 v[44:45], v[2:3], v[12:13], v[44:45]
    v_lshlrev_b32 v4, 16, v223
    v_and_b32 v5, s70, v223
    v_pk_fma_f32 v[46:47], v[4:5], v[14:15], v[46:47]
    v_lshlrev_b32 v2, 16, v224
    v_and_b32 v3, s70, v224
    v_pk_fma_f32 v[48:49], v[2:3], v[8:9], v[48:49]
    v_lshlrev_b32 v4, 16, v225
    v_and_b32 v5, s70, v225
    v_pk_fma_f32 v[50:51], v[4:5], v[10:11], v[50:51]
    v_lshlrev_b32 v2, 16, v226
    v_and_b32 v3, s70, v226
    v_pk_fma_f32 v[52:53], v[2:3], v[12:13], v[52:53]
    v_lshlrev_b32 v4, 16, v227
    v_and_b32 v5, s70, v227
    v_pk_fma_f32 v[54:55], v[4:5], v[14:15], v[54:55]
    v_lshlrev_b32 v2, 16, v228
    v_and_b32 v3, s70, v228
    v_pk_fma_f32 v[56:57], v[2:3], v[8:9], v[56:57]
    v_lshlrev_b32 v4, 16, v229
    v_and_b32 v5, s70, v229
    v_pk_fma_f32 v[58:59], v[4:5], v[10:11], v[58:59]
    v_lshlrev_b32 v2, 16, v230
    v_and_b32 v3, s70, v230
    v_pk_fma_f32 v[60:61], v[2:3], v[12:13], v[60:61]
    v_lshlrev_b32 v4, 16, v231
    v_and_b32 v5, s70, v231
    v_pk_fma_f32 v[62:63], v[4:5], v[14:15], v[62:63]
    v_lshlrev_b32 v2, 16, v232
    v_and_b32 v3, s70, v232
    v_pk_fma_f32 v[64:65], v[2:3], v[8:9], v[64:65]
    v_lshlrev_b32 v4, 16, v233
    v_and_b32 v5, s70, v233
    v_pk_fma_f32 v[66:67], v[4:5], v[10:11], v[66:67]
    v_lshlrev_b32 v2, 16, v234
    v_and_b32 v3, s70, v234
    v_pk_fma_f32 v[68:69], v[2:3], v[12:13], v[68:69]
    v_lshlrev_b32 v4, 16, v235
    v_and_b32 v5, s70, v235
    v_pk_fma_f32 v[70:71], v[4:5], v[14:15], v[70:71]
    v_lshlrev_b32 v2, 16, v236
    v_and_b32 v3, s70, v236
    v_pk_fma_f32 v[72:73], v[2:3], v[8:9], v[72:73]
    v_lshlrev_b32 v4, 16, v237
    v_and_b32 v5, s70, v237
    v_pk_fma_f32 v[74:75], v[4:5], v[10:11], v[74:75]
    v_lshlrev_b32 v2, 16, v238
    v_and_b32 v3, s70, v238
    v_pk_fma_f32 v[76:77], v[2:3], v[12:13], v[76:77]
    v_lshlrev_b32 v4, 16, v239
    v_and_b32 v5, s70, v239
    v_pk_fma_f32 v[78:79], v[4:5], v[14:15], v[78:79]
    s_branch L_comb_done
    s_nop 11
L_more2:
    s_sub_u32 s78, s78, 1
L_p4:
    s_bitcmp1_b32 s93, s78
    s_cbranch_scc1 L_g4
    v_lshlrev_b32 v2, 2, v7
    s_mov_b32 exec_lo, s95
    s_mov_b32 exec_hi, 0
    buffer_load_dword v3, v2, s[28:31], s92 offen sc0 sc1
    s_waitcnt vmcnt(0)
    v_cmp_eq_u32 vcc, s37, v3
    s_mov_b64 exec, -1
    s_mov_b32 s93, vcc_lo
    s_branch L_p4
L_g4:
    buffer_load_dwordx4 v[248:251], v0, s[28:31], s76 offen offset:0 sc0 sc1
    buffer_load_dwordx4 v[252:255], v0, s[28:31], s76 offen offset:16 sc0 sc1
    buffer_load_dwordx4 v[176:179], v6, s[28:31], s77 offen offset:0 sc0 sc1
    buffer_load_dwordx4 v[180:183], v6, s[28:31], s77 offen offset:1024 sc0 sc1
    buffer_load_dwordx4 v[184:187], v6, s[28:31], s77 offen offset:2048 sc0 sc1
    buffer_load_dwordx4 v[188:191], v6, s[28:31], s77 offen offset:3072 sc0 sc1
    buffer_load_dwordx4 v[192:195], v6, s[28:31], s79 offen offset:0 sc0 sc1
    buffer_load_dwordx4 v[196:199], v6, s[28:31], s79 offen offset:1024 sc0 sc1
    buffer_load_dwordx4 v[200:203], v6, s[28:31], s79 offen offset:2048 sc0 sc1
    buffer_load_dwordx4 v[204:207], v6, s[28:31], s79 offen offset:3072 sc0 sc1
    s_sub_u32 s77, s77, 33792
    s_sub_u32 s79, s79, 33792
    s_sub_u32 s76, s76, 33792
    s_waitcnt vmcnt(10)
    v_lshlrev_b32 v2, 16, v208
    v_and_b32 v3, s70, v208
    v_pk_fma_f32 v[16:17], v[2:3], v[8:9], v[16:17]
    v_lshlrev_b32 v4, 16, v209
    v_and_b32 v5, s70, v209
    v_pk_fma_f32 v[18:19], v[4:5], v[10:11], v[18:19]
    v_lshlrev_b32 v2, 16, v210
    v_and_b32 v3, s70, v210
    v_pk_fma_f32 v[20:21], v[2:3], v[12:13], v[20:21]
    v_lshlrev_b32 v4, 16, v211
    v_and_b32 v5, s70, v211
    v_pk_fma_f32 v[22:23], v[4:5], v[14:15], v[22:23]
    v_lshlrev_b32 v2, 16, v212
    v_and_b32 v3, s70, v212
    v_pk_fma_f32 v[24:25], v[2:3], v[8:9], v[24:25]
    v_lshlrev_b32 v4, 16, v213
    v_and_b32 v5, s70, v213
    v_pk_fma_f32 v[26:27], v[4:5], v[10:11], v[26:27]
    v_lshlrev_b32 v2, 16, v214
    v_and_b32 v3, s70, v214
    v_pk_fma_f32 v[28:29], v[2:3], v[12:13], v[28:29]
    v_lshlrev_b32 v4, 16, v215
    v_and_b32 v5, s70, v215
    v_pk_fma_f32 v[30:31], v[4:5], v[14:15], v[30:31]
    v_lshlrev_b32 v2, 16, v216
    v_and_b32 v3, s70, v216
    v_pk_fma_f32 v[32:33], v[2:3], v[8:9], v[32:33]
    v_lshlrev_b32 v4, 16, v217
    v_and_b32 v5, s70, v217
    v_pk_fma_f32 v[34:35], v[4:5], v[10:11], v[34:35]
    v_lshlrev_b32 v2, 16, v218
    v_and_b32 v3, s70, v218
    v_pk_fma_f32 v[36:37], v[2:3], v[12:13], v[36:37]
    v_lshlrev_b32 v4, 16, v219
    v_and_b32 v5, s70, v219
    v_pk_fma_f32 v[38:39], v[4:5], v[14:15], v[38:39]
    v_lshlrev_b32 v2, 16, v220
    v_and_b32 v3, s70, v220
    v_pk_fma_f32 v[40:41], v[2:3], v[8:9], v[40:41]
    v_lshlrev_b32 v4, 16, v221
    v_and_b32 v5, s70, v221
    v_pk_fma_f32 v[42:43], v[4:5], v[10:11], v[42:43]
    v_lshlrev_b32 v2, 16, v222
    v_and_b32 v3, s70, v222
    v_pk_fma_f32 v[44:45], v[2:3], v[12:13], v[44:45]
    v_lshlrev_b32 v4, 16, v223
    v_and_b32 v5, s70, v223
    v_pk_fma_f32 v[46:47], v[4:5], v[14:15], v[46:47]
    v_lshlrev_b32 v2, 16, v224
    v_and_b32 v3, s70, v224
    v_pk_fma_f32 v[48:49], v[2:3], v[8:9], v[48:49]
    v_lshlrev_b32 v4, 16, v225
    v_and_b32 v5, s70, v225
    v_pk_fma_f32 v[50:51], v[4:5], v[10:11], v[50:51]
    v_lshlrev_b32 v2, 16, v226
    v_and_b32 v3, s70, v226
    v_pk_fma_f32 v[52:53], v[2:3], v[12:13], v[52:53]
    v_lshlrev_b32 v4, 16, v227
    v_and_b32 v5, s70, v227
    v_pk_fma_f32 v[54:55], v[4:5], v[14:15], v[54:55]
    v_lshlrev_b32 v2, 16, v228
    v_and_b32 v3, s70, v228
    v_pk_fma_f32 v[56:57], v[2:3], v[8:9], v[56:57]
    v_lshlrev_b32 v4, 16, v229
    v_and_b32 v5, s70, v229
    v_pk_fma_f32 v[58:59], v[4:5], v[10:11], v[58:59]
    v_lshlrev_b32 v2, 16, v230
    v_and_b32 v3, s70, v230
    v_pk_fma_f32 v[60:61], v[2:3], v[12:13], v[60:61]
    v_lshlrev_b32 v4, 16, v231
    v_and_b32 v5, s70, v231
    v_pk_fma_f32 v[62:63], v[4:5], v[14:15], v[62:63]
    v_lshlrev_b32 v2, 16, v232
    v_and_b32 v3, s70, v232
    v_pk_fma_f32 v[64:65], v[2:3], v[8:9], v[64:65]
    v_lshlrev_b32 v4, 16, v233
    v_and_b32 v5, s70, v233
    v_pk_fma_f32 v[66:67], v[4:5], v[10:11], v[66:67]
    v_lshlrev_b32 v2, 16, v234
    v_and_b32 v3, s70, v234
    v_pk_fma_f32 v[68:69], v[2:3], v[12:13], v[68:69]
    v_lshlrev_b32 v4, 16, v235
    v_and_b32 v5, s70, v235
    v_pk_fma_f32 v[70:71], v[4:5], v[14:15], v[70:71]
    v_lshlrev_b32 v2, 16, v236
    v_and_b32 v3, s70, v236
    v_pk_fma_f32 v[72:73], v[2:3], v[8:9], v[72:73]
    v_lshlrev_b32 v4, 16, v237
    v_and_b32 v5, s70, v237
    v_pk_fma_f32 v[74:75], v[4:5], v[10:11], v[74:75]
    v_lshlrev_b32 v2, 16, v238
    v_and_b32 v3, s70, v238
    v_pk_fma_f32 v[76:77], v[2:3], v[12:13], v[76:77]
    v_lshlrev_b32 v4, 16, v239
    v_and_b32 v5, s70, v239
    v_pk_fma_f32 v[78:79], v[4:5], v[14:15], v[78:79]
    s_waitcnt vmcnt(8)
    s_cmp_eq_u32 s78, 0
    s_cbranch_scc1 L_last3
    v_mul_f32 v248, v248, v240
    v_mul_f32 v249, v249, v241
    v_mul_f32 v250, v250, v242
    v_mul_f32 v251, v251, v243
    v_mul_f32 v252, v252, v244
    v_mul_f32 v253, v253, v245
    v_mul_f32 v254, v254, v246
    v_mul_f32 v255, v255, v247
    v_or3_b32 v2, v248, v249, v250
    v_or3_b32 v3, v251, v252, v253
    v_or3_b32 v3, v3, v254, v255
    v_or_b32 v2, v2, v3
    v_cmp_ne_u32 vcc, 0, v2
    s_nop 4
    s_cbranch_vccnz L_more3
L_last3:
    s_waitcnt vmcnt(0)
    v_lshlrev_b32 v2, 16, v176
    v_and_b32 v3, s70, v176
    v_pk_fma_f32 v[16:17], v[2:3], v[240:241], v[16:17]
    v_lshlrev_b32 v4, 16, v177
    v_and_b32 v5, s70, v177
    v_pk_fma_f32 v[18:19], v[4:5], v[242:243], v[18:19]
    v_lshlrev_b32 v2, 16, v178
    v_and_b32 v3, s70, v178
    v_pk_fma_f32 v[20:21], v[2:3], v[244:245], v[20:21]
    v_lshlrev_b32 v4, 16, v179
    v_and_b32 v5, s70, v179
    v_pk_fma_f32 v[22:23], v[4:5], v[246:247], v[22:23]
    v_lshlrev_b32 v2, 16, v180
    v_and_b32 v3, s70, v180
    v_pk_fma_f32 v[24:25], v[2:3], v[240:241], v[24:25]
    v_lshlrev_b32 v4, 16, v181
    v_and_b32 v5, s70, v181
    v_pk_fma_f32 v[26:27], v[4:5], v[242:243], v[26:27]
    v_lshlrev_b32 v2, 16, v182
    v_and_b32 v3, s70, v182
    v_pk_fma_f32 v[28:29], v[2:3], v[244:245], v[28:29]
    v_lshlrev_b32 v4, 16, v183
    v_and_b32 v5, s70, v183
    v_pk_fma_f32 v[30:31], v[4:5], v[246:247], v[30:31]
    v_lshlrev_b32 v2, 16, v184
    v_and_b32 v3, s70, v184
    v_pk_fma_f32 v[32:33], v[2:3], v[240:241], v[32:33]
    v_lshlrev_b32 v4, 16, v185
    v_and_b32 v5, s70, v185
    v_pk_fma_f32 v[34:35], v[4:5], v[242:243], v[34:35]
    v_lshlrev_b32 v2, 16, v186
    v_and_b32 v3, s70, v186
    v_pk_fma_f32 v[36:37], v[2:3], v[244:245], v[36:37]
    v_lshlrev_b32 v4, 16, v187
    v_and_b32 v5, s70, v187
    v_pk_fma_f32 v[38:39], v[4:5], v[246:247], v[38:39]
    v_lshlrev_b32 v2, 16, v188
    v_and_b32 v3, s70, v188
    v_pk_fma_f32 v[40:41], v[2:3], v[240:241], v[40:41]
    v_lshlrev_b32 v4, 16, v189
    v_and_b32 v5, s70, v189
    v_pk_fma_f32 v[42:43], v[4:5], v[242:243], v[42:43]
    v_lshlrev_b32 v2, 16, v190
    v_and_b32 v3, s70, v190
    v_pk_fma_f32 v[44:45], v[2:3], v[244:245], v[44:45]
    v_lshlrev_b32 v4, 16, v191
    v_and_b32 v5, s70, v191
    v_pk_fma_f32 v[46:47], v[4:5], v[246:247], v[46:47]
    v_lshlrev_b32 v2, 16, v192
    v_and_b32 v3, s70, v192
    v_pk_fma_f32 v[48:49], v[2:3], v[240:241], v[48:49]
    v_lshlrev_b32 v4, 16, v193
    v_and_b32 v5, s70, v193
    v_pk_fma_f32 v[50:51], v[4:5], v[242:243], v[50:51]
    v_lshlrev_b32 v2, 16, v194
    v_and_b32 v3, s70, v194
    v_pk_fma_f32 v[52:53], v[2:3], v[244:245], v[52:53]
    v_lshlrev_b32 v4, 16, v195
    v_and_b32 v5, s70, v195
    v_pk_fma_f32 v[54:55], v[4:5], v[246:247], v[54:55]
    v_lshlrev_b32 v2, 16, v196
    v_and_b32 v3, s70, v196
    v_pk_fma_f32 v[56:57], v[2:3], v[240:241], v[56:57]
    v_lshlrev_b32 v4, 16, v197
    v_and_b32 v5, s70, v197
    v_pk_fma_f32 v[58:59], v[4:5], v[242:243], v[58:59]
    v_lshlrev_b32 v2, 16, v198
    v_and_b32 v3, s70, v198
    v_pk_fma_f32 v[60:61], v[2:3], v[244:245], v[60:61]
    v_lshlrev_b32 v4, 16, v199
    v_and_b32 v5, s70, v199
    v_pk_fma_f32 v[62:63], v[4:5], v[246:247], v[62:63]
    v_lshlrev_b32 v2, 16, v200
    v_and_b32 v3, s70, v200
    v_pk_fma_f32 v[64:65], v[2:3], v[240:241], v[64:65]
    v_lshlrev_b32 v4, 16, v201
    v_and_b32 v5, s70, v201
    v_pk_fma_f32 v[66:67], v[4:5], v[242:243], v[66:67]
    v_lshlrev_b32 v2, 16, v202
    v_and_b32 v3, s70, v202
    v_pk_fma_f32 v[68:69], v[2:3], v[244:245], v[68:69]
    v_lshlrev_b32 v4, 16, v203
    v_and_b32 v5, s70, v203
    v_pk_fma_f32 v[70:71], v[4:5], v[246:247], v[70:71]
    v_lshlrev_b32 v2, 16, v204
    v_and_b32 v3, s70, v204
    v_pk_fma_f32 v[72:73], v[2:3], v[240:241], v[72:73]
    v_lshlrev_b32 v4, 16, v205
    v_and_b32 v5, s70, v205
    v_pk_fma_f32 v[74:75], v[4:5], v[242:243], v[74:75]
    v_lshlrev_b32 v2, 16, v206
    v_and_b32 v3, s70, v206
    v_pk_fma_f32 v[76:77], v[2:3], v[244:245], v[76:77]
    v_lshlrev_b32 v4, 16, v207
    v_and_b32 v5, s70, v207
    v_pk_fma_f32 v[78:79], v[4:5], v[246:247], v[78:79]
    s_branch L_comb_done
    s_nop 11
L_more3:
    s_sub_u32 s78, s78, 1
L_p5:
    s_bitcmp1_b32 s93, s78
    s_cbranch_scc1 L_g5
    v_lshlrev_b32 v2, 2, v7
    s_mov_b32 exec_lo, s95
    s_mov_b32 exec_hi, 0
    buffer_load_dword v3, v2, s[28:31], s92 offen sc0 sc1
    s_waitcnt vmcnt(0)
    v_cmp_eq_u32 vcc, s37, v3
    s_mov_b64 exec, -1
    s_mov_b32 s93, vcc_lo
    s_branch L_p5
L_g5:
    buffer_load_dwordx4 v[8:11], v0, s[28:31], s76 offen offset:0 sc0 sc1
    buffer_load_dwordx4 v[12:15], v0, s[28:31], s76 offen offset:16 sc0 sc1
    buffer_load_dwordx4 v[208:211], v6, s[28:31], s77 offen offset:0 sc0 sc1
    buffer_load_dwordx4 v[212:215], v6, s[28:31], s77 offen offset:1024 sc0 sc1
    buffer_load_dwordx4 v[216:219], v6, s[28:31], s77 offen offset:2048 sc0 sc1
    buffer_load_dwordx4 v[220:223], v6, s[28:31], s77 offen offset:3072 sc0 sc1
    buffer_load_dwordx4 v[224:227], v6, s[28:31], s79 offen offset:0 sc0 sc1
    buffer_load_dwordx4 v[228:231], v6, s[28:31], s79 offen offset:1024 sc0 sc1
    buffer_load_dwordx4 v[232:235], v6, s[28:31], s79 offen offset:2048 sc0 sc1
    buffer_load_dwordx4 v[236:239], v6, s[28:31], s79 offen offset:3072 sc0 sc1
    s_sub_u32 s77, s77, 33792
    s_sub_u32 s79, s79, 33792
    s_sub_u32 s76, s76, 33792
    s_waitcnt vmcnt(10)
    v_lshlrev_b32 v2, 16, v176
    v_and_b32 v3, s70, v176
    v_pk_fma_f32 v[16:17], v[2:3], v[240:241], v[16:17]
    v_lshlrev_b32 v4, 16, v177
    v_and_b32 v5, s70, v177
    v_pk_fma_f32 v[18:19], v[4:5], v[242:243], v[18:19]
    v_lshlrev_b32 v2, 16, v178
    v_and_b32 v3, s70, v178
    v_pk_fma_f32 v[20:21], v[2:3], v[244:245], v[20:21]
    v_lshlrev_b32 v4, 16, v179
    v_and_b32 v5, s70, v179
    v_pk_fma_f32 v[22:23], v[4:5], v[246:247], v[22:23]
    v_lshlrev_b32 v2, 16, v180
    v_and_b32 v3, s70, v180
    v_pk_fma_f32 v[24:25], v[2:3], v[240:241], v[24:25]
    v_lshlrev_b32 v4, 16, v181
    v_and_b32 v5, s70, v181
    v_pk_fma_f32 v[26:27], v[4:5], v[242:243], v[26:27]
    v_lshlrev_b32 v2, 16, v182
    v_and_b32 v3, s70, v182
    v_pk_fma_f32 v[28:29], v[2:3], v[244:245], v[28:29]
    v_lshlrev_b32 v4, 16, v183
    v_and_b32 v5, s70, v183
    v_pk_fma_f32 v[30:31], v[4:5], v[246:247], v[30:31]
    v_lshlrev_b32 v2, 16, v184
    v_and_b32 v3, s70, v184
    v_pk_fma_f32 v[32:33], v[2:3], v[240:241], v[32:33]
    v_lshlrev_b32 v4, 16, v185
    v_and_b32 v5, s70, v185
    v_pk_fma_f32 v[34:35], v[4:5], v[242:243], v[34:35]
    v_lshlrev_b32 v2, 16, v186
    v_and_b32 v3, s70, v186
    v_pk_fma_f32 v[36:37], v[2:3], v[244:245], v[36:37]
    v_lshlrev_b32 v4, 16, v187
    v_and_b32 v5, s70, v187
    v_pk_fma_f32 v[38:39], v[4:5], v[246:247], v[38:39]
    v_lshlrev_b32 v2, 16, v188
    v_and_b32 v3, s70, v188
    v_pk_fma_f32 v[40:41], v[2:3], v[240:241], v[40:41]
    v_lshlrev_b32 v4, 16, v189
    v_and_b32 v5, s70, v189
    v_pk_fma_f32 v[42:43], v[4:5], v[242:243], v[42:43]
    v_lshlrev_b32 v2, 16, v190
    v_and_b32 v3, s70, v190
    v_pk_fma_f32 v[44:45], v[2:3], v[244:245], v[44:45]
    v_lshlrev_b32 v4, 16, v191
    v_and_b32 v5, s70, v191
    v_pk_fma_f32 v[46:47], v[4:5], v[246:247], v[46:47]
    v_lshlrev_b32 v2, 16, v192
    v_and_b32 v3, s70, v192
    v_pk_fma_f32 v[48:49], v[2:3], v[240:241], v[48:49]
    v_lshlrev_b32 v4, 16, v193
    v_and_b32 v5, s70, v193
    v_pk_fma_f32 v[50:51], v[4:5], v[242:243], v[50:51]
    v_lshlrev_b32 v2, 16, v194
    v_and_b32 v3, s70, v194
    v_pk_fma_f32 v[52:53], v[2:3], v[244:245], v[52:53]
    v_lshlrev_b32 v4, 16, v195
    v_and_b32 v5, s70, v195
    v_pk_fma_f32 v[54:55], v[4:5], v[246:247], v[54:55]
    v_lshlrev_b32 v2, 16, v196
    v_and_b32 v3, s70, v196
    v_pk_fma_f32 v[56:57], v[2:3], v[240:241], v[56:57]
    v_lshlrev_b32 v4, 16, v197
    v_and_b32 v5, s70, v197
    v_pk_fma_f32 v[58:59], v[4:5], v[242:243], v[58:59]
    v_lshlrev_b32 v2, 16, v198
    v_and_b32 v3, s70, v198
    v_pk_fma_f32 v[60:61], v[2:3], v[244:245], v[60:61]
    v_lshlrev_b32 v4, 16, v199
    v_and_b32 v5, s70, v199
    v_pk_fma_f32 v[62:63], v[4:5], v[246:247], v[62:63]
    v_lshlrev_b32 v2, 16, v200
    v_and_b32 v3, s70, v200
    v_pk_fma_f32 v[64:65], v[2:3], v[240:241], v[64:65]
    v_lshlrev_b32 v4, 16, v201
    v_and_b32 v5, s70, v201
    v_pk_fma_f32 v[66:67], v[4:5], v[242:243], v[66:67]
    v_lshlrev_b32 v2, 16, v202
    v_and_b32 v3, s70, v202
    v_pk_fma_f32 v[68:69], v[2:3], v[244:245], v[68:69]
    v_lshlrev_b32 v4, 16, v203
    v_and_b32 v5, s70, v203
    v_pk_fma_f32 v[70:71], v[4:5], v[246:247], v[70:71]
    v_lshlrev_b32 v2, 16, v204
    v_and_b32 v3, s70, v204
    v_pk_fma_f32 v[72:73], v[2:3], v[240:241], v[72:73]
    v_lshlrev_b32 v4, 16, v205
    v_and_b32 v5, s70, v205
    v_pk_fma_f32 v[74:75], v[4:5], v[242:243], v[74:75]
    v_lshlrev_b32 v2, 16, v206
    v_and_b32 v3, s70, v206
    v_pk_fma_f32 v[76:77], v[2:3], v[244:245], v[76:77]
    v_lshlrev_b32 v4, 16, v207
    v_and_b32 v5, s70, v207
    v_pk_fma_f32 v[78:79], v[4:5], v[246:247], v[78:79]
    s_waitcnt vmcnt(8)
    s_cmp_eq_u32 s78, 0
    s_cbranch_scc1 L_last4
    v_mul_f32 v8, v8, v248
    v_mul_f32 v9, v9, v249
    v_mul_f32 v10, v10, v250
    v_mul_f32 v11, v11, v251
    v_mul_f32 v12, v12, v252
    v_mul_f32 v13, v13, v253
    v_mul_f32 v14, v14, v254
    v_mul_f32 v15, v15, v255
    v_or3_b32 v2, v8, v9, v10
    v_or3_b32 v3, v11, v12, v13
    v_or3_b32 v3, v3, v14, v15
    v_or_b32 v2, v2, v3
    v_cmp_ne_u32 vcc, 0, v2
    s_nop 4
    s_cbranch_vccnz L_more4
L_last4:
    s_waitcnt vmcnt(0)
    v_lshlrev_b32 v2, 16, v208
    v_and_b32 v3, s70, v208
    v_pk_fma_f32 v[16:17], v[2:3], v[248:249], v[16:17]
    v_lshlrev_b32 v4, 16, v209
    v_and_b32 v5, s70, v209
    v_pk_fma_f32 v[18:19], v[4:5], v[250:251], v[18:19]
    v_lshlrev_b32 v2, 16, v210
    v_and_b32 v3, s70, v210
    v_pk_fma_f32 v[20:21], v[2:3], v[252:253], v[20:21]
    v_lshlrev_b32 v4, 16, v211
    v_and_b32 v5, s70, v211
    v_pk_fma_f32 v[22:23], v[4:5], v[254:255], v[22:23]
    v_lshlrev_b32 v2, 16, v212
    v_and_b32 v3, s70, v212
    v_pk_fma_f32 v[24:25], v[2:3], v[248:249], v[24:25]
    v_lshlrev_b32 v4, 16, v213
    v_and_b32 v5, s70, v213
    v_pk_fma_f32 v[26:27], v[4:5], v[250:251], v[26:27]
    v_lshlrev_b32 v2, 16, v214
    v_and_b32 v3, s70, v214
    v_pk_fma_f32 v[28:29], v[2:3], v[252:253], v[28:29]
    v_lshlrev_b32 v4, 16, v215
    v_and_b32 v5, s70, v215
    v_pk_fma_f32 v[30:31], v[4:5], v[254:255], v[30:31]
    v_lshlrev_b32 v2, 16, v216
    v_and_b32 v3, s70, v216
    v_pk_fma_f32 v[32:33], v[2:3], v[248:249], v[32:33]
    v_lshlrev_b32 v4, 16, v217
    v_and_b32 v5, s70, v217
    v_pk_fma_f32 v[34:35], v[4:5], v[250:251], v[34:35]
    v_lshlrev_b32 v2, 16, v218
    v_and_b32 v3, s70, v218
    v_pk_fma_f32 v[36:37], v[2:3], v[252:253], v[36:37]
    v_lshlrev_b32 v4, 16, v219
    v_and_b32 v5, s70, v219
    v_pk_fma_f32 v[38:39], v[4:5], v[254:255], v[38:39]
    v_lshlrev_b32 v2, 16, v220
    v_and_b32 v3, s70, v220
    v_pk_fma_f32 v[40:41], v[2:3], v[248:249], v[40:41]
    v_lshlrev_b32 v4, 16, v221
    v_and_b32 v5, s70, v221
    v_pk_fma_f32 v[42:43], v[4:5], v[250:251], v[42:43]
    v_lshlrev_b32 v2, 16, v222
    v_and_b32 v3, s70, v222
    v_pk_fma_f32 v[44:45], v[2:3], v[252:253], v[44:45]
    v_lshlrev_b32 v4, 16, v223
    v_and_b32 v5, s70, v223
    v_pk_fma_f32 v[46:47], v[4:5], v[254:255], v[46:47]
    v_lshlrev_b32 v2, 16, v224
    v_and_b32 v3, s70, v224
    v_pk_fma_f32 v[48:49], v[2:3], v[248:249], v[48:49]
    v_lshlrev_b32 v4, 16, v225
    v_and_b32 v5, s70, v225
    v_pk_fma_f32 v[50:51], v[4:5], v[250:251], v[50:51]
    v_lshlrev_b32 v2, 16, v226
    v_and_b32 v3, s70, v226
    v_pk_fma_f32 v[52:53], v[2:3], v[252:253], v[52:53]
    v_lshlrev_b32 v4, 16, v227
    v_and_b32 v5, s70, v227
    v_pk_fma_f32 v[54:55], v[4:5], v[254:255], v[54:55]
    v_lshlrev_b32 v2, 16, v228
    v_and_b32 v3, s70, v228
    v_pk_fma_f32 v[56:57], v[2:3], v[248:249], v[56:57]
    v_lshlrev_b32 v4, 16, v229
    v_and_b32 v5, s70, v229
    v_pk_fma_f32 v[58:59], v[4:5], v[250:251], v[58:59]
    v_lshlrev_b32 v2, 16, v230
    v_and_b32 v3, s70, v230
    v_pk_fma_f32 v[60:61], v[2:3], v[252:253], v[60:61]
    v_lshlrev_b32 v4, 16, v231
    v_and_b32 v5, s70, v231
    v_pk_fma_f32 v[62:63], v[4:5], v[254:255], v[62:63]
    v_lshlrev_b32 v2, 16, v232
    v_and_b32 v3, s70, v232
    v_pk_fma_f32 v[64:65], v[2:3], v[248:249], v[64:65]
    v_lshlrev_b32 v4, 16, v233
    v_and_b32 v5, s70, v233
    v_pk_fma_f32 v[66:67], v[4:5], v[250:251], v[66:67]
    v_lshlrev_b32 v2, 16, v234
    v_and_b32 v3, s70, v234
    v_pk_fma_f32 v[68:69], v[2:3], v[252:253], v[68:69]
    v_lshlrev_b32 v4, 16, v235
    v_and_b32 v5, s70, v235
    v_pk_fma_f32 v[70:71], v[4:5], v[254:255], v[70:71]
    v_lshlrev_b32 v2, 16, v236
    v_and_b32 v3, s70, v236
    v_pk_fma_f32 v[72:73], v[2:3], v[248:249], v[72:73]
    v_lshlrev_b32 v4, 16, v237
    v_and_b32 v5, s70, v237
    v_pk_fma_f32 v[74:75], v[4:5], v[250:251], v[74:75]
    v_lshlrev_b32 v2, 16, v238
    v_and_b32 v3, s70, v238
    v_pk_fma_f32 v[76:77], v[2:3], v[252:253], v[76:77]
    v_lshlrev_b32 v4, 16, v239
    v_and_b32 v5, s70, v239
    v_pk_fma_f32 v[78:79], v[4:5], v[254:255], v[78:79]
    s_branch L_comb_done
    s_nop 11
L_more4:
    s_sub_u32 s78, s78, 1
L_p6:
    s_bitcmp1_b32 s93, s78
    s_cbranch_scc1 L_g6
    v_lshlrev_b32 v2, 2, v7
    s_mov_b32 exec_lo, s95
    s_mov_b32 exec_hi, 0
    buffer_load_dword v3, v2, s[28:31], s92 offen sc0 sc1
    s_waitcnt vmcnt(0)
    v_cmp_eq_u32 vcc, s37, v3
    s_mov_b64 exec, -1
    s_mov_b32 s93, vcc_lo
    s_branch L_p6
L_g6:
    buffer_load_dwordx4 v[240:243], v0, s[28:31], s76 offen offset:0 sc0 sc1
    buffer_load_dwordx4 v[244:247], v0, s[28:31], s76 offen offset:16 sc0 sc1
    buffer_load_dwordx4 v[176:179], v6, s[28:31], s77 offen offset:0 sc0 sc1
    buffer_load_dwordx4 v[180:183], v6, s[28:31], s77 offen offset:1024 sc0 sc1
    buffer_load_dwordx4 v[184:187], v6, s[28:31], s77 offen offset:2048 sc0 sc1
    buffer_load_dwordx4 v[188:191], v6, s[28:31], s77 offen offset:3072 sc0 sc1
    buffer_load_dwordx4 v[192:195], v6, s[28:31], s79 offen offset:0 sc0 sc1
    buffer_load_dwordx4 v[196:199], v6, s[28:31], s79 offen offset:1024 sc0 sc1
    buffer_load_dwordx4 v[200:203], v6, s[28:31], s79 offen offset:2048 sc0 sc1
    buffer_load_dwordx4 v[204:207], v6, s[28:31], s79 offen offset:3072 sc0 sc1
    s_sub_u32 s77, s77, 33792
    s_sub_u32 s79, s79, 33792
    s_sub_u32 s76, s76, 33792
    s_waitcnt vmcnt(10)
    v_lshlrev_b32 v2, 16, v208
    v_and_b32 v3, s70, v208
    v_pk_fma_f32 v[16:17], v[2:3], v[248:249], v[16:17]
    v_lshlrev_b32 v4, 16, v209
    v_and_b32 v5, s70, v209
    v_pk_fma_f32 v[18:19], v[4:5], v[250:251], v[18:19]
    v_lshlrev_b32 v2, 16, v210
    v_and_b32 v3, s70, v210
    v_pk_fma_f32 v[20:21], v[2:3], v[252:253], v[20:21]
    v_lshlrev_b32 v4, 16, v211
    v_and_b32 v5, s70, v211
    v_pk_fma_f32 v[22:23], v[4:5], v[254:255], v[22:23]
    v_lshlrev_b32 v2, 16, v212
    v_and_b32 v3, s70, v212
    v_pk_fma_f32 v[24:25], v[2:3], v[248:249], v[24:25]
    v_lshlrev_b32 v4, 16, v213
    v_and_b32 v5, s70, v213
    v_pk_fma_f32 v[26:27], v[4:5], v[250:251], v[26:27]
    v_lshlrev_b32 v2, 16, v214
    v_and_b32 v3, s70, v214
    v_pk_fma_f32 v[28:29], v[2:3], v[252:253], v[28:29]
    v_lshlrev_b32 v4, 16, v215
    v_and_b32 v5, s70, v215
    v_pk_fma_f32 v[30:31], v[4:5], v[254:255], v[30:31]
    v_lshlrev_b32 v2, 16, v216
    v_and_b32 v3, s70, v216
    v_pk_fma_f32 v[32:33], v[2:3], v[248:249], v[32:33]
    v_lshlrev_b32 v4, 16, v217
    v_and_b32 v5, s70, v217
    v_pk_fma_f32 v[34:35], v[4:5], v[250:251], v[34:35]
    v_lshlrev_b32 v2, 16, v218
    v_and_b32 v3, s70, v218
    v_pk_fma_f32 v[36:37], v[2:3], v[252:253], v[36:37]
    v_lshlrev_b32 v4, 16, v219
    v_and_b32 v5, s70, v219
    v_pk_fma_f32 v[38:39], v[4:5], v[254:255], v[38:39]
    v_lshlrev_b32 v2, 16, v220
    v_and_b32 v3, s70, v220
    v_pk_fma_f32 v[40:41], v[2:3], v[248:249], v[40:41]
    v_lshlrev_b32 v4, 16, v221
    v_and_b32 v5, s70, v221
    v_pk_fma_f32 v[42:43], v[4:5], v[250:251], v[42:43]
    v_lshlrev_b32 v2, 16, v222
    v_and_b32 v3, s70, v222
    v_pk_fma_f32 v[44:45], v[2:3], v[252:253], v[44:45]
    v_lshlrev_b32 v4, 16, v223
    v_and_b32 v5, s70, v223
    v_pk_fma_f32 v[46:47], v[4:5], v[254:255], v[46:47]
    v_lshlrev_b32 v2, 16, v224
    v_and_b32 v3, s70, v224
    v_pk_fma_f32 v[48:49], v[2:3], v[248:249], v[48:49]
    v_lshlrev_b32 v4, 16, v225
    v_and_b32 v5, s70, v225
    v_pk_fma_f32 v[50:51], v[4:5], v[250:251], v[50:51]
    v_lshlrev_b32 v2, 16, v226
    v_and_b32 v3, s70, v226
    v_pk_fma_f32 v[52:53], v[2:3], v[252:253], v[52:53]
    v_lshlrev_b32 v4, 16, v227
    v_and_b32 v5, s70, v227
    v_pk_fma_f32 v[54:55], v[4:5], v[254:255], v[54:55]
    v_lshlrev_b32 v2, 16, v228
    v_and_b32 v3, s70, v228
    v_pk_fma_f32 v[56:57], v[2:3], v[248:249], v[56:57]
    v_lshlrev_b32 v4, 16, v229
    v_and_b32 v5, s70, v229
    v_pk_fma_f32 v[58:59], v[4:5], v[250:251], v[58:59]
    v_lshlrev_b32 v2, 16, v230
    v_and_b32 v3, s70, v230
    v_pk_fma_f32 v[60:61], v[2:3], v[252:253], v[60:61]
    v_lshlrev_b32 v4, 16, v231
    v_and_b32 v5, s70, v231
    v_pk_fma_f32 v[62:63], v[4:5], v[254:255], v[62:63]
    v_lshlrev_b32 v2, 16, v232
    v_and_b32 v3, s70, v232
    v_pk_fma_f32 v[64:65], v[2:3], v[248:249], v[64:65]
    v_lshlrev_b32 v4, 16, v233
    v_and_b32 v5, s70, v233
    v_pk_fma_f32 v[66:67], v[4:5], v[250:251], v[66:67]
    v_lshlrev_b32 v2, 16, v234
    v_and_b32 v3, s70, v234
    v_pk_fma_f32 v[68:69], v[2:3], v[252:253], v[68:69]
    v_lshlrev_b32 v4, 16, v235
    v_and_b32 v5, s70, v235
    v_pk_fma_f32 v[70:71], v[4:5], v[254:255], v[70:71]
    v_lshlrev_b32 v2, 16, v236
    v_and_b32 v3, s70, v236
    v_pk_fma_f32 v[72:73], v[2:3], v[248:249], v[72:73]
    v_lshlrev_b32 v4, 16, v237
    v_and_b32 v5, s70, v237
    v_pk_fma_f32 v[74:75], v[4:5], v[250:251], v[74:75]
    v_lshlrev_b32 v2, 16, v238
    v_and_b32 v3, s70, v238
    v_pk_fma_f32 v[76:77], v[2:3], v[252:253], v[76:77]
    v_lshlrev_b32 v4, 16, v239
    v_and_b32 v5, s70, v239
    v_pk_fma_f32 v[78:79], v[4:5], v[254:255], v[78:79]
    s_waitcnt vmcnt(8)
    s_cmp_eq_u32 s78, 0
    s_cbranch_scc1 L_last5
L_last5:
    s_waitcnt vmcnt(0)
    v_lshlrev_b32 v2, 16, v176
    v_and_b32 v3, s70, v176
    v_pk_fma_f32 v[16:17], v[2:3], v[8:9], v[16:17]
    v_lshlrev_b32 v4, 16, v177
    v_and_b32 v5, s70, v177
    v_pk_fma_f32 v[18:19], v[4:5], v[10:11], v[18:19]
    v_lshlrev_b32 v2, 16, v178
    v_and_b32 v3, s70, v178
    v_pk_fma_f32 v[20:21], v[2:3], v[12:13], v[20:21]
    v_lshlrev_b32 v4, 16, v179
    v_and_b32 v5, s70, v179
    v_pk_fma_f32 v[22:23], v[4:5], v[14:15], v[22:23]
    v_lshlrev_b32 v2, 16, v180
    v_and_b32 v3, s70, v180
    v_pk_fma_f32 v[24:25], v[2:3], v[8:9], v[24:25]
    v_lshlrev_b32 v4, 16, v181
    v_and_b32 v5, s70, v181
    v_pk_fma_f32 v[26:27], v[4:5], v[10:11], v[26:27]
    v_lshlrev_b32 v2, 16, v182
    v_and_b32 v3, s70, v182
    v_pk_fma_f32 v[28:29], v[2:3], v[12:13], v[28:29]
    v_lshlrev_b32 v4, 16, v183
    v_and_b32 v5, s70, v183
    v_pk_fma_f32 v[30:31], v[4:5], v[14:15], v[30:31]
    v_lshlrev_b32 v2, 16, v184
    v_and_b32 v3, s70, v184
    v_pk_fma_f32 v[32:33], v[2:3], v[8:9], v[32:33]
    v_lshlrev_b32 v4, 16, v185
    v_and_b32 v5, s70, v185
    v_pk_fma_f32 v[34:35], v[4:5], v[10:11], v[34:35]
    v_lshlrev_b32 v2, 16, v186
    v_and_b32 v3, s70, v186
    v_pk_fma_f32 v[36:37], v[2:3], v[12:13], v[36:37]
    v_lshlrev_b32 v4, 16, v187
    v_and_b32 v5, s70, v187
    v_pk_fma_f32 v[38:39], v[4:5], v[14:15], v[38:39]
    v_lshlrev_b32 v2, 16, v188
    v_and_b32 v3, s70, v188
    v_pk_fma_f32 v[40:41], v[2:3], v[8:9], v[40:41]
    v_lshlrev_b32 v4, 16, v189
    v_and_b32 v5, s70, v189
    v_pk_fma_f32 v[42:43], v[4:5], v[10:11], v[42:43]
    v_lshlrev_b32 v2, 16, v190
    v_and_b32 v3, s70, v190
    v_pk_fma_f32 v[44:45], v[2:3], v[12:13], v[44:45]
    v_lshlrev_b32 v4, 16, v191
    v_and_b32 v5, s70, v191
    v_pk_fma_f32 v[46:47], v[4:5], v[14:15], v[46:47]
    v_lshlrev_b32 v2, 16, v192
    v_and_b32 v3, s70, v192
    v_pk_fma_f32 v[48:49], v[2:3], v[8:9], v[48:49]
    v_lshlrev_b32 v4, 16, v193
    v_and_b32 v5, s70, v193
    v_pk_fma_f32 v[50:51], v[4:5], v[10:11], v[50:51]
    v_lshlrev_b32 v2, 16, v194
    v_and_b32 v3, s70, v194
    v_pk_fma_f32 v[52:53], v[2:3], v[12:13], v[52:53]
    v_lshlrev_b32 v4, 16, v195
    v_and_b32 v5, s70, v195
    v_pk_fma_f32 v[54:55], v[4:5], v[14:15], v[54:55]
    v_lshlrev_b32 v2, 16, v196
    v_and_b32 v3, s70, v196
    v_pk_fma_f32 v[56:57], v[2:3], v[8:9], v[56:57]
    v_lshlrev_b32 v4, 16, v197
    v_and_b32 v5, s70, v197
    v_pk_fma_f32 v[58:59], v[4:5], v[10:11], v[58:59]
    v_lshlrev_b32 v2, 16, v198
    v_and_b32 v3, s70, v198
    v_pk_fma_f32 v[60:61], v[2:3], v[12:13], v[60:61]
    v_lshlrev_b32 v4, 16, v199
    v_and_b32 v5, s70, v199
    v_pk_fma_f32 v[62:63], v[4:5], v[14:15], v[62:63]
    v_lshlrev_b32 v2, 16, v200
    v_and_b32 v3, s70, v200
    v_pk_fma_f32 v[64:65], v[2:3], v[8:9], v[64:65]
    v_lshlrev_b32 v4, 16, v201
    v_and_b32 v5, s70, v201
    v_pk_fma_f32 v[66:67], v[4:5], v[10:11], v[66:67]
    v_lshlrev_b32 v2, 16, v202
    v_and_b32 v3, s70, v202
    v_pk_fma_f32 v[68:69], v[2:3], v[12:13], v[68:69]
    v_lshlrev_b32 v4, 16, v203
    v_and_b32 v5, s70, v203
    v_pk_fma_f32 v[70:71], v[4:5], v[14:15], v[70:71]
    v_lshlrev_b32 v2, 16, v204
    v_and_b32 v3, s70, v204
    v_pk_fma_f32 v[72:73], v[2:3], v[8:9], v[72:73]
    v_lshlrev_b32 v4, 16, v205
    v_and_b32 v5, s70, v205
    v_pk_fma_f32 v[74:75], v[4:5], v[10:11], v[74:75]
    v_lshlrev_b32 v2, 16, v206
    v_and_b32 v3, s70, v206
    v_pk_fma_f32 v[76:77], v[2:3], v[12:13], v[76:77]
    v_lshlrev_b32 v4, 16, v207
    v_and_b32 v5, s70, v207
    v_pk_fma_f32 v[78:79], v[4:5], v[14:15], v[78:79]
    s_nop 11
L_comb_done:
    s_mul_i32 s94, s71, 6144
    s_lshl_b32 s91, s71, 11
    s_add_u32 s38, s94, 98304
    v_add_u32 v10, s38, v6
    s_add_u32 s38, s91, 122880
    v_add_u32 v11, s38, v6
    v_cvt_pk_bf16_f32 v176, v16, v17
    v_cvt_pk_bf16_f32 v177, v18, v19
    v_cvt_pk_bf16_f32 v178, v20, v21
    v_cvt_pk_bf16_f32 v179, v22, v23
    ds_write_b128 v10, v[176:179] offset:0
    v_cvt_pk_bf16_f32 v180, v24, v25
    v_cvt_pk_bf16_f32 v181, v26, v27
    v_cvt_pk_bf16_f32 v182, v28, v29
    v_cvt_pk_bf16_f32 v183, v30, v31
    ds_write_b128 v10, v[180:183] offset:1024
    v_cvt_pk_bf16_f32 v184, v32, v33
    v_cvt_pk_bf16_f32 v185, v34, v35
    v_cvt_pk_bf16_f32 v186, v36, v37
    v_cvt_pk_bf16_f32 v187, v38, v39
    ds_write_b128 v10, v[184:187] offset:2048
    v_cvt_pk_bf16_f32 v188, v40, v41
    v_cvt_pk_bf16_f32 v189, v42, v43
    v_cvt_pk_bf16_f32 v190, v44, v45
    v_cvt_pk_bf16_f32 v191, v46, v47
    ds_write_b128 v10, v[188:191] offset:3072
    v_cvt_pk_bf16_f32 v192, v48, v49
    v_cvt_pk_bf16_f32 v193, v50, v51
    v_cvt_pk_bf16_f32 v194, v52, v53
    v_cvt_pk_bf16_f32 v195, v54, v55
    ds_write_b128 v10, v[192:195] offset:4096
    v_cvt_pk_bf16_f32 v196, v56, v57
    v_cvt_pk_bf16_f32 v197, v58, v59
    v_cvt_pk_bf16_f32 v198, v60, v61
    v_cvt_pk_bf16_f32 v199, v62, v63
    ds_write_b128 v10, v[196:199] offset:5120
    v_cvt_pk_bf16_f32 v200, v64, v65
    v_cvt_pk_bf16_f32 v201, v66, v67
    v_cvt_pk_bf16_f32 v202, v68, v69
    v_cvt_pk_bf16_f32 v203, v70, v71
    ds_write_b128 v11, v[200:203] offset:0
    v_cvt_pk_bf16_f32 v204, v72, v73
    v_cvt_pk_bf16_f32 v205, v74, v75
    v_cvt_pk_bf16_f32 v206, v76, v77
    v_cvt_pk_bf16_f32 v207, v78, v79
    ds_write_b128 v11, v[204:207] offset:1024
    v_mov_b32 v12, 135168
    v_mov_b32 v13, 1
    s_mov_b64 exec, 1
    ds_add_u32 v12, v13 offset:12
    s_mov_b64 exec, -1
    s_waitcnt lgkmcnt(0)
    s_add_u32 s71, s71, 1
    s_bitcmp1_b32 s71, 0
    s_cbranch_scc1 L_general
    s_nop 11
L_fetched:
    s_setprio 0
    s_cmp_lg_u64 s[74:75], 0
    s_cbranch_scc0 L_epi
    s_nop 11
L_corr:
    v_mov_b32 v12, 135168
L_spin56:
    ds_read_b32 v13, v12 offset:12
    s_waitcnt lgkmcnt(0)
    v_readfirstlane_b32 s38, v13
    s_nop 1
    s_cmp_ge_u32 s38, 4
    s_cbranch_scc1 L_spun57
    s_sleep 1
    s_branch L_spin56
L_spun57:
    v_lshlrev_b32 v6, 4, v7
    v_add_u32 v8, 98304, v6
    v_add_u32 v9, 122880, v6
    ds_read_b128 v[176:179], v8 offset:0
    ds_read_b128 v[180:183], v8 offset:1024
    ds_read_b128 v[184:187], v8 offset:6144
    ds_read_b128 v[188:191], v8 offset:7168
    ds_read_b128 v[192:195], v8 offset:12288
    ds_read_b128 v[196:199], v8 offset:13312
    ds_read_b128 v[200:203], v8 offset:18432
    ds_read_b128 v[204:207], v8 offset:19456
    ds_read_b128 v[208:211], v8 offset:2048
    ds_read_b128 v[212:215], v8 offset:3072
    ds_read_b128 v[216:219], v8 offset:8192
    ds_read_b128 v[220:223], v8 offset:9216
    ds_read_b128 v[224:227], v8 offset:14336
    s_waitcnt lgkmcnt(12)
    v_mfma_f32_16x16x32_bf16 v[80:83], v[176:179], v[144:147], v[80:83]
    v_mfma_f32_16x16x32_bf16 v[84:87], v[176:179], v[160:163], v[84:87]
    ds_read_b128 v[228:231], v8 offset:15360
    s_waitcnt lgkmcnt(12)
    v_mfma_f32_16x16x32_bf16 v[88:91], v[180:183], v[144:147], v[88:91]
    v_mfma_f32_16x16x32_bf16 v[92:95], v[180:183], v[160:163], v[92:95]
    ds_read_b128 v[232:235], v8 offset:20480
    s_waitcnt lgkmcnt(12)
    v_mfma_f32_16x16x32_bf16 v[80:83], v[184:187], v[148:151], v[80:83]
    v_mfma_f32_16x16x32_bf16 v[84:87], v[184:187], v[164:167], v[84:87]
    ds_read_b128 v[236:239], v8 offset:21504
    s_waitcnt lgkmcnt(12)
    v_mfma_f32_16x16x32_bf16 v[88:91], v[188:191], v[148:151], v[88:91]
    v_mfma_f32_16x16x32_bf16 v[92:95], v[188:191], v[164:167], v[92:95]
    ds_read_b128 v[176:179], v8 offset:4096
    s_waitcnt lgkmcnt(12)
    v_mfma_f32_16x16x32_bf16 v[80:83], v[192:195], v[152:155], v[80:83]
    v_mfma_f32_16x16x32_bf16 v[84:87], v[192:195], v[168:171], v[84:87]
    ds_read_b128 v[180:183], v8 offset:5120
    s_waitcnt lgkmcnt(12)
    v_mfma_f32_16x16x32_bf16 v[88:91], v[196:199], v[152:155], v[88:91]
    v_mfma_f32_16x16x32_bf16 v[92:95], v[196:199], v[168:171], v[92:95]
    ds_read_b128 v[184:187], v8 offset:10240
    s_waitcnt lgkmcnt(12)
    v_mfma_f32_16x16x32_bf16 v[80:83], v[200:203], v[156:159], v[80:83]
    v_mfma_f32_16x16x32_bf16 v[84:87], v[200:203], v[172:175], v[84:87]
    ds_read_b128 v[188:191], v8 offset:11264
    s_waitcnt lgkmcnt(12)
    v_mfma_f32_16x16x32_bf16 v[88:91], v[204:207], v[156:159], v[88:91]
    v_mfma_f32_16x16x32_bf16 v[92:95], v[204:207], v[172:175], v[92:95]
    ds_read_b128 v[192:195], v8 offset:16384
    s_waitcnt lgkmcnt(12)
    v_mfma_f32_16x16x32_bf16 v[96:99], v[208:211], v[144:147], v[96:99]
    v_mfma_f32_16x16x32_bf16 v[100:103], v[208:211], v[160:163], v[100:103]
    ds_read_b128 v[196:199], v8 offset:17408
    s_waitcnt lgkmcnt(12)
    v_mfma_f32_16x16x32_bf16 v[104:107], v[212:215], v[144:147], v[104:107]
    v_mfma_f32_16x16x32_bf16 v[108:111], v[212:215], v[160:163], v[108:111]
    ds_read_b128 v[200:203], v8 offset:22528
    s_waitcnt lgkmcnt(12)
    v_mfma_f32_16x16x32_bf16 v[96:99], v[216:219], v[148:151], v[96:99]
    v_mfma_f32_16x16x32_bf16 v[100:103], v[216:219], v[164:167], v[100:103]
    ds_read_b128 v[204:207], v8 offset:23552
    s_waitcnt lgkmcnt(12)
    v_mfma_f32_16x16x32_bf16 v[104:107], v[220:223], v[148:151], v[104:107]
    v_mfma_f32_16x16x32_bf16 v[108:111], v[220:223], v[164:167], v[108:111]
    ds_read_b128 v[208:211], v9 offset:0
    s_waitcnt lgkmcnt(12)
    v_mfma_f32_16x16x32_bf16 v[96:99], v[224:227], v[152:155], v[96:99]
    v_mfma_f32_16x16x32_bf16 v[100:103], v[224:227], v[168:171], v[100:103]
    ds_read_b128 v[212:215], v9 offset:1024
    s_waitcnt lgkmcnt(12)
    v_mfma_f32_16x16x32_bf16 v[104:107], v[228:231], v[152:155], v[104:107]
    v_mfma_f32_16x16x32_bf16 v[108:111], v[228:231], v[168:171], v[108:111]
    ds_read_b128 v[216:219], v9 offset:2048
    s_waitcnt lgkmcnt(12)
    v_mfma_f32_16x16x32_bf16 v[96:99], v[232:235], v[156:159], v[96:99]
    v_mfma_f32_16x16x32_bf16 v[100:103], v[232:235], v[172:175], v[100:103]
    ds_read_b128 v[220:223], v9 offset:3072
    s_waitcnt lgkmcnt(12)
    v_mfma_f32_16x16x32_bf16 v[104:107], v[236:239], v[156:159], v[104:107]
    v_mfma_f32_16x16x32_bf16 v[108:111], v[236:239], v[172:175], v[108:111]
    ds_read_b128 v[224:227], v9 offset:4096
    s_waitcnt lgkmcnt(12)
    v_mfma_f32_16x16x32_bf16 v[112:115], v[176:179], v[144:147], v[112:115]
    v_mfma_f32_16x16x32_bf16 v[116:119], v[176:179], v[160:163], v[116:119]
    ds_read_b128 v[228:231], v9 offset:5120
    s_waitcnt lgkmcnt(12)
    v_mfma_f32_16x16x32_bf16 v[120:123], v[180:183], v[144:147], v[120:123]
    v_mfma_f32_16x16x32_bf16 v[124:127], v[180:183], v[160:163], v[124:127]
    s_mov_b64 exec, s[56:57]
    v_cvt_pk_bf16_f32 v16, v80, v81
    v_cvt_pk_bf16_f32 v17, v82, v83
    v_cvt_pk_bf16_f32 v18, v88, v89
    v_cvt_pk_bf16_f32 v19, v90, v91
    v_cvt_pk_bf16_f32 v20, v84, v85
    v_cvt_pk_bf16_f32 v21, v86, v87
    v_cvt_pk_bf16_f32 v22, v92, v93
    v_cvt_pk_bf16_f32 v23, v94, v95
    v_cvt_pk_bf16_f32 v24, v96, v97
    v_cvt_pk_bf16_f32 v25, v98, v99
    v_cvt_pk_bf16_f32 v26, v104, v105
    v_cvt_pk_bf16_f32 v27, v106, v107
    v_cvt_pk_bf16_f32 v28, v100, v101
    v_cvt_pk_bf16_f32 v29, v102, v103
    v_cvt_pk_bf16_f32 v30, v108, v109
    v_cvt_pk_bf16_f32 v31, v110, v111
    s_mov_b64 exec, s[58:59]
    v_cvt_pk_bf16_f32 v16, v88, v89
    v_cvt_pk_bf16_f32 v17, v90, v91
    v_cvt_pk_bf16_f32 v18, v80, v81
    v_cvt_pk_bf16_f32 v19, v82, v83
    v_cvt_pk_bf16_f32 v20, v92, v93
    v_cvt_pk_bf16_f32 v21, v94, v95
    v_cvt_pk_bf16_f32 v22, v84, v85
    v_cvt_pk_bf16_f32 v23, v86, v87
    v_cvt_pk_bf16_f32 v24, v104, v105
    v_cvt_pk_bf16_f32 v25, v106, v107
    v_cvt_pk_bf16_f32 v26, v96, v97
    v_cvt_pk_bf16_f32 v27, v98, v99
    v_cvt_pk_bf16_f32 v28, v108, v109
    v_cvt_pk_bf16_f32 v29, v110, v111
    v_cvt_pk_bf16_f32 v30, v100, v101
    v_cvt_pk_bf16_f32 v31, v102, v103
    s_mov_b64 exec, -1
    buffer_store_dwordx4 v[16:19], v1, s[20:23], s36 offen offset:0 sc0 sc1 nt
    buffer_store_dwordx4 v[20:23], v1, s[20:23], s36 offen offset:256 sc0 sc1 nt
    buffer_store_dwordx4 v[24:27], v1, s[20:23], s36 offen offset:64 sc0 sc1 nt
    buffer_store_dwordx4 v[28:31], v1, s[20:23], s36 offen offset:320 sc0 sc1 nt
    ds_read_b128 v[232:235], v9 offset:6144
    s_waitcnt lgkmcnt(12)
    v_mfma_f32_16x16x32_bf16 v[112:115], v[184:187], v[148:151], v[112:115]
    v_mfma_f32_16x16x32_bf16 v[116:119], v[184:187], v[164:167], v[116:119]
    ds_read_b128 v[236:239], v9 offset:7168
    s_waitcnt lgkmcnt(12)
    v_mfma_f32_16x16x32_bf16 v[120:123], v[188:191], v[148:151], v[120:123]
    v_mfma_f32_16x16x32_bf16 v[124:127], v[188:191], v[164:167], v[124:127]
    s_waitcnt lgkmcnt(11)
    v_mfma_f32_16x16x32_bf16 v[112:115], v[192:195], v[152:155], v[112:115]
    v_mfma_f32_16x16x32_bf16 v[116:119], v[192:195], v[168:171], v[116:119]
    s_waitcnt lgkmcnt(10)
    v_mfma_f32_16x16x32_bf16 v[120:123], v[196:199], v[152:155], v[120:123]
    v_mfma_f32_16x16x32_bf16 v[124:127], v[196:199], v[168:171], v[124:127]
    s_waitcnt lgkmcnt(9)
    v_mfma_f32_16x16x32_bf16 v[112:115], v[200:203], v[156:159], v[112:115]
    v_mfma_f32_16x16x32_bf16 v[116:119], v[200:203], v[172:175], v[116:119]
    s_waitcnt lgkmcnt(8)
    v_mfma_f32_16x16x32_bf16 v[120:123], v[204:207], v[156:159], v[120:123]
    v_mfma_f32_16x16x32_bf16 v[124:127], v[204:207], v[172:175], v[124:127]
    s_waitcnt lgkmcnt(7)
    v_mfma_f32_16x16x32_bf16 v[128:131], v[208:211], v[144:147], v[128:131]
    v_mfma_f32_16x16x32_bf16 v[132:135], v[208:211], v[160:163], v[132:135]
    s_waitcnt lgkmcnt(6)
    v_mfma_f32_16x16x32_bf16 v[136:139], v[212:215], v[144:147], v[136:139]
    v_mfma_f32_16x16x32_bf16 v[140:143], v[212:215], v[160:163], v[140:143]
    s_waitcnt lgkmcnt(5)
    v_mfma_f32_16x16x32_bf16 v[128:131], v[216:219], v[148:151], v[128:131]
    v_mfma_f32_16x16x32_bf16 v[132:135], v[216:219], v[164:167], v[132:135]
    s_waitcnt lgkmcnt(4)
    v_mfma_f32_16x16x32_bf16 v[136:139], v[220:223], v[148:151], v[136:139]
    v_mfma_f32_16x16x32_bf16 v[140:143], v[220:223], v[164:167], v[140:143]
    s_waitcnt lgkmcnt(3)
    v_mfma_f32_16x16x32_bf16 v[128:131], v[224:227], v[152:155], v[128:131]
    v_mfma_f32_16x16x32_bf16 v[132:135], v[224:227], v[168:171], v[132:135]
    s_waitcnt lgkmcnt(2)
    v_mfma_f32_16x16x32_bf16 v[136:139], v[228:231], v[152:155], v[136:139]
    v_mfma_f32_16x16x32_bf16 v[140:143], v[228:231], v[168:171], v[140:143]
    s_waitcnt lgkmcnt(1)
    v_mfma_f32_16x16x32_bf16 v[128:131], v[232:235], v[156:159], v[128:131]
    v_mfma_f32_16x16x32_bf16 v[132:135], v[232:235], v[172:175], v[132:135]
    s_waitcnt lgkmcnt(0)
    v_mfma_f32_16x16x32_bf16 v[136:139], v[236:239], v[156:159], v[136:139]
    v_mfma_f32_16x16x32_bf16 v[140:143], v[236:239], v[172:175], v[140:143]
    s_mov_b64 exec, s[56:57]
    v_cvt_pk_bf16_f32 v32, v112, v113
    v_cvt_pk_bf16_f32 v33, v114, v115
    v_cvt_pk_bf16_f32 v34, v120, v121
    v_cvt_pk_bf16_f32 v35, v122, v123
    v_cvt_pk_bf16_f32 v36, v116, v117
    v_cvt_pk_bf16_f32 v37, v118, v119
    v_cvt_pk_bf16_f32 v38, v124, v125
    v_cvt_pk_bf16_f32 v39, v126, v127
    v_cvt_pk_bf16_f32 v40, v128, v129
    v_cvt_pk_bf16_f32 v41, v130, v131
    v_cvt_pk_bf16_f32 v42, v136, v137
    v_cvt_pk_bf16_f32 v43, v138, v139
    v_cvt_pk_bf16_f32 v44, v132, v133
    v_cvt_pk_bf16_f32 v45, v134, v135
    v_cvt_pk_bf16_f32 v46, v140, v141
    v_cvt_pk_bf16_f32 v47, v142, v143
    s_mov_b64 exec, s[58:59]
    v_cvt_pk_bf16_f32 v32, v120, v121
    v_cvt_pk_bf16_f32 v33, v122, v123
    v_cvt_pk_bf16_f32 v34, v112, v113
    v_cvt_pk_bf16_f32 v35, v114, v115
    v_cvt_pk_bf16_f32 v36, v124, v125
    v_cvt_pk_bf16_f32 v37, v126, v127
    v_cvt_pk_bf16_f32 v38, v116, v117
    v_cvt_pk_bf16_f32 v39, v118, v119
    v_cvt_pk_bf16_f32 v40, v136, v137
    v_cvt_pk_bf16_f32 v41, v138, v139
    v_cvt_pk_bf16_f32 v42, v128, v129
    v_cvt_pk_bf16_f32 v43, v130, v131
    v_cvt_pk_bf16_f32 v44, v140, v141
    v_cvt_pk_bf16_f32 v45, v142, v143
    v_cvt_pk_bf16_f32 v46, v132, v133
    v_cvt_pk_bf16_f32 v47, v134, v135
    s_mov_b64 exec, -1
    buffer_store_dwordx4 v[32:35], v1, s[20:23], s36 offen offset:128 sc0 sc1 nt
    buffer_store_dwordx4 v[36:39], v1, s[20:23], s36 offen offset:384 sc0 sc1 nt
    buffer_store_dwordx4 v[40:43], v1, s[20:23], s36 offen offset:192 sc0 sc1 nt
    buffer_store_dwordx4 v[44:47], v1, s[20:23], s36 offen offset:448 sc0 sc1 nt
    s_branch L_fin
    s_nop 11
L_epi:
    s_mov_b64 exec, s[56:57]
    v_cvt_pk_bf16_f32 v16, v80, v81
    v_cvt_pk_bf16_f32 v17, v82, v83
    v_cvt_pk_bf16_f32 v18, v88, v89
    v_cvt_pk_bf16_f32 v19, v90, v91
    v_cvt_pk_bf16_f32 v20, v84, v85
    v_cvt_pk_bf16_f32 v21, v86, v87
    v_cvt_pk_bf16_f32 v22, v92, v93
    v_cvt_pk_bf16_f32 v23, v94, v95
    v_cvt_pk_bf16_f32 v24, v96, v97
    v_cvt_pk_bf16_f32 v25, v98, v99
    v_cvt_pk_bf16_f32 v26, v104, v105
    v_cvt_pk_bf16_f32 v27, v106, v107
    v_cvt_pk_bf16_f32 v28, v100, v101
    v_cvt_pk_bf16_f32 v29, v102, v103
    v_cvt_pk_bf16_f32 v30, v108, v109
    v_cvt_pk_bf16_f32 v31, v110, v111
    v_cvt_pk_bf16_f32 v32, v112, v113
    v_cvt_pk_bf16_f32 v33, v114, v115
    v_cvt_pk_bf16_f32 v34, v120, v121
    v_cvt_pk_bf16_f32 v35, v122, v123
    v_cvt_pk_bf16_f32 v36, v116, v117
    v_cvt_pk_bf16_f32 v37, v118, v119
    v_cvt_pk_bf16_f32 v38, v124, v125
    v_cvt_pk_bf16_f32 v39, v126, v127
    v_cvt_pk_bf16_f32 v40, v128, v129
    v_cvt_pk_bf16_f32 v41, v130, v131
    v_cvt_pk_bf16_f32 v42, v136, v137
    v_cvt_pk_bf16_f32 v43, v138, v139
    v_cvt_pk_bf16_f32 v44, v132, v133
    v_cvt_pk_bf16_f32 v45, v134, v135
    v_cvt_pk_bf16_f32 v46, v140, v141
    v_cvt_pk_bf16_f32 v47, v142, v143
    s_mov_b64 exec, s[58:59]
    v_cvt_pk_bf16_f32 v16, v88, v89
    v_cvt_pk_bf16_f32 v17, v90, v91
    v_cvt_pk_bf16_f32 v18, v80, v81
    v_cvt_pk_bf16_f32 v19, v82, v83
    v_cvt_pk_bf16_f32 v20, v92, v93
    v_cvt_pk_bf16_f32 v21, v94, v95
    v_cvt_pk_bf16_f32 v22, v84, v85
    v_cvt_pk_bf16_f32 v23, v86, v87
    v_cvt_pk_bf16_f32 v24, v104, v105
    v_cvt_pk_bf16_f32 v25, v106, v107
    v_cvt_pk_bf16_f32 v26, v96, v97
    v_cvt_pk_bf16_f32 v27, v98, v99
    v_cvt_pk_bf16_f32 v28, v108, v109
    v_cvt_pk_bf16_f32 v29, v110, v111
    v_cvt_pk_bf16_f32 v30, v100, v101
    v_cvt_pk_bf16_f32 v31, v102, v103
    v_cvt_pk_bf16_f32 v32, v120, v121
    v_cvt_pk_bf16_f32 v33, v122, v123
    v_cvt_pk_bf16_f32 v34, v112, v113
    v_cvt_pk_bf16_f32 v35, v114, v115
    v_cvt_pk_bf16_f32 v36, v124, v125
    v_cvt_pk_bf16_f32 v37, v126, v127
    v_cvt_pk_bf16_f32 v38, v116, v117
    v_cvt_pk_bf16_f32 v39, v118, v119
    v_cvt_pk_bf16_f32 v40, v136, v137
    v_cvt_pk_bf16_f32 v41, v138, v139
    v_cvt_pk_bf16_f32 v42, v128, v129
    v_cvt_pk_bf16_f32 v43, v130, v131
    v_cvt_pk_bf16_f32 v44, v140, v141
    v_cvt_pk_bf16_f32 v45, v142, v143
    v_cvt_pk_bf16_f32 v46, v132, v133
    v_cvt_pk_bf16_f32 v47, v134, v135
    s_mov_b64 exec, -1
    buffer_store_dwordx4 v[16:19], v1, s[20:23], s36 offen offset:0 sc0 sc1 nt
    buffer_store_dwordx4 v[20:23], v1, s[20:23], s36 offen offset:256 sc0 sc1 nt
    buffer_store_dwordx4 v[24:27], v1, s[20:23], s36 offen offset:64 sc0 sc1 nt
    buffer_store_dwordx4 v[28:31], v1, s[20:23], s36 offen offset:320 sc0 sc1 nt
    buffer_store_dwordx4 v[32:35], v1, s[20:23], s36 offen offset:128 sc0 sc1 nt
    buffer_store_dwordx4 v[36:39], v1, s[20:23], s36 offen offset:384 sc0 sc1 nt
    buffer_store_dwordx4 v[40:43], v1, s[20:23], s36 offen offset:192 sc0 sc1 nt
    buffer_store_dwordx4 v[44:47], v1, s[20:23], s36 offen offset:448 sc0 sc1 nt
L_fin:
    s_nop 11
L_end:
    s_endpgm
    s_nop 11
L_slow:
    s_waitcnt vmcnt(0) lgkmcnt(0)
    buffer_load_dwordx4 v[240:243], v1, s[16:19], s36 offen offset:0
    buffer_load_dwordx4 v[248:251], v1, s[8:11], s36 offen offset:0
    buffer_load_dwordx4 v[244:247], v1, s[16:19], s36 offen offset:256
    buffer_load_dwordx4 v[252:255], v1, s[8:11], s36 offen offset:256
    s_waitcnt vmcnt(0)
    v_lshlrev_b32 v192, 16, v240
    v_and_b32 v193, s70, v240
    v_lshlrev_b32 v194, 16, v241
    v_and_b32 v195, s70, v241
    v_lshlrev_b32 v196, 16, v242
    v_and_b32 v197, s70, v242
    v_lshlrev_b32 v198, 16, v243
    v_and_b32 v199, s70, v243
    v_lshlrev_b32 v200, 16, v244
    v_and_b32 v201, s70, v244
    v_lshlrev_b32 v202, 16, v245
    v_and_b32 v203, s70, v245
    v_lshlrev_b32 v204, 16, v246
    v_and_b32 v205, s70, v246
    v_lshlrev_b32 v206, 16, v247
    v_and_b32 v207, s70, v247
    v_mul_f32 v192, s62, v192
    v_mul_f32 v193, s62, v193
    v_mul_f32 v194, s62, v194
    v_mul_f32 v195, s62, v195
    v_mul_f32 v196, s62, v196
    v_mul_f32 v197, s62, v197
    v_mul_f32 v198, s62, v198
    v_mul_f32 v199, s62, v199
    v_mul_f32 v200, s62, v200
    v_mul_f32 v201, s62, v201
    v_mul_f32 v202, s62, v202
    v_mul_f32 v203, s62, v203
    v_mul_f32 v204, s62, v204
    v_mul_f32 v205, s62, v205
    v_mul_f32 v206, s62, v206
    v_mul_f32 v207, s62, v207
    v_exp_f32 v192, v192
    v_exp_f32 v193, v193
    v_exp_f32 v194, v194
    v_exp_f32 v195, v195
    v_exp_f32 v196, v196
    v_exp_f32 v197, v197
    v_exp_f32 v198, v198
    v_exp_f32 v199, v199
    v_exp_f32 v200, v200
    v_exp_f32 v201, v201
    v_exp_f32 v202, v202
    v_exp_f32 v203, v203
    v_exp_f32 v204, v204
    v_exp_f32 v205, v205
    v_exp_f32 v206, v206
    v_exp_f32 v207, v207
    v_add_f32 v192, 1.0, v192
    v_add_f32 v193, 1.0, v193
    v_add_f32 v194, 1.0, v194
    v_add_f32 v195, 1.0, v195
    v_add_f32 v196, 1.0, v196
    v_add_f32 v197, 1.0, v197
    v_add_f32 v198, 1.0, v198
    v_add_f32 v199, 1.0, v199
    v_add_f32 v200, 1.0, v200
    v_add_f32 v201, 1.0, v201
    v_add_f32 v202, 1.0, v202
    v_add_f32 v203, 1.0, v203
    v_add_f32 v204, 1.0, v204
    v_add_f32 v205, 1.0, v205
    v_add_f32 v206, 1.0, v206
    v_add_f32 v207, 1.0, v207
    v_rcp_f32 v192, v192
    v_rcp_f32 v193, v193
    v_rcp_f32 v194, v194
    v_rcp_f32 v195, v195
    v_rcp_f32 v196, v196
    v_rcp_f32 v197, v197
    v_rcp_f32 v198, v198
    v_rcp_f32 v199, v199
    v_rcp_f32 v200, v200
    v_rcp_f32 v201, v201
    v_rcp_f32 v202, v202
    v_rcp_f32 v203, v203
    v_rcp_f32 v204, v204
    v_rcp_f32 v205, v205
    v_rcp_f32 v206, v206
    v_rcp_f32 v207, v207
    v_lshlrev_b32 v176, 16, v248
    v_and_b32 v177, s70, v248
    v_lshlrev_b32 v178, 16, v249
    v_and_b32 v179, s70, v249
    v_lshlrev_b32 v180, 16, v250
    v_and_b32 v181, s70, v250
    v_lshlrev_b32 v182, 16, v251
    v_and_b32 v183, s70, v251
    v_lshlrev_b32 v16, 16, v208
    v_and_b32 v17, s70, v208
    v_lshlrev_b32 v18, 16, v209
    v_and_b32 v19, s70, v209
    v_lshlrev_b32 v20, 16, v210
    v_and_b32 v21, s70, v210
    v_lshlrev_b32 v22, 16, v211
    v_and_b32 v23, s70, v211
    v_lshlrev_b32 v184, 16, v252
    v_and_b32 v185, s70, v252
    v_lshlrev_b32 v186, 16, v253
    v_and_b32 v187, s70, v253
    v_lshlrev_b32 v188, 16, v254
    v_and_b32 v189, s70, v254
    v_lshlrev_b32 v190, 16, v255
    v_and_b32 v191, s70, v255
    v_lshlrev_b32 v48, 16, v212
    v_and_b32 v49, s70, v212
    v_lshlrev_b32 v50, 16, v213
    v_and_b32 v51, s70, v213
    v_lshlrev_b32 v52, 16, v214
    v_and_b32 v53, s70, v214
    v_lshlrev_b32 v54, 16, v215
    v_and_b32 v55, s70, v215
    v_mul_f32 v176, s64, v176
    v_mul_f32 v177, s64, v177
    v_mul_f32 v178, s64, v178
    v_mul_f32 v179, s64, v179
    v_mul_f32 v180, s64, v180
    v_mul_f32 v181, s64, v181
    v_mul_f32 v182, s64, v182
    v_mul_f32 v183, s64, v183
    v_mul_f32 v184, s64, v184
    v_mul_f32 v185, s64, v185
    v_mul_f32 v186, s64, v186
    v_mul_f32 v187, s64, v187
    v_mul_f32 v188, s64, v188
    v_mul_f32 v189, s64, v189
    v_mul_f32 v190, s64, v190
    v_mul_f32 v191, s64, v191
    v_cvt_pk_bf16_f32 v240, v16, v17
    v_cvt_pk_bf16_f32 v248, v176, v177
    v_cvt_pk_bf16_f32 v241, v18, v19
    v_cvt_pk_bf16_f32 v249, v178, v179
    v_cvt_pk_bf16_f32 v242, v20, v21
    v_cvt_pk_bf16_f32 v250, v180, v181
    v_cvt_pk_bf16_f32 v243, v22, v23
    v_cvt_pk_bf16_f32 v251, v182, v183
    v_cvt_pk_bf16_f32 v244, v48, v49
    v_cvt_pk_bf16_f32 v252, v184, v185
    v_cvt_pk_bf16_f32 v245, v50, v51
    v_cvt_pk_bf16_f32 v253, v186, v187
    v_cvt_pk_bf16_f32 v246, v52, v53
    v_cvt_pk_bf16_f32 v254, v188, v189
    v_cvt_pk_bf16_f32 v247, v54, v55
    v_cvt_pk_bf16_f32 v255, v190, v191
    v_mfma_f32_16x16x32_bf16 v[80:83], v[248:251], v[240:243], 0
    s_nop 0
    v_mfma_f32_16x16x32_bf16 v[92:95], v[252:255], v[244:247], 0
    s_nop 3
    v_mul_f32 v16, v16, v192
    v_mul_f32 v48, v48, v200
    v_mul_f32 v17, v17, v193
    v_mul_f32 v49, v49, v201
    v_mul_f32 v18, v18, v194
    v_mul_f32 v50, v50, v202
    v_mul_f32 v19, v19, v195
    v_mul_f32 v51, v51, v203
    v_mul_f32 v20, v20, v196
    v_mul_f32 v52, v52, v204
    v_mul_f32 v21, v21, v197
    v_mul_f32 v53, v53, v205
    v_mul_f32 v22, v22, v198
    v_mul_f32 v54, v54, v206
    v_mul_f32 v23, v23, v199
    v_mul_f32 v55, v55, v207
    v_cvt_pk_bf16_f32 v240, v16, v17
    v_cvt_pk_bf16_f32 v248, v176, v177
    v_cvt_pk_bf16_f32 v241, v18, v19
    v_cvt_pk_bf16_f32 v249, v178, v179
    v_cvt_pk_bf16_f32 v242, v20, v21
    v_cvt_pk_bf16_f32 v250, v180, v181
    v_cvt_pk_bf16_f32 v243, v22, v23
    v_cvt_pk_bf16_f32 v251, v182, v183
    v_cvt_pk_bf16_f32 v244, v48, v49
    v_cvt_pk_bf16_f32 v252, v184, v185
    v_cvt_pk_bf16_f32 v245, v50, v51
    v_cvt_pk_bf16_f32 v253, v186, v187
    v_cvt_pk_bf16_f32 v246, v52, v53
    v_cvt_pk_bf16_f32 v254, v188, v189
    v_cvt_pk_bf16_f32 v247, v54, v55
    v_cvt_pk_bf16_f32 v255, v190, v191
    s_nop 0
    v_mfma_f32_16x16x32_bf16 v[100:103], v[248:251], v[244:247], 0
    s_nop 3
    v_mul_f32 v48, v48, v192
    v_mul_f32 v176, v176, v200
    v_mul_f32 v49, v49, v193
    v_mul_f32 v177, v177, v201
    v_mul_f32 v50, v50, v194
    v_mul_f32 v178, v178, v202
    v_mul_f32 v51, v51, v195
    v_mul_f32 v179, v179, v203
    v_mul_f32 v52, v52, v196
    v_mul_f32 v180, v180, v204
    v_mul_f32 v53, v53, v197
    v_mul_f32 v181, v181, v205
    v_mul_f32 v54, v54, v198
    v_mul_f32 v182, v182, v206
    v_mul_f32 v55, v55, v199
    v_mul_f32 v183, v183, v207
    v_mul_f32 v192, v192, v200
    v_mul_f32 v193, v193, v201
    v_mul_f32 v194, v194, v202
    v_mul_f32 v195, v195, v203
    v_mul_f32 v196, v196, v204
    v_mul_f32 v197, v197, v205
    v_mul_f32 v198, v198, v206
    v_mul_f32 v199, v199, v207
    v_cvt_pk_bf16_f32 v240, v16, v17
    v_cvt_pk_bf16_f32 v248, v176, v177
    v_cvt_pk_bf16_f32 v241, v18, v19
    v_cvt_pk_bf16_f32 v249, v178, v179
    v_cvt_pk_bf16_f32 v242, v20, v21
    v_cvt_pk_bf16_f32 v250, v180, v181
    v_cvt_pk_bf16_f32 v243, v22, v23
    v_cvt_pk_bf16_f32 v251, v182, v183
    v_cvt_pk_bf16_f32 v244, v48, v49
    v_cvt_pk_bf16_f32 v252, v184, v185
    v_cvt_pk_bf16_f32 v245, v50, v51
    v_cvt_pk_bf16_f32 v253, v186, v187
    v_cvt_pk_bf16_f32 v246, v52, v53
    v_cvt_pk_bf16_f32 v254, v188, v189
    v_cvt_pk_bf16_f32 v247, v54, v55
    v_cvt_pk_bf16_f32 v255, v190, v191
    v_mfma_f32_16x16x32_bf16 v[112:115], v[248:251], v[240:243], 0
    v_mfma_f32_16x16x32_bf16 v[116:119], v[248:251], v[244:247], 0
    v_mfma_f32_16x16x32_bf16 v[120:123], v[252:255], v[240:243], 0
    v_mfma_f32_16x16x32_bf16 v[124:127], v[252:255], v[244:247], 0
    s_nop 3
    v_mov_b32_dpp v200, v192 quad_perm:[1,0,3,2] row_mask:0xf bank_mask:0xf
    v_mov_b32_dpp v201, v193 quad_perm:[1,0,3,2] row_mask:0xf bank_mask:0xf
    v_mov_b32_dpp v202, v194 quad_perm:[1,0,3,2] row_mask:0xf bank_mask:0xf
    v_mov_b32_dpp v203, v195 quad_perm:[1,0,3,2] row_mask:0xf bank_mask:0xf
    v_mov_b32_dpp v204, v196 quad_perm:[1,0,3,2] row_mask:0xf bank_mask:0xf
    v_mov_b32_dpp v205, v197 quad_perm:[1,0,3,2] row_mask:0xf bank_mask:0xf
    v_mov_b32_dpp v206, v198 quad_perm:[1,0,3,2] row_mask:0xf bank_mask:0xf
    v_mov_b32_dpp v207, v199 quad_perm:[1,0,3,2] row_mask:0xf bank_mask:0xf
    s_mov_b32 exec_lo, 0xaaaaaaaa
    s_mov_b32 exec_hi, 0xaaaaaaaa
    v_mul_f32 v16, v16, v200
    v_mul_f32 v17, v17, v201
    v_mul_f32 v18, v18, v202
    v_mul_f32 v19, v19, v203
    v_mul_f32 v20, v20, v204
    v_mul_f32 v21, v21, v205
    v_mul_f32 v22, v22, v206
    v_mul_f32 v23, v23, v207
    v_mul_f32 v48, v48, v200
    v_mul_f32 v49, v49, v201
    v_mul_f32 v50, v50, v202
    v_mul_f32 v51, v51, v203
    v_mul_f32 v52, v52, v204
    v_mul_f32 v53, v53, v205
    v_mul_f32 v54, v54, v206
    v_mul_f32 v55, v55, v207
    s_mov_b32 exec_lo, 0x55555555
    s_mov_b32 exec_hi, 0x55555555
    v_mul_f32 v176, v176, v200
    v_mul_f32 v177, v177, v201
    v_mul_f32 v178, v178, v202
    v_mul_f32 v179, v179, v203
    v_mul_f32 v180, v180, v204
    v_mul_f32 v181, v181, v205
    v_mul_f32 v182, v182, v206
    v_mul_f32 v183, v183, v207
    v_mul_f32 v184, v184, v200
    v_mul_f32 v185, v185, v201
    v_mul_f32 v186, v186, v202
    v_mul_f32 v187, v187, v203
    v_mul_f32 v188, v188, v204
    v_mul_f32 v189, v189, v205
    v_mul_f32 v190, v190, v206
    v_mul_f32 v191, v191, v207
    s_mov_b64 exec, -1
    v_mul_f32 v192, v192, v200
    v_mul_f32 v193, v193, v201
    v_mul_f32 v194, v194, v202
    v_mul_f32 v195, v195, v203
    v_mul_f32 v196, v196, v204
    v_mul_f32 v197, v197, v205
    v_mul_f32 v198, v198, v206
    v_mul_f32 v199, v199, v207
    v_cvt_pk_bf16_f32 v240, v16, v17
    v_cvt_pk_bf16_f32 v248, v176, v177
    v_cvt_pk_bf16_f32 v241, v18, v19
    v_cvt_pk_bf16_f32 v249, v178, v179
    v_cvt_pk_bf16_f32 v242, v20, v21
    v_cvt_pk_bf16_f32 v250, v180, v181
    v_cvt_pk_bf16_f32 v243, v22, v23
    v_cvt_pk_bf16_f32 v251, v182, v183
    v_cvt_pk_bf16_f32 v244, v48, v49
    v_cvt_pk_bf16_f32 v252, v184, v185
    v_cvt_pk_bf16_f32 v245, v50, v51
    v_cvt_pk_bf16_f32 v253, v186, v187
    v_cvt_pk_bf16_f32 v246, v52, v53
    v_cvt_pk_bf16_f32 v254, v188, v189
    v_cvt_pk_bf16_f32 v247, v54, v55
    v_cvt_pk_bf16_f32 v255, v190, v191
    v_mfma_f32_16x16x32_bf16 v[128:131], v[248:251], v[240:243], 0
    v_mfma_f32_16x16x32_bf16 v[132:135], v[248:251], v[244:247], 0
    v_mfma_f32_16x16x32_bf16 v[136:139], v[252:255], v[240:243], 0
    v_mfma_f32_16x16x32_bf16 v[140:143], v[252:255], v[244:247], 0
    s_nop 3
    v_mov_b32_dpp v200, v192 quad_perm:[2,3,0,1] row_mask:0xf bank_mask:0xf
    v_mov_b32_dpp v201, v193 quad_perm:[2,3,0,1] row_mask:0xf bank_mask:0xf
    v_mov_b32_dpp v202, v194 quad_perm:[2,3,0,1] row_mask:0xf bank_mask:0xf
    v_mov_b32_dpp v203, v195 quad_perm:[2,3,0,1] row_mask:0xf bank_mask:0xf
    v_mov_b32_dpp v204, v196 quad_perm:[2,3,0,1] row_mask:0xf bank_mask:0xf
    v_mov_b32_dpp v205, v197 quad_perm:[2,3,0,1] row_mask:0xf bank_mask:0xf
    v_mov_b32_dpp v206, v198 quad_perm:[2,3,0,1] row_mask:0xf bank_mask:0xf
    v_mov_b32_dpp v207, v199 quad_perm:[2,3,0,1] row_mask:0xf bank_mask:0xf
    s_mov_b32 exec_lo, 0xcccccccc
    s_mov_b32 exec_hi, 0xcccccccc
    v_mul_f32 v16, v16, v200
    v_mul_f32 v17, v17, v201
    v_mul_f32 v18, v18, v202
    v_mul_f32 v19, v19, v203
    v_mul_f32 v20, v20, v204
    v_mul_f32 v21, v21, v205
    v_mul_f32 v22, v22, v206
    v_mul_f32 v23, v23, v207
    v_mul_f32 v48, v48, v200
    v_mul_f32 v49, v49, v201
    v_mul_f32 v50, v50, v202
    v_mul_f32 v51, v51, v203
    v_mul_f32 v52, v52, v204
    v_mul_f32 v53, v53, v205
    v_mul_f32 v54, v54, v206
    v_mul_f32 v55, v55, v207
    s_mov_b32 exec_lo, 0x33333333
    s_mov_b32 exec_hi, 0x33333333
    v_mul_f32 v176, v176, v200
    v_mul_f32 v177, v177, v201
    v_mul_f32 v178, v178, v202
    v_mul_f32 v179, v179, v203
    v_mul_f32 v180, v180, v204
    v_mul_f32 v181, v181, v205
    v_mul_f32 v182, v182, v206
    v_mul_f32 v183, v183, v207
    v_mul_f32 v184, v184, v200
    v_mul_f32 v185, v185, v201
    v_mul_f32 v186, v186, v202
    v_mul_f32 v187, v187, v203
    v_mul_f32 v188, v188, v204
    v_mul_f32 v189, v189, v205
    v_mul_f32 v190, v190, v206
    v_mul_f32 v191, v191, v207
    s_mov_b64 exec, -1
    v_mul_f32 v192, v192, v200
    v_mul_f32 v193, v193, v201
    v_mul_f32 v194, v194, v202
    v_mul_f32 v195, v195, v203
    v_mul_f32 v196, v196, v204
    v_mul_f32 v197, v197, v205
    v_mul_f32 v198, v198, v206
    v_mul_f32 v199, v199, v207
    v_cvt_pk_bf16_f32 v240, v16, v17
    v_cvt_pk_bf16_f32 v248, v176, v177
    v_cvt_pk_bf16_f32 v241, v18, v19
    v_cvt_pk_bf16_f32 v249, v178, v179
    v_cvt_pk_bf16_f32 v242, v20, v21
    v_cvt_pk_bf16_f32 v250, v180, v181
    v_cvt_pk_bf16_f32 v243, v22, v23
    v_cvt_pk_bf16_f32 v251, v182, v183
    v_cvt_pk_bf16_f32 v244, v48, v49
    v_cvt_pk_bf16_f32 v252, v184, v185
    v_cvt_pk_bf16_f32 v245, v50, v51
    v_cvt_pk_bf16_f32 v253, v186, v187
    v_cvt_pk_bf16_f32 v246, v52, v53
    v_cvt_pk_bf16_f32 v254, v188, v189
    v_cvt_pk_bf16_f32 v247, v54, v55
    v_cvt_pk_bf16_f32 v255, v190, v191
    v_mfma_f32_16x16x32_bf16 v[144:147], v[248:251], v[240:243], 0
    v_mfma_f32_16x16x32_bf16 v[148:151], v[248:251], v[244:247], 0
    v_mfma_f32_16x16x32_bf16 v[152:155], v[252:255], v[240:243], 0
    v_mfma_f32_16x16x32_bf16 v[156:159], v[252:255], v[244:247], 0
    s_nop 3
    v_mov_b32_dpp v200, v192 row_half_mirror row_mask:0xf bank_mask:0xf
    v_mov_b32_dpp v201, v193 row_half_mirror row_mask:0xf bank_mask:0xf
    v_mov_b32_dpp v202, v194 row_half_mirror row_mask:0xf bank_mask:0xf
    v_mov_b32_dpp v203, v195 row_half_mirror row_mask:0xf bank_mask:0xf
    v_mov_b32_dpp v204, v196 row_half_mirror row_mask:0xf bank_mask:0xf
    v_mov_b32_dpp v205, v197 row_half_mirror row_mask:0xf bank_mask:0xf
    v_mov_b32_dpp v206, v198 row_half_mirror row_mask:0xf bank_mask:0xf
    v_mov_b32_dpp v207, v199 row_half_mirror row_mask:0xf bank_mask:0xf
    s_mov_b32 exec_lo, 0xf0f0f0f0
    s_mov_b32 exec_hi, 0xf0f0f0f0
    v_mul_f32 v16, v16, v200
    v_mul_f32 v17, v17, v201
    v_mul_f32 v18, v18, v202
    v_mul_f32 v19, v19, v203
    v_mul_f32 v20, v20, v204
    v_mul_f32 v21, v21, v205
    v_mul_f32 v22, v22, v206
    v_mul_f32 v23, v23, v207
    v_mul_f32 v48, v48, v200
    v_mul_f32 v49, v49, v201
    v_mul_f32 v50, v50, v202
    v_mul_f32 v51, v51, v203
    v_mul_f32 v52, v52, v204
    v_mul_f32 v53, v53, v205
    v_mul_f32 v54, v54, v206
    v_mul_f32 v55, v55, v207
    s_mov_b32 exec_lo, 0xf0f0f0f
    s_mov_b32 exec_hi, 0xf0f0f0f
    v_mul_f32 v176, v176, v200
    v_mul_f32 v177, v177, v201
    v_mul_f32 v178, v178, v202
    v_mul_f32 v179, v179, v203
    v_mul_f32 v180, v180, v204
    v_mul_f32 v181, v181, v205
    v_mul_f32 v182, v182, v206
    v_mul_f32 v183, v183, v207
    v_mul_f32 v184, v184, v200
    v_mul_f32 v185, v185, v201
    v_mul_f32 v186, v186, v202
    v_mul_f32 v187, v187, v203
    v_mul_f32 v188, v188, v204
    v_mul_f32 v189, v189, v205
    v_mul_f32 v190, v190, v206
    v_mul_f32 v191, v191, v207
    s_mov_b64 exec, -1
    v_mul_f32 v192, v192, v200
    v_mul_f32 v193, v193, v201
    v_mul_f32 v194, v194, v202
    v_mul_f32 v195, v195, v203
    v_mul_f32 v196, v196, v204
    v_mul_f32 v197, v197, v205
    v_mul_f32 v198, v198, v206
    v_mul_f32 v199, v199, v207
    v_cvt_pk_bf16_f32 v240, v16, v17
    v_cvt_pk_bf16_f32 v248, v176, v177
    v_cvt_pk_bf16_f32 v241, v18, v19
    v_cvt_pk_bf16_f32 v249, v178, v179
    v_cvt_pk_bf16_f32 v242, v20, v21
    v_cvt_pk_bf16_f32 v250, v180, v181
    v_cvt_pk_bf16_f32 v243, v22, v23
    v_cvt_pk_bf16_f32 v251, v182, v183
    v_cvt_pk_bf16_f32 v244, v48, v49
    v_cvt_pk_bf16_f32 v252, v184, v185
    v_cvt_pk_bf16_f32 v245, v50, v51
    v_cvt_pk_bf16_f32 v253, v186, v187
    v_cvt_pk_bf16_f32 v246, v52, v53
    v_cvt_pk_bf16_f32 v254, v188, v189
    v_cvt_pk_bf16_f32 v247, v54, v55
    v_cvt_pk_bf16_f32 v255, v190, v191
    v_mfma_f32_16x16x32_bf16 v[160:163], v[248:251], v[240:243], 0
    v_mfma_f32_16x16x32_bf16 v[164:167], v[248:251], v[244:247], 0
    v_mfma_f32_16x16x32_bf16 v[168:171], v[252:255], v[240:243], 0
    v_mfma_f32_16x16x32_bf16 v[172:175], v[252:255], v[244:247], 0
    s_nop 3
    v_mov_b32_dpp v200, v192 row_mirror row_mask:0xf bank_mask:0xf
    v_mov_b32_dpp v201, v193 row_mirror row_mask:0xf bank_mask:0xf
    v_mov_b32_dpp v202, v194 row_mirror row_mask:0xf bank_mask:0xf
    v_mov_b32_dpp v203, v195 row_mirror row_mask:0xf bank_mask:0xf
    v_mov_b32_dpp v204, v196 row_mirror row_mask:0xf bank_mask:0xf
    v_mov_b32_dpp v205, v197 row_mirror row_mask:0xf bank_mask:0xf
    v_mov_b32_dpp v206, v198 row_mirror row_mask:0xf bank_mask:0xf
    v_mov_b32_dpp v207, v199 row_mirror row_mask:0xf bank_mask:0xf
    s_mov_b32 exec_lo, 0xff00ff00
    s_mov_b32 exec_hi, 0xff00ff00
    v_mul_f32 v16, v16, v200
    v_mul_f32 v17, v17, v201
    v_mul_f32 v18, v18, v202
    v_mul_f32 v19, v19, v203
    v_mul_f32 v20, v20, v204
    v_mul_f32 v21, v21, v205
    v_mul_f32 v22, v22, v206
    v_mul_f32 v23, v23, v207
    v_mul_f32 v48, v48, v200
    v_mul_f32 v49, v49, v201
    v_mul_f32 v50, v50, v202
    v_mul_f32 v51, v51, v203
    v_mul_f32 v52, v52, v204
    v_mul_f32 v53, v53, v205
    v_mul_f32 v54, v54, v206
    v_mul_f32 v55, v55, v207
    s_mov_b64 exec, -1
    buffer_load_dwordx4 v[240:243], v1, s[16:19], s36 offen offset:64
    buffer_load_dwordx4 v[248:251], v1, s[8:11], s36 offen offset:64
    buffer_load_dwordx4 v[244:247], v1, s[16:19], s36 offen offset:320
    buffer_load_dwordx4 v[252:255], v1, s[8:11], s36 offen offset:320
    s_waitcnt vmcnt(0)
    v_lshlrev_b32 v192, 16, v240
    v_and_b32 v193, s70, v240
    v_lshlrev_b32 v194, 16, v241
    v_and_b32 v195, s70, v241
    v_lshlrev_b32 v196, 16, v242
    v_and_b32 v197, s70, v242
    v_lshlrev_b32 v198, 16, v243
    v_and_b32 v199, s70, v243
    v_lshlrev_b32 v200, 16, v244
    v_and_b32 v201, s70, v244
    v_lshlrev_b32 v202, 16, v245
    v_and_b32 v203, s70, v245
    v_lshlrev_b32 v204, 16, v246
    v_and_b32 v205, s70, v246
    v_lshlrev_b32 v206, 16, v247
    v_and_b32 v207, s70, v247
    v_mul_f32 v192, s62, v192
    v_mul_f32 v193, s62, v193
    v_mul_f32 v194, s62, v194
    v_mul_f32 v195, s62, v195
    v_mul_f32 v196, s62, v196
    v_mul_f32 v197, s62, v197
    v_mul_f32 v198, s62, v198
    v_mul_f32 v199, s62, v199
    v_mul_f32 v200, s62, v200
    v_mul_f32 v201, s62, v201
    v_mul_f32 v202, s62, v202
    v_mul_f32 v203, s62, v203
    v_mul_f32 v204, s62, v204
    v_mul_f32 v205, s62, v205
    v_mul_f32 v206, s62, v206
    v_mul_f32 v207, s62, v207
    v_exp_f32 v192, v192
    v_exp_f32 v193, v193
    v_exp_f32 v194, v194
    v_exp_f32 v195, v195
    v_exp_f32 v196, v196
    v_exp_f32 v197, v197
    v_exp_f32 v198, v198
    v_exp_f32 v199, v199
    v_exp_f32 v200, v200
    v_exp_f32 v201, v201
    v_exp_f32 v202, v202
    v_exp_f32 v203, v203
    v_exp_f32 v204, v204
    v_exp_f32 v205, v205
    v_exp_f32 v206, v206
    v_exp_f32 v207, v207
    v_add_f32 v192, 1.0, v192
    v_add_f32 v193, 1.0, v193
    v_add_f32 v194, 1.0, v194
    v_add_f32 v195, 1.0, v195
    v_add_f32 v196, 1.0, v196
    v_add_f32 v197, 1.0, v197
    v_add_f32 v198, 1.0, v198
    v_add_f32 v199, 1.0, v199
    v_add_f32 v200, 1.0, v200
    v_add_f32 v201, 1.0, v201
    v_add_f32 v202, 1.0, v202
    v_add_f32 v203, 1.0, v203
    v_add_f32 v204, 1.0, v204
    v_add_f32 v205, 1.0, v205
    v_add_f32 v206, 1.0, v206
    v_add_f32 v207, 1.0, v207
    v_rcp_f32 v192, v192
    v_rcp_f32 v193, v193
    v_rcp_f32 v194, v194
    v_rcp_f32 v195, v195
    v_rcp_f32 v196, v196
    v_rcp_f32 v197, v197
    v_rcp_f32 v198, v198
    v_rcp_f32 v199, v199
    v_rcp_f32 v200, v200
    v_rcp_f32 v201, v201
    v_rcp_f32 v202, v202
    v_rcp_f32 v203, v203
    v_rcp_f32 v204, v204
    v_rcp_f32 v205, v205
    v_rcp_f32 v206, v206
    v_rcp_f32 v207, v207
    v_lshlrev_b32 v176, 16, v248
    v_and_b32 v177, s70, v248
    v_lshlrev_b32 v178, 16, v249
    v_and_b32 v179, s70, v249
    v_lshlrev_b32 v180, 16, v250
    v_and_b32 v181, s70, v250
    v_lshlrev_b32 v182, 16, v251
    v_and_b32 v183, s70, v251
    v_lshlrev_b32 v24, 16, v216
    v_and_b32 v25, s70, v216
    v_lshlrev_b32 v26, 16, v217
    v_and_b32 v27, s70, v217
    v_lshlrev_b32 v28, 16, v218
    v_and_b32 v29, s70, v218
    v_lshlrev_b32 v30, 16, v219
    v_and_b32 v31, s70, v219
    v_lshlrev_b32 v184, 16, v252
    v_and_b32 v185, s70, v252
    v_lshlrev_b32 v186, 16, v253
    v_and_b32 v187, s70, v253
    v_lshlrev_b32 v188, 16, v254
    v_and_b32 v189, s70, v254
    v_lshlrev_b32 v190, 16, v255
    v_and_b32 v191, s70, v255
    v_lshlrev_b32 v56, 16, v220
    v_and_b32 v57, s70, v220
    v_lshlrev_b32 v58, 16, v221
    v_and_b32 v59, s70, v221
    v_lshlrev_b32 v60, 16, v222
    v_and_b32 v61, s70, v222
    v_lshlrev_b32 v62, 16, v223
    v_and_b32 v63, s70, v223
    v_mul_f32 v176, s64, v176
    v_mul_f32 v177, s64, v177
    v_mul_f32 v178, s64, v178
    v_mul_f32 v179, s64, v179
    v_mul_f32 v180, s64, v180
    v_mul_f32 v181, s64, v181
    v_mul_f32 v182, s64, v182
    v_mul_f32 v183, s64, v183
    v_mul_f32 v184, s64, v184
    v_mul_f32 v185, s64, v185
    v_mul_f32 v186, s64, v186
    v_mul_f32 v187, s64, v187
    v_mul_f32 v188, s64, v188
    v_mul_f32 v189, s64, v189
    v_mul_f32 v190, s64, v190
    v_mul_f32 v191, s64, v191
    v_cvt_pk_bf16_f32 v240, v24, v25
    v_cvt_pk_bf16_f32 v248, v176, v177
    v_cvt_pk_bf16_f32 v241, v26, v27
    v_cvt_pk_bf16_f32 v249, v178, v179
    v_cvt_pk_bf16_f32 v242, v28, v29
    v_cvt_pk_bf16_f32 v250, v180, v181
    v_cvt_pk_bf16_f32 v243, v30, v31
    v_cvt_pk_bf16_f32 v251, v182, v183
    v_cvt_pk_bf16_f32 v244, v56, v57
    v_cvt_pk_bf16_f32 v252, v184, v185
    v_cvt_pk_bf16_f32 v245, v58, v59
    v_cvt_pk_bf16_f32 v253, v186, v187
    v_cvt_pk_bf16_f32 v246, v60, v61
    v_cvt_pk_bf16_f32 v254, v188, v189
    v_cvt_pk_bf16_f32 v247, v62, v63
    v_cvt_pk_bf16_f32 v255, v190, v191
    v_mfma_f32_16x16x32_bf16 v[80:83], v[248:251], v[240:243], v[80:83]
    s_nop 0
    v_mfma_f32_16x16x32_bf16 v[92:95], v[252:255], v[244:247], v[92:95]
    s_nop 3
    v_mul_f32 v24, v24, v192
    v_mul_f32 v56, v56, v200
    v_mul_f32 v25, v25, v193
    v_mul_f32 v57, v57, v201
    v_mul_f32 v26, v26, v194
    v_mul_f32 v58, v58, v202
    v_mul_f32 v27, v27, v195
    v_mul_f32 v59, v59, v203
    v_mul_f32 v28, v28, v196
    v_mul_f32 v60, v60, v204
    v_mul_f32 v29, v29, v197
    v_mul_f32 v61, v61, v205
    v_mul_f32 v30, v30, v198
    v_mul_f32 v62, v62, v206
    v_mul_f32 v31, v31, v199
    v_mul_f32 v63, v63, v207
    v_cvt_pk_bf16_f32 v240, v24, v25
    v_cvt_pk_bf16_f32 v248, v176, v177
    v_cvt_pk_bf16_f32 v241, v26, v27
    v_cvt_pk_bf16_f32 v249, v178, v179
    v_cvt_pk_bf16_f32 v242, v28, v29
    v_cvt_pk_bf16_f32 v250, v180, v181
    v_cvt_pk_bf16_f32 v243, v30, v31
    v_cvt_pk_bf16_f32 v251, v182, v183
    v_cvt_pk_bf16_f32 v244, v56, v57
    v_cvt_pk_bf16_f32 v252, v184, v185
    v_cvt_pk_bf16_f32 v245, v58, v59
    v_cvt_pk_bf16_f32 v253, v186, v187
    v_cvt_pk_bf16_f32 v246, v60, v61
    v_cvt_pk_bf16_f32 v254, v188, v189
    v_cvt_pk_bf16_f32 v247, v62, v63
    v_cvt_pk_bf16_f32 v255, v190, v191
    s_nop 0
    v_mfma_f32_16x16x32_bf16 v[100:103], v[248:251], v[244:247], v[100:103]
    s_nop 3
    v_mul_f32 v56, v56, v192
    v_mul_f32 v176, v176, v200
    v_mul_f32 v57, v57, v193
    v_mul_f32 v177, v177, v201
    v_mul_f32 v58, v58, v194
    v_mul_f32 v178, v178, v202
    v_mul_f32 v59, v59, v195
    v_mul_f32 v179, v179, v203
    v_mul_f32 v60, v60, v196
    v_mul_f32 v180, v180, v204
    v_mul_f32 v61, v61, v197
    v_mul_f32 v181, v181, v205
    v_mul_f32 v62, v62, v198
    v_mul_f32 v182, v182, v206
    v_mul_f32 v63, v63, v199
    v_mul_f32 v183, v183, v207
    v_mul_f32 v192, v192, v200
    v_mul_f32 v193, v193, v201
    v_mul_f32 v194, v194, v202
    v_mul_f32 v195, v195, v203
    v_mul_f32 v196, v196, v204
    v_mul_f32 v197, v197, v205
    v_mul_f32 v198, v198, v206
    v_mul_f32 v199, v199, v207
    v_cvt_pk_bf16_f32 v240, v24, v25
    v_cvt_pk_bf16_f32 v248, v176, v177
    v_cvt_pk_bf16_f32 v241, v26, v27
    v_cvt_pk_bf16_f32 v249, v178, v179
    v_cvt_pk_bf16_f32 v242, v28, v29
    v_cvt_pk_bf16_f32 v250, v180, v181
    v_cvt_pk_bf16_f32 v243, v30, v31
    v_cvt_pk_bf16_f32 v251, v182, v183
    v_cvt_pk_bf16_f32 v244, v56, v57
    v_cvt_pk_bf16_f32 v252, v184, v185
    v_cvt_pk_bf16_f32 v245, v58, v59
    v_cvt_pk_bf16_f32 v253, v186, v187
    v_cvt_pk_bf16_f32 v246, v60, v61
    v_cvt_pk_bf16_f32 v254, v188, v189
    v_cvt_pk_bf16_f32 v247, v62, v63
    v_cvt_pk_bf16_f32 v255, v190, v191
    v_mfma_f32_16x16x32_bf16 v[112:115], v[248:251], v[240:243], v[112:115]
    v_mfma_f32_16x16x32_bf16 v[116:119], v[248:251], v[244:247], v[116:119]
    v_mfma_f32_16x16x32_bf16 v[120:123], v[252:255], v[240:243], v[120:123]
    v_mfma_f32_16x16x32_bf16 v[124:127], v[252:255], v[244:247], v[124:127]
    s_nop 3
    v_mov_b32_dpp v200, v192 quad_perm:[1,0,3,2] row_mask:0xf bank_mask:0xf
    v_mov_b32_dpp v201, v193 quad_perm:[1,0,3,2] row_mask:0xf bank_mask:0xf
    v_mov_b32_dpp v202, v194 quad_perm:[1,0,3,2] row_mask:0xf bank_mask:0xf
    v_mov_b32_dpp v203, v195 quad_perm:[1,0,3,2] row_mask:0xf bank_mask:0xf
    v_mov_b32_dpp v204, v196 quad_perm:[1,0,3,2] row_mask:0xf bank_mask:0xf
    v_mov_b32_dpp v205, v197 quad_perm:[1,0,3,2] row_mask:0xf bank_mask:0xf
    v_mov_b32_dpp v206, v198 quad_perm:[1,0,3,2] row_mask:0xf bank_mask:0xf
    v_mov_b32_dpp v207, v199 quad_perm:[1,0,3,2] row_mask:0xf bank_mask:0xf
    s_mov_b32 exec_lo, 0xaaaaaaaa
    s_mov_b32 exec_hi, 0xaaaaaaaa
    v_mul_f32 v24, v24, v200
    v_mul_f32 v25, v25, v201
    v_mul_f32 v26, v26, v202
    v_mul_f32 v27, v27, v203
    v_mul_f32 v28, v28, v204
    v_mul_f32 v29, v29, v205
    v_mul_f32 v30, v30, v206
    v_mul_f32 v31, v31, v207
    v_mul_f32 v56, v56, v200
    v_mul_f32 v57, v57, v201
    v_mul_f32 v58, v58, v202
    v_mul_f32 v59, v59, v203
    v_mul_f32 v60, v60, v204
    v_mul_f32 v61, v61, v205
    v_mul_f32 v62, v62, v206
    v_mul_f32 v63, v63, v207
    s_mov_b32 exec_lo, 0x55555555
    s_mov_b32 exec_hi, 0x55555555
    v_mul_f32 v176, v176, v200
    v_mul_f32 v177, v177, v201
    v_mul_f32 v178, v178, v202
    v_mul_f32 v179, v179, v203
    v_mul_f32 v180, v180, v204
    v_mul_f32 v181, v181, v205
    v_mul_f32 v182, v182, v206
    v_mul_f32 v183, v183, v207
    v_mul_f32 v184, v184, v200
    v_mul_f32 v185, v185, v201
    v_mul_f32 v186, v186, v202
    v_mul_f32 v187, v187, v203
    v_mul_f32 v188, v188, v204
    v_mul_f32 v189, v189, v205
    v_mul_f32 v190, v190, v206
    v_mul_f32 v191, v191, v207
    s_mov_b64 exec, -1
    v_mul_f32 v192, v192, v200
    v_mul_f32 v193, v193, v201
    v_mul_f32 v194, v194, v202
    v_mul_f32 v195, v195, v203
    v_mul_f32 v196, v196, v204
    v_mul_f32 v197, v197, v205
    v_mul_f32 v198, v198, v206
    v_mul_f32 v199, v199, v207
    v_cvt_pk_bf16_f32 v240, v24, v25
    v_cvt_pk_bf16_f32 v248, v176, v177
    v_cvt_pk_bf16_f32 v241, v26, v27
    v_cvt_pk_bf16_f32 v249, v178, v179
    v_cvt_pk_bf16_f32 v242, v28, v29
    v_cvt_pk_bf16_f32 v250, v180, v181
    v_cvt_pk_bf16_f32 v243, v30, v31
    v_cvt_pk_bf16_f32 v251, v182, v183
    v_cvt_pk_bf16_f32 v244, v56, v57
    v_cvt_pk_bf16_f32 v252, v184, v185
    v_cvt_pk_bf16_f32 v245, v58, v59
    v_cvt_pk_bf16_f32 v253, v186, v187
    v_cvt_pk_bf16_f32 v246, v60, v61
    v_cvt_pk_bf16_f32 v254, v188, v189
    v_cvt_pk_bf16_f32 v247, v62, v63
    v_cvt_pk_bf16_f32 v255, v190, v191
    v_mfma_f32_16x16x32_bf16 v[128:131], v[248:251], v[240:243], v[128:131]
    v_mfma_f32_16x16x32_bf16 v[132:135], v[248:251], v[244:247], v[132:135]
    v_mfma_f32_16x16x32_bf16 v[136:139], v[252:255], v[240:243], v[136:139]
    v_mfma_f32_16x16x32_bf16 v[140:143], v[252:255], v[244:247], v[140:143]
    s_nop 3
    v_mov_b32_dpp v200, v192 quad_perm:[2,3,0,1] row_mask:0xf bank_mask:0xf
    v_mov_b32_dpp v201, v193 quad_perm:[2,3,0,1] row_mask:0xf bank_mask:0xf
    v_mov_b32_dpp v202, v194 quad_perm:[2,3,0,1] row_mask:0xf bank_mask:0xf
    v_mov_b32_dpp v203, v195 quad_perm:[2,3,0,1] row_mask:0xf bank_mask:0xf
    v_mov_b32_dpp v204, v196 quad_perm:[2,3,0,1] row_mask:0xf bank_mask:0xf
    v_mov_b32_dpp v205, v197 quad_perm:[2,3,0,1] row_mask:0xf bank_mask:0xf
    v_mov_b32_dpp v206, v198 quad_perm:[2,3,0,1] row_mask:0xf bank_mask:0xf
    v_mov_b32_dpp v207, v199 quad_perm:[2,3,0,1] row_mask:0xf bank_mask:0xf
    s_mov_b32 exec_lo, 0xcccccccc
    s_mov_b32 exec_hi, 0xcccccccc
    v_mul_f32 v24, v24, v200
    v_mul_f32 v25, v25, v201
    v_mul_f32 v26, v26, v202
    v_mul_f32 v27, v27, v203
    v_mul_f32 v28, v28, v204
    v_mul_f32 v29, v29, v205
    v_mul_f32 v30, v30, v206
    v_mul_f32 v31, v31, v207
    v_mul_f32 v56, v56, v200
    v_mul_f32 v57, v57, v201
    v_mul_f32 v58, v58, v202
    v_mul_f32 v59, v59, v203
    v_mul_f32 v60, v60, v204
    v_mul_f32 v61, v61, v205
    v_mul_f32 v62, v62, v206
    v_mul_f32 v63, v63, v207
    s_mov_b32 exec_lo, 0x33333333
    s_mov_b32 exec_hi, 0x33333333
    v_mul_f32 v176, v176, v200
    v_mul_f32 v177, v177, v201
    v_mul_f32 v178, v178, v202
    v_mul_f32 v179, v179, v203
    v_mul_f32 v180, v180, v204
    v_mul_f32 v181, v181, v205
    v_mul_f32 v182, v182, v206
    v_mul_f32 v183, v183, v207
    v_mul_f32 v184, v184, v200
    v_mul_f32 v185, v185, v201
    v_mul_f32 v186, v186, v202
    v_mul_f32 v187, v187, v203
    v_mul_f32 v188, v188, v204
    v_mul_f32 v189, v189, v205
    v_mul_f32 v190, v190, v206
    v_mul_f32 v191, v191, v207
    s_mov_b64 exec, -1
    v_mul_f32 v192, v192, v200
    v_mul_f32 v193, v193, v201
    v_mul_f32 v194, v194, v202
    v_mul_f32 v195, v195, v203
    v_mul_f32 v196, v196, v204
    v_mul_f32 v197, v197, v205
    v_mul_f32 v198, v198, v206
    v_mul_f32 v199, v199, v207
    v_cvt_pk_bf16_f32 v240, v24, v25
    v_cvt_pk_bf16_f32 v248, v176, v177
    v_cvt_pk_bf16_f32 v241, v26, v27
    v_cvt_pk_bf16_f32 v249, v178, v179
    v_cvt_pk_bf16_f32 v242, v28, v29
    v_cvt_pk_bf16_f32 v250, v180, v181
    v_cvt_pk_bf16_f32 v243, v30, v31
    v_cvt_pk_bf16_f32 v251, v182, v183
    v_cvt_pk_bf16_f32 v244, v56, v57
    v_cvt_pk_bf16_f32 v252, v184, v185
    v_cvt_pk_bf16_f32 v245, v58, v59
    v_cvt_pk_bf16_f32 v253, v186, v187
    v_cvt_pk_bf16_f32 v246, v60, v61
    v_cvt_pk_bf16_f32 v254, v188, v189
    v_cvt_pk_bf16_f32 v247, v62, v63
    v_cvt_pk_bf16_f32 v255, v190, v191
    v_mfma_f32_16x16x32_bf16 v[144:147], v[248:251], v[240:243], v[144:147]
    v_mfma_f32_16x16x32_bf16 v[148:151], v[248:251], v[244:247], v[148:151]
    v_mfma_f32_16x16x32_bf16 v[152:155], v[252:255], v[240:243], v[152:155]
    v_mfma_f32_16x16x32_bf16 v[156:159], v[252:255], v[244:247], v[156:159]
    s_nop 3
    v_mov_b32_dpp v200, v192 row_half_mirror row_mask:0xf bank_mask:0xf
    v_mov_b32_dpp v201, v193 row_half_mirror row_mask:0xf bank_mask:0xf
    v_mov_b32_dpp v202, v194 row_half_mirror row_mask:0xf bank_mask:0xf
    v_mov_b32_dpp v203, v195 row_half_mirror row_mask:0xf bank_mask:0xf
    v_mov_b32_dpp v204, v196 row_half_mirror row_mask:0xf bank_mask:0xf
    v_mov_b32_dpp v205, v197 row_half_mirror row_mask:0xf bank_mask:0xf
    v_mov_b32_dpp v206, v198 row_half_mirror row_mask:0xf bank_mask:0xf
    v_mov_b32_dpp v207, v199 row_half_mirror row_mask:0xf bank_mask:0xf
    s_mov_b32 exec_lo, 0xf0f0f0f0
    s_mov_b32 exec_hi, 0xf0f0f0f0
    v_mul_f32 v24, v24, v200
    v_mul_f32 v25, v25, v201
    v_mul_f32 v26, v26, v202
    v_mul_f32 v27, v27, v203
    v_mul_f32 v28, v28, v204
    v_mul_f32 v29, v29, v205
    v_mul_f32 v30, v30, v206
    v_mul_f32 v31, v31, v207
    v_mul_f32 v56, v56, v200
    v_mul_f32 v57, v57, v201
    v_mul_f32 v58, v58, v202
    v_mul_f32 v59, v59, v203
    v_mul_f32 v60, v60, v204
    v_mul_f32 v61, v61, v205
    v_mul_f32 v62, v62, v206
    v_mul_f32 v63, v63, v207
    s_mov_b32 exec_lo, 0xf0f0f0f
    s_mov_b32 exec_hi, 0xf0f0f0f
    v_mul_f32 v176, v176, v200
    v_mul_f32 v177, v177, v201
    v_mul_f32 v178, v178, v202
    v_mul_f32 v179, v179, v203
    v_mul_f32 v180, v180, v204
    v_mul_f32 v181, v181, v205
    v_mul_f32 v182, v182, v206
    v_mul_f32 v183, v183, v207
    v_mul_f32 v184, v184, v200
    v_mul_f32 v185, v185, v201
    v_mul_f32 v186, v186, v202
    v_mul_f32 v187, v187, v203
    v_mul_f32 v188, v188, v204
    v_mul_f32 v189, v189, v205
    v_mul_f32 v190, v190, v206
    v_mul_f32 v191, v191, v207
    s_mov_b64 exec, -1
    v_mul_f32 v192, v192, v200
    v_mul_f32 v193, v193, v201
    v_mul_f32 v194, v194, v202
    v_mul_f32 v195, v195, v203
    v_mul_f32 v196, v196, v204
    v_mul_f32 v197, v197, v205
    v_mul_f32 v198, v198, v206
    v_mul_f32 v199, v199, v207
    v_cvt_pk_bf16_f32 v240, v24, v25
    v_cvt_pk_bf16_f32 v248, v176, v177
    v_cvt_pk_bf16_f32 v241, v26, v27
    v_cvt_pk_bf16_f32 v249, v178, v179
    v_cvt_pk_bf16_f32 v242, v28, v29
    v_cvt_pk_bf16_f32 v250, v180, v181
    v_cvt_pk_bf16_f32 v243, v30, v31
    v_cvt_pk_bf16_f32 v251, v182, v183
    v_cvt_pk_bf16_f32 v244, v56, v57
    v_cvt_pk_bf16_f32 v252, v184, v185
    v_cvt_pk_bf16_f32 v245, v58, v59
    v_cvt_pk_bf16_f32 v253, v186, v187
    v_cvt_pk_bf16_f32 v246, v60, v61
    v_cvt_pk_bf16_f32 v254, v188, v189
    v_cvt_pk_bf16_f32 v247, v62, v63
    v_cvt_pk_bf16_f32 v255, v190, v191
    v_mfma_f32_16x16x32_bf16 v[160:163], v[248:251], v[240:243], v[160:163]
    v_mfma_f32_16x16x32_bf16 v[164:167], v[248:251], v[244:247], v[164:167]
    v_mfma_f32_16x16x32_bf16 v[168:171], v[252:255], v[240:243], v[168:171]
    v_mfma_f32_16x16x32_bf16 v[172:175], v[252:255], v[244:247], v[172:175]
    s_nop 3
    v_mov_b32_dpp v200, v192 row_mirror row_mask:0xf bank_mask:0xf
    v_mov_b32_dpp v201, v193 row_mirror row_mask:0xf bank_mask:0xf
    v_mov_b32_dpp v202, v194 row_mirror row_mask:0xf bank_mask:0xf
    v_mov_b32_dpp v203, v195 row_mirror row_mask:0xf bank_mask:0xf
    v_mov_b32_dpp v204, v196 row_mirror row_mask:0xf bank_mask:0xf
    v_mov_b32_dpp v205, v197 row_mirror row_mask:0xf bank_mask:0xf
    v_mov_b32_dpp v206, v198 row_mirror row_mask:0xf bank_mask:0xf
    v_mov_b32_dpp v207, v199 row_mirror row_mask:0xf bank_mask:0xf
    s_mov_b32 exec_lo, 0xff00ff00
    s_mov_b32 exec_hi, 0xff00ff00
    v_mul_f32 v24, v24, v200
    v_mul_f32 v25, v25, v201
    v_mul_f32 v26, v26, v202
    v_mul_f32 v27, v27, v203
    v_mul_f32 v28, v28, v204
    v_mul_f32 v29, v29, v205
    v_mul_f32 v30, v30, v206
    v_mul_f32 v31, v31, v207
    v_mul_f32 v56, v56, v200
    v_mul_f32 v57, v57, v201
    v_mul_f32 v58, v58, v202
    v_mul_f32 v59, v59, v203
    v_mul_f32 v60, v60, v204
    v_mul_f32 v61, v61, v205
    v_mul_f32 v62, v62, v206
    v_mul_f32 v63, v63, v207
    s_mov_b64 exec, -1
    buffer_load_dwordx4 v[240:243], v1, s[16:19], s36 offen offset:128
    buffer_load_dwordx4 v[248:251], v1, s[8:11], s36 offen offset:128
    buffer_load_dwordx4 v[244:247], v1, s[16:19], s36 offen offset:384
    buffer_load_dwordx4 v[252:255], v1, s[8:11], s36 offen offset:384
    s_waitcnt vmcnt(0)
    v_lshlrev_b32 v192, 16, v240
    v_and_b32 v193, s70, v240
    v_lshlrev_b32 v194, 16, v241
    v_and_b32 v195, s70, v241
    v_lshlrev_b32 v196, 16, v242
    v_and_b32 v197, s70, v242
    v_lshlrev_b32 v198, 16, v243
    v_and_b32 v199, s70, v243
    v_lshlrev_b32 v200, 16, v244
    v_and_b32 v201, s70, v244
    v_lshlrev_b32 v202, 16, v245
    v_and_b32 v203, s70, v245
    v_lshlrev_b32 v204, 16, v246
    v_and_b32 v205, s70, v246
    v_lshlrev_b32 v206, 16, v247
    v_and_b32 v207, s70, v247
    v_mul_f32 v192, s62, v192
    v_mul_f32 v193, s62, v193
    v_mul_f32 v194, s62, v194
    v_mul_f32 v195, s62, v195
    v_mul_f32 v196, s62, v196
    v_mul_f32 v197, s62, v197
    v_mul_f32 v198, s62, v198
    v_mul_f32 v199, s62, v199
    v_mul_f32 v200, s62, v200
    v_mul_f32 v201, s62, v201
    v_mul_f32 v202, s62, v202
    v_mul_f32 v203, s62, v203
    v_mul_f32 v204, s62, v204
    v_mul_f32 v205, s62, v205
    v_mul_f32 v206, s62, v206
    v_mul_f32 v207, s62, v207
    v_exp_f32 v192, v192
    v_exp_f32 v193, v193
    v_exp_f32 v194, v194
    v_exp_f32 v195, v195
    v_exp_f32 v196, v196
    v_exp_f32 v197, v197
    v_exp_f32 v198, v198
    v_exp_f32 v199, v199
    v_exp_f32 v200, v200
    v_exp_f32 v201, v201
    v_exp_f32 v202, v202
    v_exp_f32 v203, v203
    v_exp_f32 v204, v204
    v_exp_f32 v205, v205
    v_exp_f32 v206, v206
    v_exp_f32 v207, v207
    v_add_f32 v192, 1.0, v192
    v_add_f32 v193, 1.0, v193
    v_add_f32 v194, 1.0, v194
    v_add_f32 v195, 1.0, v195
    v_add_f32 v196, 1.0, v196
    v_add_f32 v197, 1.0, v197
    v_add_f32 v198, 1.0, v198
    v_add_f32 v199, 1.0, v199
    v_add_f32 v200, 1.0, v200
    v_add_f32 v201, 1.0, v201
    v_add_f32 v202, 1.0, v202
    v_add_f32 v203, 1.0, v203
    v_add_f32 v204, 1.0, v204
    v_add_f32 v205, 1.0, v205
    v_add_f32 v206, 1.0, v206
    v_add_f32 v207, 1.0, v207
    v_rcp_f32 v192, v192
    v_rcp_f32 v193, v193
    v_rcp_f32 v194, v194
    v_rcp_f32 v195, v195
    v_rcp_f32 v196, v196
    v_rcp_f32 v197, v197
    v_rcp_f32 v198, v198
    v_rcp_f32 v199, v199
    v_rcp_f32 v200, v200
    v_rcp_f32 v201, v201
    v_rcp_f32 v202, v202
    v_rcp_f32 v203, v203
    v_rcp_f32 v204, v204
    v_rcp_f32 v205, v205
    v_rcp_f32 v206, v206
    v_rcp_f32 v207, v207
    v_lshlrev_b32 v176, 16, v248
    v_and_b32 v177, s70, v248
    v_lshlrev_b32 v178, 16, v249
    v_and_b32 v179, s70, v249
    v_lshlrev_b32 v180, 16, v250
    v_and_b32 v181, s70, v250
    v_lshlrev_b32 v182, 16, v251
    v_and_b32 v183, s70, v251
    v_lshlrev_b32 v32, 16, v224
    v_and_b32 v33, s70, v224
    v_lshlrev_b32 v34, 16, v225
    v_and_b32 v35, s70, v225
    v_lshlrev_b32 v36, 16, v226
    v_and_b32 v37, s70, v226
    v_lshlrev_b32 v38, 16, v227
    v_and_b32 v39, s70, v227
    v_lshlrev_b32 v184, 16, v252
    v_and_b32 v185, s70, v252
    v_lshlrev_b32 v186, 16, v253
    v_and_b32 v187, s70, v253
    v_lshlrev_b32 v188, 16, v254
    v_and_b32 v189, s70, v254
    v_lshlrev_b32 v190, 16, v255
    v_and_b32 v191, s70, v255
    v_lshlrev_b32 v64, 16, v228
    v_and_b32 v65, s70, v228
    v_lshlrev_b32 v66, 16, v229
    v_and_b32 v67, s70, v229
    v_lshlrev_b32 v68, 16, v230
    v_and_b32 v69, s70, v230
    v_lshlrev_b32 v70, 16, v231
    v_and_b32 v71, s70, v231
    v_mul_f32 v176, s64, v176
    v_mul_f32 v177, s64, v177
    v_mul_f32 v178, s64, v178
    v_mul_f32 v179, s64, v179
    v_mul_f32 v180, s64, v180
    v_mul_f32 v181, s64, v181
    v_mul_f32 v182, s64, v182
    v_mul_f32 v183, s64, v183
    v_mul_f32 v184, s64, v184
    v_mul_f32 v185, s64, v185
    v_mul_f32 v186, s64, v186
    v_mul_f32 v187, s64, v187
    v_mul_f32 v188, s64, v188
    v_mul_f32 v189, s64, v189
    v_mul_f32 v190, s64, v190
    v_mul_f32 v191, s64, v191
    v_cvt_pk_bf16_f32 v240, v32, v33
    v_cvt_pk_bf16_f32 v248, v176, v177
    v_cvt_pk_bf16_f32 v241, v34, v35
    v_cvt_pk_bf16_f32 v249, v178, v179
    v_cvt_pk_bf16_f32 v242, v36, v37
    v_cvt_pk_bf16_f32 v250, v180, v181
    v_cvt_pk_bf16_f32 v243, v38, v39
    v_cvt_pk_bf16_f32 v251, v182, v183
    v_cvt_pk_bf16_f32 v244, v64, v65
    v_cvt_pk_bf16_f32 v252, v184, v185
    v_cvt_pk_bf16_f32 v245, v66, v67
    v_cvt_pk_bf16_f32 v253, v186, v187
    v_cvt_pk_bf16_f32 v246, v68, v69
    v_cvt_pk_bf16_f32 v254, v188, v189
    v_cvt_pk_bf16_f32 v247, v70, v71
    v_cvt_pk_bf16_f32 v255, v190, v191
    v_mfma_f32_16x16x32_bf16 v[80:83], v[248:251], v[240:243], v[80:83]
    s_nop 0
    v_mfma_f32_16x16x32_bf16 v[92:95], v[252:255], v[244:247], v[92:95]
    s_nop 3
    v_mul_f32 v32, v32, v192
    v_mul_f32 v64, v64, v200
    v_mul_f32 v33, v33, v193
    v_mul_f32 v65, v65, v201
    v_mul_f32 v34, v34, v194
    v_mul_f32 v66, v66, v202
    v_mul_f32 v35, v35, v195
    v_mul_f32 v67, v67, v203
    v_mul_f32 v36, v36, v196
    v_mul_f32 v68, v68, v204
    v_mul_f32 v37, v37, v197
    v_mul_f32 v69, v69, v205
    v_mul_f32 v38, v38, v198
    v_mul_f32 v70, v70, v206
    v_mul_f32 v39, v39, v199
    v_mul_f32 v71, v71, v207
    v_cvt_pk_bf16_f32 v240, v32, v33
    v_cvt_pk_bf16_f32 v248, v176, v177
    v_cvt_pk_bf16_f32 v241, v34, v35
    v_cvt_pk_bf16_f32 v249, v178, v179
    v_cvt_pk_bf16_f32 v242, v36, v37
    v_cvt_pk_bf16_f32 v250, v180, v181
    v_cvt_pk_bf16_f32 v243, v38, v39
    v_cvt_pk_bf16_f32 v251, v182, v183
    v_cvt_pk_bf16_f32 v244, v64, v65
    v_cvt_pk_bf16_f32 v252, v184, v185
    v_cvt_pk_bf16_f32 v245, v66, v67
    v_cvt_pk_bf16_f32 v253, v186, v187
    v_cvt_pk_bf16_f32 v246, v68, v69
    v_cvt_pk_bf16_f32 v254, v188, v189
    v_cvt_pk_bf16_f32 v247, v70, v71
    v_cvt_pk_bf16_f32 v255, v190, v191
    s_nop 0
    v_mfma_f32_16x16x32_bf16 v[100:103], v[248:251], v[244:247], v[100:103]
    s_nop 3
    v_mul_f32 v64, v64, v192
    v_mul_f32 v176, v176, v200
    v_mul_f32 v65, v65, v193
    v_mul_f32 v177, v177, v201
    v_mul_f32 v66, v66, v194
    v_mul_f32 v178, v178, v202
    v_mul_f32 v67, v67, v195
    v_mul_f32 v179, v179, v203
    v_mul_f32 v68, v68, v196
    v_mul_f32 v180, v180, v204
    v_mul_f32 v69, v69, v197
    v_mul_f32 v181, v181, v205
    v_mul_f32 v70, v70, v198
    v_mul_f32 v182, v182, v206
    v_mul_f32 v71, v71, v199
    v_mul_f32 v183, v183, v207
    v_mul_f32 v192, v192, v200
    v_mul_f32 v193, v193, v201
    v_mul_f32 v194, v194, v202
    v_mul_f32 v195, v195, v203
    v_mul_f32 v196, v196, v204
    v_mul_f32 v197, v197, v205
    v_mul_f32 v198, v198, v206
    v_mul_f32 v199, v199, v207
    v_cvt_pk_bf16_f32 v240, v32, v33
    v_cvt_pk_bf16_f32 v248, v176, v177
    v_cvt_pk_bf16_f32 v241, v34, v35
    v_cvt_pk_bf16_f32 v249, v178, v179
    v_cvt_pk_bf16_f32 v242, v36, v37
    v_cvt_pk_bf16_f32 v250, v180, v181
    v_cvt_pk_bf16_f32 v243, v38, v39
    v_cvt_pk_bf16_f32 v251, v182, v183
    v_cvt_pk_bf16_f32 v244, v64, v65
    v_cvt_pk_bf16_f32 v252, v184, v185
    v_cvt_pk_bf16_f32 v245, v66, v67
    v_cvt_pk_bf16_f32 v253, v186, v187
    v_cvt_pk_bf16_f32 v246, v68, v69
    v_cvt_pk_bf16_f32 v254, v188, v189
    v_cvt_pk_bf16_f32 v247, v70, v71
    v_cvt_pk_bf16_f32 v255, v190, v191
    v_mfma_f32_16x16x32_bf16 v[112:115], v[248:251], v[240:243], v[112:115]
    v_mfma_f32_16x16x32_bf16 v[116:119], v[248:251], v[244:247], v[116:119]
    v_mfma_f32_16x16x32_bf16 v[120:123], v[252:255], v[240:243], v[120:123]
    v_mfma_f32_16x16x32_bf16 v[124:127], v[252:255], v[244:247], v[124:127]
    s_nop 3
    v_mov_b32_dpp v200, v192 quad_perm:[1,0,3,2] row_mask:0xf bank_mask:0xf
    v_mov_b32_dpp v201, v193 quad_perm:[1,0,3,2] row_mask:0xf bank_mask:0xf
    v_mov_b32_dpp v202, v194 quad_perm:[1,0,3,2] row_mask:0xf bank_mask:0xf
    v_mov_b32_dpp v203, v195 quad_perm:[1,0,3,2] row_mask:0xf bank_mask:0xf
    v_mov_b32_dpp v204, v196 quad_perm:[1,0,3,2] row_mask:0xf bank_mask:0xf
    v_mov_b32_dpp v205, v197 quad_perm:[1,0,3,2] row_mask:0xf bank_mask:0xf
    v_mov_b32_dpp v206, v198 quad_perm:[1,0,3,2] row_mask:0xf bank_mask:0xf
    v_mov_b32_dpp v207, v199 quad_perm:[1,0,3,2] row_mask:0xf bank_mask:0xf
    s_mov_b32 exec_lo, 0xaaaaaaaa
    s_mov_b32 exec_hi, 0xaaaaaaaa
    v_mul_f32 v32, v32, v200
    v_mul_f32 v33, v33, v201
    v_mul_f32 v34, v34, v202
    v_mul_f32 v35, v35, v203
    v_mul_f32 v36, v36, v204
    v_mul_f32 v37, v37, v205
    v_mul_f32 v38, v38, v206
    v_mul_f32 v39, v39, v207
    v_mul_f32 v64, v64, v200
    v_mul_f32 v65, v65, v201
    v_mul_f32 v66, v66, v202
    v_mul_f32 v67, v67, v203
    v_mul_f32 v68, v68, v204
    v_mul_f32 v69, v69, v205
    v_mul_f32 v70, v70, v206
    v_mul_f32 v71, v71, v207
    s_mov_b32 exec_lo, 0x55555555
    s_mov_b32 exec_hi, 0x55555555
    v_mul_f32 v176, v176, v200
    v_mul_f32 v177, v177, v201
    v_mul_f32 v178, v178, v202
    v_mul_f32 v179, v179, v203
    v_mul_f32 v180, v180, v204
    v_mul_f32 v181, v181, v205
    v_mul_f32 v182, v182, v206
    v_mul_f32 v183, v183, v207
    v_mul_f32 v184, v184, v200
    v_mul_f32 v185, v185, v201
    v_mul_f32 v186, v186, v202
    v_mul_f32 v187, v187, v203
    v_mul_f32 v188, v188, v204
    v_mul_f32 v189, v189, v205
    v_mul_f32 v190, v190, v206
    v_mul_f32 v191, v191, v207
    s_mov_b64 exec, -1
    v_mul_f32 v192, v192, v200
    v_mul_f32 v193, v193, v201
    v_mul_f32 v194, v194, v202
    v_mul_f32 v195, v195, v203
    v_mul_f32 v196, v196, v204
    v_mul_f32 v197, v197, v205
    v_mul_f32 v198, v198, v206
    v_mul_f32 v199, v199, v207
    v_cvt_pk_bf16_f32 v240, v32, v33
    v_cvt_pk_bf16_f32 v248, v176, v177
    v_cvt_pk_bf16_f32 v241, v34, v35
    v_cvt_pk_bf16_f32 v249, v178, v179
    v_cvt_pk_bf16_f32 v242, v36, v37
    v_cvt_pk_bf16_f32 v250, v180, v181
    v_cvt_pk_bf16_f32 v243, v38, v39
    v_cvt_pk_bf16_f32 v251, v182, v183
    v_cvt_pk_bf16_f32 v244, v64, v65
    v_cvt_pk_bf16_f32 v252, v184, v185
    v_cvt_pk_bf16_f32 v245, v66, v67
    v_cvt_pk_bf16_f32 v253, v186, v187
    v_cvt_pk_bf16_f32 v246, v68, v69
    v_cvt_pk_bf16_f32 v254, v188, v189
    v_cvt_pk_bf16_f32 v247, v70, v71
    v_cvt_pk_bf16_f32 v255, v190, v191
    v_mfma_f32_16x16x32_bf16 v[128:131], v[248:251], v[240:243], v[128:131]
    v_mfma_f32_16x16x32_bf16 v[132:135], v[248:251], v[244:247], v[132:135]
    v_mfma_f32_16x16x32_bf16 v[136:139], v[252:255], v[240:243], v[136:139]
    v_mfma_f32_16x16x32_bf16 v[140:143], v[252:255], v[244:247], v[140:143]
    s_nop 3
    v_mov_b32_dpp v200, v192 quad_perm:[2,3,0,1] row_mask:0xf bank_mask:0xf
    v_mov_b32_dpp v201, v193 quad_perm:[2,3,0,1] row_mask:0xf bank_mask:0xf
    v_mov_b32_dpp v202, v194 quad_perm:[2,3,0,1] row_mask:0xf bank_mask:0xf
    v_mov_b32_dpp v203, v195 quad_perm:[2,3,0,1] row_mask:0xf bank_mask:0xf
    v_mov_b32_dpp v204, v196 quad_perm:[2,3,0,1] row_mask:0xf bank_mask:0xf
    v_mov_b32_dpp v205, v197 quad_perm:[2,3,0,1] row_mask:0xf bank_mask:0xf
    v_mov_b32_dpp v206, v198 quad_perm:[2,3,0,1] row_mask:0xf bank_mask:0xf
    v_mov_b32_dpp v207, v199 quad_perm:[2,3,0,1] row_mask:0xf bank_mask:0xf
    s_mov_b32 exec_lo, 0xcccccccc
    s_mov_b32 exec_hi, 0xcccccccc
    v_mul_f32 v32, v32, v200
    v_mul_f32 v33, v33, v201
    v_mul_f32 v34, v34, v202
    v_mul_f32 v35, v35, v203
    v_mul_f32 v36, v36, v204
    v_mul_f32 v37, v37, v205
    v_mul_f32 v38, v38, v206
    v_mul_f32 v39, v39, v207
    v_mul_f32 v64, v64, v200
    v_mul_f32 v65, v65, v201
    v_mul_f32 v66, v66, v202
    v_mul_f32 v67, v67, v203
    v_mul_f32 v68, v68, v204
    v_mul_f32 v69, v69, v205
    v_mul_f32 v70, v70, v206
    v_mul_f32 v71, v71, v207
    s_mov_b32 exec_lo, 0x33333333
    s_mov_b32 exec_hi, 0x33333333
    v_mul_f32 v176, v176, v200
    v_mul_f32 v177, v177, v201
    v_mul_f32 v178, v178, v202
    v_mul_f32 v179, v179, v203
    v_mul_f32 v180, v180, v204
    v_mul_f32 v181, v181, v205
    v_mul_f32 v182, v182, v206
    v_mul_f32 v183, v183, v207
    v_mul_f32 v184, v184, v200
    v_mul_f32 v185, v185, v201
    v_mul_f32 v186, v186, v202
    v_mul_f32 v187, v187, v203
    v_mul_f32 v188, v188, v204
    v_mul_f32 v189, v189, v205
    v_mul_f32 v190, v190, v206
    v_mul_f32 v191, v191, v207
    s_mov_b64 exec, -1
    v_mul_f32 v192, v192, v200
    v_mul_f32 v193, v193, v201
    v_mul_f32 v194, v194, v202
    v_mul_f32 v195, v195, v203
    v_mul_f32 v196, v196, v204
    v_mul_f32 v197, v197, v205
    v_mul_f32 v198, v198, v206
    v_mul_f32 v199, v199, v207
    v_cvt_pk_bf16_f32 v240, v32, v33
    v_cvt_pk_bf16_f32 v248, v176, v177
    v_cvt_pk_bf16_f32 v241, v34, v35
    v_cvt_pk_bf16_f32 v249, v178, v179
    v_cvt_pk_bf16_f32 v242, v36, v37
    v_cvt_pk_bf16_f32 v250, v180, v181
    v_cvt_pk_bf16_f32 v243, v38, v39
    v_cvt_pk_bf16_f32 v251, v182, v183
    v_cvt_pk_bf16_f32 v244, v64, v65
    v_cvt_pk_bf16_f32 v252, v184, v185
    v_cvt_pk_bf16_f32 v245, v66, v67
    v_cvt_pk_bf16_f32 v253, v186, v187
    v_cvt_pk_bf16_f32 v246, v68, v69
    v_cvt_pk_bf16_f32 v254, v188, v189
    v_cvt_pk_bf16_f32 v247, v70, v71
    v_cvt_pk_bf16_f32 v255, v190, v191
    v_mfma_f32_16x16x32_bf16 v[144:147], v[248:251], v[240:243], v[144:147]
    v_mfma_f32_16x16x32_bf16 v[148:151], v[248:251], v[244:247], v[148:151]
    v_mfma_f32_16x16x32_bf16 v[152:155], v[252:255], v[240:243], v[152:155]
    v_mfma_f32_16x16x32_bf16 v[156:159], v[252:255], v[244:247], v[156:159]
    s_nop 3
    v_mov_b32_dpp v200, v192 row_half_mirror row_mask:0xf bank_mask:0xf
    v_mov_b32_dpp v201, v193 row_half_mirror row_mask:0xf bank_mask:0xf
    v_mov_b32_dpp v202, v194 row_half_mirror row_mask:0xf bank_mask:0xf
    v_mov_b32_dpp v203, v195 row_half_mirror row_mask:0xf bank_mask:0xf
    v_mov_b32_dpp v204, v196 row_half_mirror row_mask:0xf bank_mask:0xf
    v_mov_b32_dpp v205, v197 row_half_mirror row_mask:0xf bank_mask:0xf
    v_mov_b32_dpp v206, v198 row_half_mirror row_mask:0xf bank_mask:0xf
    v_mov_b32_dpp v207, v199 row_half_mirror row_mask:0xf bank_mask:0xf
    s_mov_b32 exec_lo, 0xf0f0f0f0
    s_mov_b32 exec_hi, 0xf0f0f0f0
    v_mul_f32 v32, v32, v200
    v_mul_f32 v33, v33, v201
    v_mul_f32 v34, v34, v202
    v_mul_f32 v35, v35, v203
    v_mul_f32 v36, v36, v204
    v_mul_f32 v37, v37, v205
    v_mul_f32 v38, v38, v206
    v_mul_f32 v39, v39, v207
    v_mul_f32 v64, v64, v200
    v_mul_f32 v65, v65, v201
    v_mul_f32 v66, v66, v202
    v_mul_f32 v67, v67, v203
    v_mul_f32 v68, v68, v204
    v_mul_f32 v69, v69, v205
    v_mul_f32 v70, v70, v206
    v_mul_f32 v71, v71, v207
    s_mov_b32 exec_lo, 0xf0f0f0f
    s_mov_b32 exec_hi, 0xf0f0f0f
    v_mul_f32 v176, v176, v200
    v_mul_f32 v177, v177, v201
    v_mul_f32 v178, v178, v202
    v_mul_f32 v179, v179, v203
    v_mul_f32 v180, v180, v204
    v_mul_f32 v181, v181, v205
    v_mul_f32 v182, v182, v206
    v_mul_f32 v183, v183, v207
    v_mul_f32 v184, v184, v200
    v_mul_f32 v185, v185, v201
    v_mul_f32 v186, v186, v202
    v_mul_f32 v187, v187, v203
    v_mul_f32 v188, v188, v204
    v_mul_f32 v189, v189, v205
    v_mul_f32 v190, v190, v206
    v_mul_f32 v191, v191, v207
    s_mov_b64 exec, -1
    v_mul_f32 v192, v192, v200
    v_mul_f32 v193, v193, v201
    v_mul_f32 v194, v194, v202
    v_mul_f32 v195, v195, v203
    v_mul_f32 v196, v196, v204
    v_mul_f32 v197, v197, v205
    v_mul_f32 v198, v198, v206
    v_mul_f32 v199, v199, v207
    v_cvt_pk_bf16_f32 v240, v32, v33
    v_cvt_pk_bf16_f32 v248, v176, v177
    v_cvt_pk_bf16_f32 v241, v34, v35
    v_cvt_pk_bf16_f32 v249, v178, v179
    v_cvt_pk_bf16_f32 v242, v36, v37
    v_cvt_pk_bf16_f32 v250, v180, v181
    v_cvt_pk_bf16_f32 v243, v38, v39
    v_cvt_pk_bf16_f32 v251, v182, v183
    v_cvt_pk_bf16_f32 v244, v64, v65
    v_cvt_pk_bf16_f32 v252, v184, v185
    v_cvt_pk_bf16_f32 v245, v66, v67
    v_cvt_pk_bf16_f32 v253, v186, v187
    v_cvt_pk_bf16_f32 v246, v68, v69
    v_cvt_pk_bf16_f32 v254, v188, v189
    v_cvt_pk_bf16_f32 v247, v70, v71
    v_cvt_pk_bf16_f32 v255, v190, v191
    v_mfma_f32_16x16x32_bf16 v[160:163], v[248:251], v[240:243], v[160:163]
    v_mfma_f32_16x16x32_bf16 v[164:167], v[248:251], v[244:247], v[164:167]
    v_mfma_f32_16x16x32_bf16 v[168:171], v[252:255], v[240:243], v[168:171]
    v_mfma_f32_16x16x32_bf16 v[172:175], v[252:255], v[244:247], v[172:175]
    s_nop 3
    v_mov_b32_dpp v200, v192 row_mirror row_mask:0xf bank_mask:0xf
    v_mov_b32_dpp v201, v193 row_mirror row_mask:0xf bank_mask:0xf
    v_mov_b32_dpp v202, v194 row_mirror row_mask:0xf bank_mask:0xf
    v_mov_b32_dpp v203, v195 row_mirror row_mask:0xf bank_mask:0xf
    v_mov_b32_dpp v204, v196 row_mirror row_mask:0xf bank_mask:0xf
    v_mov_b32_dpp v205, v197 row_mirror row_mask:0xf bank_mask:0xf
    v_mov_b32_dpp v206, v198 row_mirror row_mask:0xf bank_mask:0xf
    v_mov_b32_dpp v207, v199 row_mirror row_mask:0xf bank_mask:0xf
    s_mov_b32 exec_lo, 0xff00ff00
    s_mov_b32 exec_hi, 0xff00ff00
    v_mul_f32 v32, v32, v200
    v_mul_f32 v33, v33, v201
    v_mul_f32 v34, v34, v202
    v_mul_f32 v35, v35, v203
    v_mul_f32 v36, v36, v204
    v_mul_f32 v37, v37, v205
    v_mul_f32 v38, v38, v206
    v_mul_f32 v39, v39, v207
    v_mul_f32 v64, v64, v200
    v_mul_f32 v65, v65, v201
    v_mul_f32 v66, v66, v202
    v_mul_f32 v67, v67, v203
    v_mul_f32 v68, v68, v204
    v_mul_f32 v69, v69, v205
    v_mul_f32 v70, v70, v206
    v_mul_f32 v71, v71, v207
    s_mov_b64 exec, -1
    buffer_load_dwordx4 v[240:243], v1, s[16:19], s36 offen offset:192
    buffer_load_dwordx4 v[248:251], v1, s[8:11], s36 offen offset:192
    buffer_load_dwordx4 v[244:247], v1, s[16:19], s36 offen offset:448
    buffer_load_dwordx4 v[252:255], v1, s[8:11], s36 offen offset:448
    s_waitcnt vmcnt(0)
    v_lshlrev_b32 v192, 16, v240
    v_and_b32 v193, s70, v240
    v_lshlrev_b32 v194, 16, v241
    v_and_b32 v195, s70, v241
    v_lshlrev_b32 v196, 16, v242
    v_and_b32 v197, s70, v242
    v_lshlrev_b32 v198, 16, v243
    v_and_b32 v199, s70, v243
    v_lshlrev_b32 v200, 16, v244
    v_and_b32 v201, s70, v244
    v_lshlrev_b32 v202, 16, v245
    v_and_b32 v203, s70, v245
    v_lshlrev_b32 v204, 16, v246
    v_and_b32 v205, s70, v246
    v_lshlrev_b32 v206, 16, v247
    v_and_b32 v207, s70, v247
    v_mul_f32 v192, s62, v192
    v_mul_f32 v193, s62, v193
    v_mul_f32 v194, s62, v194
    v_mul_f32 v195, s62, v195
    v_mul_f32 v196, s62, v196
    v_mul_f32 v197, s62, v197
    v_mul_f32 v198, s62, v198
    v_mul_f32 v199, s62, v199
    v_mul_f32 v200, s62, v200
    v_mul_f32 v201, s62, v201
    v_mul_f32 v202, s62, v202
    v_mul_f32 v203, s62, v203
    v_mul_f32 v204, s62, v204
    v_mul_f32 v205, s62, v205
    v_mul_f32 v206, s62, v206
    v_mul_f32 v207, s62, v207
    v_exp_f32 v192, v192
    v_exp_f32 v193, v193
    v_exp_f32 v194, v194
    v_exp_f32 v195, v195
    v_exp_f32 v196, v196
    v_exp_f32 v197, v197
    v_exp_f32 v198, v198
    v_exp_f32 v199, v199
    v_exp_f32 v200, v200
    v_exp_f32 v201, v201
    v_exp_f32 v202, v202
    v_exp_f32 v203, v203
    v_exp_f32 v204, v204
    v_exp_f32 v205, v205
    v_exp_f32 v206, v206
    v_exp_f32 v207, v207
    v_add_f32 v192, 1.0, v192
    v_add_f32 v193, 1.0, v193
    v_add_f32 v194, 1.0, v194
    v_add_f32 v195, 1.0, v195
    v_add_f32 v196, 1.0, v196
    v_add_f32 v197, 1.0, v197
    v_add_f32 v198, 1.0, v198
    v_add_f32 v199, 1.0, v199
    v_add_f32 v200, 1.0, v200
    v_add_f32 v201, 1.0, v201
    v_add_f32 v202, 1.0, v202
    v_add_f32 v203, 1.0, v203
    v_add_f32 v204, 1.0, v204
    v_add_f32 v205, 1.0, v205
    v_add_f32 v206, 1.0, v206
    v_add_f32 v207, 1.0, v207
    v_rcp_f32 v192, v192
    v_rcp_f32 v193, v193
    v_rcp_f32 v194, v194
    v_rcp_f32 v195, v195
    v_rcp_f32 v196, v196
    v_rcp_f32 v197, v197
    v_rcp_f32 v198, v198
    v_rcp_f32 v199, v199
    v_rcp_f32 v200, v200
    v_rcp_f32 v201, v201
    v_rcp_f32 v202, v202
    v_rcp_f32 v203, v203
    v_rcp_f32 v204, v204
    v_rcp_f32 v205, v205
    v_rcp_f32 v206, v206
    v_rcp_f32 v207, v207
    v_lshlrev_b32 v176, 16, v248
    v_and_b32 v177, s70, v248
    v_lshlrev_b32 v178, 16, v249
    v_and_b32 v179, s70, v249
    v_lshlrev_b32 v180, 16, v250
    v_and_b32 v181, s70, v250
    v_lshlrev_b32 v182, 16, v251
    v_and_b32 v183, s70, v251
    v_lshlrev_b32 v40, 16, v232
    v_and_b32 v41, s70, v232
    v_lshlrev_b32 v42, 16, v233
    v_and_b32 v43, s70, v233
    v_lshlrev_b32 v44, 16, v234
    v_and_b32 v45, s70, v234
    v_lshlrev_b32 v46, 16, v235
    v_and_b32 v47, s70, v235
    v_lshlrev_b32 v184, 16, v252
    v_and_b32 v185, s70, v252
    v_lshlrev_b32 v186, 16, v253
    v_and_b32 v187, s70, v253
    v_lshlrev_b32 v188, 16, v254
    v_and_b32 v189, s70, v254
    v_lshlrev_b32 v190, 16, v255
    v_and_b32 v191, s70, v255
    v_lshlrev_b32 v72, 16, v236
    v_and_b32 v73, s70, v236
    v_lshlrev_b32 v74, 16, v237
    v_and_b32 v75, s70, v237
    v_lshlrev_b32 v76, 16, v238
    v_and_b32 v77, s70, v238
    v_lshlrev_b32 v78, 16, v239
    v_and_b32 v79, s70, v239
    v_mul_f32 v176, s64, v176
    v_mul_f32 v177, s64, v177
    v_mul_f32 v178, s64, v178
    v_mul_f32 v179, s64, v179
    v_mul_f32 v180, s64, v180
    v_mul_f32 v181, s64, v181
    v_mul_f32 v182, s64, v182
    v_mul_f32 v183, s64, v183
    v_mul_f32 v184, s64, v184
    v_mul_f32 v185, s64, v185
    v_mul_f32 v186, s64, v186
    v_mul_f32 v187, s64, v187
    v_mul_f32 v188, s64, v188
    v_mul_f32 v189, s64, v189
    v_mul_f32 v190, s64, v190
    v_mul_f32 v191, s64, v191
    v_cvt_pk_bf16_f32 v240, v40, v41
    v_cvt_pk_bf16_f32 v248, v176, v177
    v_cvt_pk_bf16_f32 v241, v42, v43
    v_cvt_pk_bf16_f32 v249, v178, v179
    v_cvt_pk_bf16_f32 v242, v44, v45
    v_cvt_pk_bf16_f32 v250, v180, v181
    v_cvt_pk_bf16_f32 v243, v46, v47
    v_cvt_pk_bf16_f32 v251, v182, v183
    v_cvt_pk_bf16_f32 v244, v72, v73
    v_cvt_pk_bf16_f32 v252, v184, v185
    v_cvt_pk_bf16_f32 v245, v74, v75
    v_cvt_pk_bf16_f32 v253, v186, v187
    v_cvt_pk_bf16_f32 v246, v76, v77
    v_cvt_pk_bf16_f32 v254, v188, v189
    v_cvt_pk_bf16_f32 v247, v78, v79
    v_cvt_pk_bf16_f32 v255, v190, v191
    v_mfma_f32_16x16x32_bf16 v[80:83], v[248:251], v[240:243], v[80:83]
    s_nop 0
    v_mfma_f32_16x16x32_bf16 v[92:95], v[252:255], v[244:247], v[92:95]
    s_nop 3
    v_mul_f32 v40, v40, v192
    v_mul_f32 v72, v72, v200
    v_mul_f32 v41, v41, v193
    v_mul_f32 v73, v73, v201
    v_mul_f32 v42, v42, v194
    v_mul_f32 v74, v74, v202
    v_mul_f32 v43, v43, v195
    v_mul_f32 v75, v75, v203
    v_mul_f32 v44, v44, v196
    v_mul_f32 v76, v76, v204
    v_mul_f32 v45, v45, v197
    v_mul_f32 v77, v77, v205
    v_mul_f32 v46, v46, v198
    v_mul_f32 v78, v78, v206
    v_mul_f32 v47, v47, v199
    v_mul_f32 v79, v79, v207
    v_cvt_pk_bf16_f32 v240, v40, v41
    v_cvt_pk_bf16_f32 v248, v176, v177
    v_cvt_pk_bf16_f32 v241, v42, v43
    v_cvt_pk_bf16_f32 v249, v178, v179
    v_cvt_pk_bf16_f32 v242, v44, v45
    v_cvt_pk_bf16_f32 v250, v180, v181
    v_cvt_pk_bf16_f32 v243, v46, v47
    v_cvt_pk_bf16_f32 v251, v182, v183
    v_cvt_pk_bf16_f32 v244, v72, v73
    v_cvt_pk_bf16_f32 v252, v184, v185
    v_cvt_pk_bf16_f32 v245, v74, v75
    v_cvt_pk_bf16_f32 v253, v186, v187
    v_cvt_pk_bf16_f32 v246, v76, v77
    v_cvt_pk_bf16_f32 v254, v188, v189
    v_cvt_pk_bf16_f32 v247, v78, v79
    v_cvt_pk_bf16_f32 v255, v190, v191
    s_nop 0
    v_mfma_f32_16x16x32_bf16 v[100:103], v[248:251], v[244:247], v[100:103]
    s_nop 3
    v_mul_f32 v72, v72, v192
    v_mul_f32 v176, v176, v200
    v_mul_f32 v73, v73, v193
    v_mul_f32 v177, v177, v201
    v_mul_f32 v74, v74, v194
    v_mul_f32 v178, v178, v202
    v_mul_f32 v75, v75, v195
    v_mul_f32 v179, v179, v203
    v_mul_f32 v76, v76, v196
    v_mul_f32 v180, v180, v204
    v_mul_f32 v77, v77, v197
    v_mul_f32 v181, v181, v205
    v_mul_f32 v78, v78, v198
    v_mul_f32 v182, v182, v206
    v_mul_f32 v79, v79, v199
    v_mul_f32 v183, v183, v207
    v_mul_f32 v192, v192, v200
    v_mul_f32 v193, v193, v201
    v_mul_f32 v194, v194, v202
    v_mul_f32 v195, v195, v203
    v_mul_f32 v196, v196, v204
    v_mul_f32 v197, v197, v205
    v_mul_f32 v198, v198, v206
    v_mul_f32 v199, v199, v207
    v_cvt_pk_bf16_f32 v240, v40, v41
    v_cvt_pk_bf16_f32 v248, v176, v177
    v_cvt_pk_bf16_f32 v241, v42, v43
    v_cvt_pk_bf16_f32 v249, v178, v179
    v_cvt_pk_bf16_f32 v242, v44, v45
    v_cvt_pk_bf16_f32 v250, v180, v181
    v_cvt_pk_bf16_f32 v243, v46, v47
    v_cvt_pk_bf16_f32 v251, v182, v183
    v_cvt_pk_bf16_f32 v244, v72, v73
    v_cvt_pk_bf16_f32 v252, v184, v185
    v_cvt_pk_bf16_f32 v245, v74, v75
    v_cvt_pk_bf16_f32 v253, v186, v187
    v_cvt_pk_bf16_f32 v246, v76, v77
    v_cvt_pk_bf16_f32 v254, v188, v189
    v_cvt_pk_bf16_f32 v247, v78, v79
    v_cvt_pk_bf16_f32 v255, v190, v191
    v_mfma_f32_16x16x32_bf16 v[112:115], v[248:251], v[240:243], v[112:115]
    v_mfma_f32_16x16x32_bf16 v[116:119], v[248:251], v[244:247], v[116:119]
    v_mfma_f32_16x16x32_bf16 v[120:123], v[252:255], v[240:243], v[120:123]
    v_mfma_f32_16x16x32_bf16 v[124:127], v[252:255], v[244:247], v[124:127]
    s_nop 3
    v_mov_b32_dpp v200, v192 quad_perm:[1,0,3,2] row_mask:0xf bank_mask:0xf
    v_mov_b32_dpp v201, v193 quad_perm:[1,0,3,2] row_mask:0xf bank_mask:0xf
    v_mov_b32_dpp v202, v194 quad_perm:[1,0,3,2] row_mask:0xf bank_mask:0xf
    v_mov_b32_dpp v203, v195 quad_perm:[1,0,3,2] row_mask:0xf bank_mask:0xf
    v_mov_b32_dpp v204, v196 quad_perm:[1,0,3,2] row_mask:0xf bank_mask:0xf
    v_mov_b32_dpp v205, v197 quad_perm:[1,0,3,2] row_mask:0xf bank_mask:0xf
    v_mov_b32_dpp v206, v198 quad_perm:[1,0,3,2] row_mask:0xf bank_mask:0xf
    v_mov_b32_dpp v207, v199 quad_perm:[1,0,3,2] row_mask:0xf bank_mask:0xf
    s_mov_b32 exec_lo, 0xaaaaaaaa
    s_mov_b32 exec_hi, 0xaaaaaaaa
    v_mul_f32 v40, v40, v200
    v_mul_f32 v41, v41, v201
    v_mul_f32 v42, v42, v202
    v_mul_f32 v43, v43, v203
    v_mul_f32 v44, v44, v204
    v_mul_f32 v45, v45, v205
    v_mul_f32 v46, v46, v206
    v_mul_f32 v47, v47, v207
    v_mul_f32 v72, v72, v200
    v_mul_f32 v73, v73, v201
    v_mul_f32 v74, v74, v202
    v_mul_f32 v75, v75, v203
    v_mul_f32 v76, v76, v204
    v_mul_f32 v77, v77, v205
    v_mul_f32 v78, v78, v206
    v_mul_f32 v79, v79, v207
    s_mov_b32 exec_lo, 0x55555555
    s_mov_b32 exec_hi, 0x55555555
    v_mul_f32 v176, v176, v200
    v_mul_f32 v177, v177, v201
    v_mul_f32 v178, v178, v202
    v_mul_f32 v179, v179, v203
    v_mul_f32 v180, v180, v204
    v_mul_f32 v181, v181, v205
    v_mul_f32 v182, v182, v206
    v_mul_f32 v183, v183, v207
    v_mul_f32 v184, v184, v200
    v_mul_f32 v185, v185, v201
    v_mul_f32 v186, v186, v202
    v_mul_f32 v187, v187, v203
    v_mul_f32 v188, v188, v204
    v_mul_f32 v189, v189, v205
    v_mul_f32 v190, v190, v206
    v_mul_f32 v191, v191, v207
    s_mov_b64 exec, -1
    v_mul_f32 v192, v192, v200
    v_mul_f32 v193, v193, v201
    v_mul_f32 v194, v194, v202
    v_mul_f32 v195, v195, v203
    v_mul_f32 v196, v196, v204
    v_mul_f32 v197, v197, v205
    v_mul_f32 v198, v198, v206
    v_mul_f32 v199, v199, v207
    v_cvt_pk_bf16_f32 v240, v40, v41
    v_cvt_pk_bf16_f32 v248, v176, v177
    v_cvt_pk_bf16_f32 v241, v42, v43
    v_cvt_pk_bf16_f32 v249, v178, v179
    v_cvt_pk_bf16_f32 v242, v44, v45
    v_cvt_pk_bf16_f32 v250, v180, v181
    v_cvt_pk_bf16_f32 v243, v46, v47
    v_cvt_pk_bf16_f32 v251, v182, v183
    v_cvt_pk_bf16_f32 v244, v72, v73
    v_cvt_pk_bf16_f32 v252, v184, v185
    v_cvt_pk_bf16_f32 v245, v74, v75
    v_cvt_pk_bf16_f32 v253, v186, v187
    v_cvt_pk_bf16_f32 v246, v76, v77
    v_cvt_pk_bf16_f32 v254, v188, v189
    v_cvt_pk_bf16_f32 v247, v78, v79
    v_cvt_pk_bf16_f32 v255, v190, v191
    v_mfma_f32_16x16x32_bf16 v[128:131], v[248:251], v[240:243], v[128:131]
    v_mfma_f32_16x16x32_bf16 v[132:135], v[248:251], v[244:247], v[132:135]
    v_mfma_f32_16x16x32_bf16 v[136:139], v[252:255], v[240:243], v[136:139]
    v_mfma_f32_16x16x32_bf16 v[140:143], v[252:255], v[244:247], v[140:143]
    s_nop 3
    v_mov_b32_dpp v200, v192 quad_perm:[2,3,0,1] row_mask:0xf bank_mask:0xf
    v_mov_b32_dpp v201, v193 quad_perm:[2,3,0,1] row_mask:0xf bank_mask:0xf
    v_mov_b32_dpp v202, v194 quad_perm:[2,3,0,1] row_mask:0xf bank_mask:0xf
    v_mov_b32_dpp v203, v195 quad_perm:[2,3,0,1] row_mask:0xf bank_mask:0xf
    v_mov_b32_dpp v204, v196 quad_perm:[2,3,0,1] row_mask:0xf bank_mask:0xf
    v_mov_b32_dpp v205, v197 quad_perm:[2,3,0,1] row_mask:0xf bank_mask:0xf
    v_mov_b32_dpp v206, v198 quad_perm:[2,3,0,1] row_mask:0xf bank_mask:0xf
    v_mov_b32_dpp v207, v199 quad_perm:[2,3,0,1] row_mask:0xf bank_mask:0xf
    s_mov_b32 exec_lo, 0xcccccccc
    s_mov_b32 exec_hi, 0xcccccccc
    v_mul_f32 v40, v40, v200
    v_mul_f32 v41, v41, v201
    v_mul_f32 v42, v42, v202
    v_mul_f32 v43, v43, v203
    v_mul_f32 v44, v44, v204
    v_mul_f32 v45, v45, v205
    v_mul_f32 v46, v46, v206
    v_mul_f32 v47, v47, v207
    v_mul_f32 v72, v72, v200
    v_mul_f32 v73, v73, v201
    v_mul_f32 v74, v74, v202
    v_mul_f32 v75, v75, v203
    v_mul_f32 v76, v76, v204
    v_mul_f32 v77, v77, v205
    v_mul_f32 v78, v78, v206
    v_mul_f32 v79, v79, v207
    s_mov_b32 exec_lo, 0x33333333
    s_mov_b32 exec_hi, 0x33333333
    v_mul_f32 v176, v176, v200
    v_mul_f32 v177, v177, v201
    v_mul_f32 v178, v178, v202
    v_mul_f32 v179, v179, v203
    v_mul_f32 v180, v180, v204
    v_mul_f32 v181, v181, v205
    v_mul_f32 v182, v182, v206
    v_mul_f32 v183, v183, v207
    v_mul_f32 v184, v184, v200
    v_mul_f32 v185, v185, v201
    v_mul_f32 v186, v186, v202
    v_mul_f32 v187, v187, v203
    v_mul_f32 v188, v188, v204
    v_mul_f32 v189, v189, v205
    v_mul_f32 v190, v190, v206
    v_mul_f32 v191, v191, v207
    s_mov_b64 exec, -1
    v_mul_f32 v192, v192, v200
    v_mul_f32 v193, v193, v201
    v_mul_f32 v194, v194, v202
    v_mul_f32 v195, v195, v203
    v_mul_f32 v196, v196, v204
    v_mul_f32 v197, v197, v205
    v_mul_f32 v198, v198, v206
    v_mul_f32 v199, v199, v207
    v_cvt_pk_bf16_f32 v240, v40, v41
    v_cvt_pk_bf16_f32 v248, v176, v177
    v_cvt_pk_bf16_f32 v241, v42, v43
    v_cvt_pk_bf16_f32 v249, v178, v179
    v_cvt_pk_bf16_f32 v242, v44, v45
    v_cvt_pk_bf16_f32 v250, v180, v181
    v_cvt_pk_bf16_f32 v243, v46, v47
    v_cvt_pk_bf16_f32 v251, v182, v183
    v_cvt_pk_bf16_f32 v244, v72, v73
    v_cvt_pk_bf16_f32 v252, v184, v185
    v_cvt_pk_bf16_f32 v245, v74, v75
    v_cvt_pk_bf16_f32 v253, v186, v187
    v_cvt_pk_bf16_f32 v246, v76, v77
    v_cvt_pk_bf16_f32 v254, v188, v189
    v_cvt_pk_bf16_f32 v247, v78, v79
    v_cvt_pk_bf16_f32 v255, v190, v191
    v_mfma_f32_16x16x32_bf16 v[144:147], v[248:251], v[240:243], v[144:147]
    v_mfma_f32_16x16x32_bf16 v[148:151], v[248:251], v[244:247], v[148:151]
    v_mfma_f32_16x16x32_bf16 v[152:155], v[252:255], v[240:243], v[152:155]
    v_mfma_f32_16x16x32_bf16 v[156:159], v[252:255], v[244:247], v[156:159]
    s_nop 3
    v_mov_b32_dpp v200, v192 row_half_mirror row_mask:0xf bank_mask:0xf
    v_mov_b32_dpp v201, v193 row_half_mirror row_mask:0xf bank_mask:0xf
    v_mov_b32_dpp v202, v194 row_half_mirror row_mask:0xf bank_mask:0xf
    v_mov_b32_dpp v203, v195 row_half_mirror row_mask:0xf bank_mask:0xf
    v_mov_b32_dpp v204, v196 row_half_mirror row_mask:0xf bank_mask:0xf
    v_mov_b32_dpp v205, v197 row_half_mirror row_mask:0xf bank_mask:0xf
    v_mov_b32_dpp v206, v198 row_half_mirror row_mask:0xf bank_mask:0xf
    v_mov_b32_dpp v207, v199 row_half_mirror row_mask:0xf bank_mask:0xf
    s_mov_b32 exec_lo, 0xf0f0f0f0
    s_mov_b32 exec_hi, 0xf0f0f0f0
    v_mul_f32 v40, v40, v200
    v_mul_f32 v41, v41, v201
    v_mul_f32 v42, v42, v202
    v_mul_f32 v43, v43, v203
    v_mul_f32 v44, v44, v204
    v_mul_f32 v45, v45, v205
    v_mul_f32 v46, v46, v206
    v_mul_f32 v47, v47, v207
    v_mul_f32 v72, v72, v200
    v_mul_f32 v73, v73, v201
    v_mul_f32 v74, v74, v202
    v_mul_f32 v75, v75, v203
    v_mul_f32 v76, v76, v204
    v_mul_f32 v77, v77, v205
    v_mul_f32 v78, v78, v206
    v_mul_f32 v79, v79, v207
    s_mov_b32 exec_lo, 0xf0f0f0f
    s_mov_b32 exec_hi, 0xf0f0f0f
    v_mul_f32 v176, v176, v200
    v_mul_f32 v177, v177, v201
    v_mul_f32 v178, v178, v202
    v_mul_f32 v179, v179, v203
    v_mul_f32 v180, v180, v204
    v_mul_f32 v181, v181, v205
    v_mul_f32 v182, v182, v206
    v_mul_f32 v183, v183, v207
    v_mul_f32 v184, v184, v200
    v_mul_f32 v185, v185, v201
    v_mul_f32 v186, v186, v202
    v_mul_f32 v187, v187, v203
    v_mul_f32 v188, v188, v204
    v_mul_f32 v189, v189, v205
    v_mul_f32 v190, v190, v206
    v_mul_f32 v191, v191, v207
    s_mov_b64 exec, -1
    v_mul_f32 v192, v192, v200
    v_mul_f32 v193, v193, v201
    v_mul_f32 v194, v194, v202
    v_mul_f32 v195, v195, v203
    v_mul_f32 v196, v196, v204
    v_mul_f32 v197, v197, v205
    v_mul_f32 v198, v198, v206
    v_mul_f32 v199, v199, v207
    v_cvt_pk_bf16_f32 v240, v40, v41
    v_cvt_pk_bf16_f32 v248, v176, v177
    v_cvt_pk_bf16_f32 v241, v42, v43
    v_cvt_pk_bf16_f32 v249, v178, v179
    v_cvt_pk_bf16_f32 v242, v44, v45
    v_cvt_pk_bf16_f32 v250, v180, v181
    v_cvt_pk_bf16_f32 v243, v46, v47
    v_cvt_pk_bf16_f32 v251, v182, v183
    v_cvt_pk_bf16_f32 v244, v72, v73
    v_cvt_pk_bf16_f32 v252, v184, v185
    v_cvt_pk_bf16_f32 v245, v74, v75
    v_cvt_pk_bf16_f32 v253, v186, v187
    v_cvt_pk_bf16_f32 v246, v76, v77
    v_cvt_pk_bf16_f32 v254, v188, v189
    v_cvt_pk_bf16_f32 v247, v78, v79
    v_cvt_pk_bf16_f32 v255, v190, v191
    v_mfma_f32_16x16x32_bf16 v[160:163], v[248:251], v[240:243], v[160:163]
    v_mfma_f32_16x16x32_bf16 v[164:167], v[248:251], v[244:247], v[164:167]
    v_mfma_f32_16x16x32_bf16 v[168:171], v[252:255], v[240:243], v[168:171]
    v_mfma_f32_16x16x32_bf16 v[172:175], v[252:255], v[244:247], v[172:175]
    s_nop 3
    v_mov_b32_dpp v200, v192 row_mirror row_mask:0xf bank_mask:0xf
    v_mov_b32_dpp v201, v193 row_mirror row_mask:0xf bank_mask:0xf
    v_mov_b32_dpp v202, v194 row_mirror row_mask:0xf bank_mask:0xf
    v_mov_b32_dpp v203, v195 row_mirror row_mask:0xf bank_mask:0xf
    v_mov_b32_dpp v204, v196 row_mirror row_mask:0xf bank_mask:0xf
    v_mov_b32_dpp v205, v197 row_mirror row_mask:0xf bank_mask:0xf
    v_mov_b32_dpp v206, v198 row_mirror row_mask:0xf bank_mask:0xf
    v_mov_b32_dpp v207, v199 row_mirror row_mask:0xf bank_mask:0xf
    s_mov_b32 exec_lo, 0xff00ff00
    s_mov_b32 exec_hi, 0xff00ff00
    v_mul_f32 v40, v40, v200
    v_mul_f32 v41, v41, v201
    v_mul_f32 v42, v42, v202
    v_mul_f32 v43, v43, v203
    v_mul_f32 v44, v44, v204
    v_mul_f32 v45, v45, v205
    v_mul_f32 v46, v46, v206
    v_mul_f32 v47, v47, v207
    v_mul_f32 v72, v72, v200
    v_mul_f32 v73, v73, v201
    v_mul_f32 v74, v74, v202
    v_mul_f32 v75, v75, v203
    v_mul_f32 v76, v76, v204
    v_mul_f32 v77, v77, v205
    v_mul_f32 v78, v78, v206
    v_mul_f32 v79, v79, v207
    s_mov_b64 exec, -1
    ds_read_b64_tr_b16 v[208:209], v4 offset:0
    ds_read_b64_tr_b16 v[210:211], v4 offset:4096
    ds_read_b64_tr_b16 v[212:213], v5 offset:0
    ds_read_b64_tr_b16 v[214:215], v5 offset:4096
    ds_read_b64_tr_b16 v[216:217], v4 offset:1024
    ds_read_b64_tr_b16 v[218:219], v4 offset:5120
    ds_read_b64_tr_b16 v[220:221], v5 offset:1024
    ds_read_b64_tr_b16 v[222:223], v5 offset:5120
    ds_read_b64_tr_b16 v[224:225], v4 offset:2048
    ds_read_b64_tr_b16 v[226:227], v4 offset:6144
    ds_read_b64_tr_b16 v[228:229], v5 offset:2048
    ds_read_b64_tr_b16 v[230:231], v5 offset:6144
    ds_read_b64_tr_b16 v[232:233], v4 offset:3072
    ds_read_b64_tr_b16 v[234:235], v4 offset:7168
    ds_read_b64_tr_b16 v[236:237], v5 offset:3072
    ds_read_b64_tr_b16 v[238:239], v5 offset:7168
    v_and_b32 v3, 15, v7
    v_lshlrev_b32 v6, 2, v10
    v_add_u32 v8, 0, v6
    v_xor_b32 v8, v8, v3
    s_andn2_b64 s[92:93], s[40:41], s[48:49]
    v_cndmask_b32 v240, 0, v80, s[92:93]
    v_cndmask_b32 v252, 0, v92, s[92:93]
    v_cndmask_b32 v244, 0, v100, s[92:93]
    v_mov_b32 v248, 0
    v_lshrrev_b32 v9, 0, v8
    v_cmp_eq_u32 vcc, 1, v9
    s_nop 1
    s_and_b64 s[92:93], vcc, s[48:49]
    v_cndmask_b32 v240, v240, v112, s[92:93]
    v_cndmask_b32 v244, v244, v116, s[92:93]
    v_cndmask_b32 v248, v248, v120, s[92:93]
    v_cndmask_b32 v252, v252, v124, s[92:93]
    v_lshrrev_b32 v9, 1, v8
    v_cmp_eq_u32 vcc, 1, v9
    s_nop 1
    s_and_b64 s[92:93], vcc, s[48:49]
    v_cndmask_b32 v240, v240, v128, s[92:93]
    v_cndmask_b32 v244, v244, v132, s[92:93]
    v_cndmask_b32 v248, v248, v136, s[92:93]
    v_cndmask_b32 v252, v252, v140, s[92:93]
    v_lshrrev_b32 v9, 2, v8
    v_cmp_eq_u32 vcc, 1, v9
    s_nop 1
    s_and_b64 s[92:93], vcc, s[48:49]
    v_cndmask_b32 v240, v240, v144, s[92:93]
    v_cndmask_b32 v244, v244, v148, s[92:93]
    v_cndmask_b32 v248, v248, v152, s[92:93]
    v_cndmask_b32 v252, v252, v156, s[92:93]
    v_lshrrev_b32 v9, 3, v8
    v_cmp_eq_u32 vcc, 1, v9
    s_nop 1
    s_and_b64 s[92:93], vcc, s[48:49]
    v_cndmask_b32 v240, v240, v160, s[92:93]
    v_cndmask_b32 v244, v244, v164, s[92:93]
    v_cndmask_b32 v248, v248, v168, s[92:93]
    v_cndmask_b32 v252, v252, v172, s[92:93]
    v_add_u32 v8, 1, v6
    v_xor_b32 v8, v8, v3
    s_andn2_b64 s[92:93], s[42:43], s[50:51]
    v_cndmask_b32 v241, 0, v81, s[92:93]
    v_cndmask_b32 v253, 0, v93, s[92:93]
    v_cndmask_b32 v245, 0, v101, s[92:93]
    v_mov_b32 v249, 0
    v_lshrrev_b32 v9, 0, v8
    v_cmp_eq_u32 vcc, 1, v9
    s_nop 1
    s_and_b64 s[92:93], vcc, s[50:51]
    v_cndmask_b32 v241, v241, v113, s[92:93]
    v_cndmask_b32 v245, v245, v117, s[92:93]
    v_cndmask_b32 v249, v249, v121, s[92:93]
    v_cndmask_b32 v253, v253, v125, s[92:93]
    v_lshrrev_b32 v9, 1, v8
    v_cmp_eq_u32 vcc, 1, v9
    s_nop 1
    s_and_b64 s[92:93], vcc, s[50:51]
    v_cndmask_b32 v241, v241, v129, s[92:93]
    v_cndmask_b32 v245, v245, v133, s[92:93]
    v_cndmask_b32 v249, v249, v137, s[92:93]
    v_cndmask_b32 v253, v253, v141, s[92:93]
    v_lshrrev_b32 v9, 2, v8
    v_cmp_eq_u32 vcc, 1, v9
    s_nop 1
    s_and_b64 s[92:93], vcc, s[50:51]
    v_cndmask_b32 v241, v241, v145, s[92:93]
    v_cndmask_b32 v245, v245, v149, s[92:93]
    v_cndmask_b32 v249, v249, v153, s[92:93]
    v_cndmask_b32 v253, v253, v157, s[92:93]
    v_lshrrev_b32 v9, 3, v8
    v_cmp_eq_u32 vcc, 1, v9
    s_nop 1
    s_and_b64 s[92:93], vcc, s[50:51]
    v_cndmask_b32 v241, v241, v161, s[92:93]
    v_cndmask_b32 v245, v245, v165, s[92:93]
    v_cndmask_b32 v249, v249, v169, s[92:93]
    v_cndmask_b32 v253, v253, v173, s[92:93]
    v_add_u32 v8, 2, v6
    v_xor_b32 v8, v8, v3
    s_andn2_b64 s[92:93], s[44:45], s[52:53]
    v_cndmask_b32 v242, 0, v82, s[92:93]
    v_cndmask_b32 v254, 0, v94, s[92:93]
    v_cndmask_b32 v246, 0, v102, s[92:93]
    v_mov_b32 v250, 0
    v_lshrrev_b32 v9, 0, v8
    v_cmp_eq_u32 vcc, 1, v9
    s_nop 1
    s_and_b64 s[92:93], vcc, s[52:53]
    v_cndmask_b32 v242, v242, v114, s[92:93]
    v_cndmask_b32 v246, v246, v118, s[92:93]
    v_cndmask_b32 v250, v250, v122, s[92:93]
    v_cndmask_b32 v254, v254, v126, s[92:93]
    v_lshrrev_b32 v9, 1, v8
    v_cmp_eq_u32 vcc, 1, v9
    s_nop 1
    s_and_b64 s[92:93], vcc, s[52:53]
    v_cndmask_b32 v242, v242, v130, s[92:93]
    v_cndmask_b32 v246, v246, v134, s[92:93]
    v_cndmask_b32 v250, v250, v138, s[92:93]
    v_cndmask_b32 v254, v254, v142, s[92:93]
    v_lshrrev_b32 v9, 2, v8
    v_cmp_eq_u32 vcc, 1, v9
    s_nop 1
    s_and_b64 s[92:93], vcc, s[52:53]
    v_cndmask_b32 v242, v242, v146, s[92:93]
    v_cndmask_b32 v246, v246, v150, s[92:93]
    v_cndmask_b32 v250, v250, v154, s[92:93]
    v_cndmask_b32 v254, v254, v158, s[92:93]
    v_lshrrev_b32 v9, 3, v8
    v_cmp_eq_u32 vcc, 1, v9
    s_nop 1
    s_and_b64 s[92:93], vcc, s[52:53]
    v_cndmask_b32 v242, v242, v162, s[92:93]
    v_cndmask_b32 v246, v246, v166, s[92:93]
    v_cndmask_b32 v250, v250, v170, s[92:93]
    v_cndmask_b32 v254, v254, v174, s[92:93]
    v_add_u32 v8, 3, v6
    v_xor_b32 v8, v8, v3
    s_andn2_b64 s[92:93], s[46:47], s[54:55]
    v_cndmask_b32 v243, 0, v83, s[92:93]
    v_cndmask_b32 v255, 0, v95, s[92:93]
    v_cndmask_b32 v247, 0, v103, s[92:93]
    v_mov_b32 v251, 0
    v_lshrrev_b32 v9, 0, v8
    v_cmp_eq_u32 vcc, 1, v9
    s_nop 1
    s_and_b64 s[92:93], vcc, s[54:55]
    v_cndmask_b32 v243, v243, v115, s[92:93]
    v_cndmask_b32 v247, v247, v119, s[92:93]
    v_cndmask_b32 v251, v251, v123, s[92:93]
    v_cndmask_b32 v255, v255, v127, s[92:93]
    v_lshrrev_b32 v9, 1, v8
    v_cmp_eq_u32 vcc, 1, v9
    s_nop 1
    s_and_b64 s[92:93], vcc, s[54:55]
    v_cndmask_b32 v243, v243, v131, s[92:93]
    v_cndmask_b32 v247, v247, v135, s[92:93]
    v_cndmask_b32 v251, v251, v139, s[92:93]
    v_cndmask_b32 v255, v255, v143, s[92:93]
    v_lshrrev_b32 v9, 2, v8
    v_cmp_eq_u32 vcc, 1, v9
    s_nop 1
    s_and_b64 s[92:93], vcc, s[54:55]
    v_cndmask_b32 v243, v243, v147, s[92:93]
    v_cndmask_b32 v247, v247, v151, s[92:93]
    v_cndmask_b32 v251, v251, v155, s[92:93]
    v_cndmask_b32 v255, v255, v159, s[92:93]
    v_lshrrev_b32 v9, 3, v8
    v_cmp_eq_u32 vcc, 1, v9
    s_nop 1
    s_and_b64 s[92:93], vcc, s[54:55]
    v_cndmask_b32 v243, v243, v163, s[92:93]
    v_cndmask_b32 v247, v247, v167, s[92:93]
    v_cndmask_b32 v251, v251, v171, s[92:93]
    v_cndmask_b32 v255, v255, v175, s[92:93]
    v_cvt_pk_bf16_f32 v8, v240, v241
    v_cvt_pk_bf16_f32 v9, v242, v243
    v_cvt_pk_bf16_f32 v10, v248, v249
    v_cvt_pk_bf16_f32 v11, v250, v251
    v_cvt_pk_bf16_f32 v12, v244, v245
    v_cvt_pk_bf16_f32 v13, v246, v247
    v_cvt_pk_bf16_f32 v14, v252, v253
    v_cvt_pk_bf16_f32 v15, v254, v255
    s_waitcnt lgkmcnt(0)
    v_mfma_f32_16x16x32_bf16 v[80:83], v[208:211], v[8:11], 0
    v_mfma_f32_16x16x32_bf16 v[88:91], v[212:215], v[8:11], 0
    v_mfma_f32_16x16x32_bf16 v[96:99], v[216:219], v[8:11], 0
    v_mfma_f32_16x16x32_bf16 v[104:107], v[220:223], v[8:11], 0
    v_mfma_f32_16x16x32_bf16 v[112:115], v[224:227], v[8:11], 0
    v_mfma_f32_16x16x32_bf16 v[120:123], v[228:231], v[8:11], 0
    v_mfma_f32_16x16x32_bf16 v[128:131], v[232:235], v[8:11], 0
    v_mfma_f32_16x16x32_bf16 v[136:139], v[236:239], v[8:11], 0
    v_mfma_f32_16x16x32_bf16 v[84:87], v[208:211], v[12:15], 0
    v_mfma_f32_16x16x32_bf16 v[92:95], v[212:215], v[12:15], 0
    v_mfma_f32_16x16x32_bf16 v[100:103], v[216:219], v[12:15], 0
    v_mfma_f32_16x16x32_bf16 v[108:111], v[220:223], v[12:15], 0
    v_mfma_f32_16x16x32_bf16 v[116:119], v[224:227], v[12:15], 0
    v_mfma_f32_16x16x32_bf16 v[124:127], v[228:231], v[12:15], 0
    v_mfma_f32_16x16x32_bf16 v[132:135], v[232:235], v[12:15], 0
    v_mfma_f32_16x16x32_bf16 v[140:143], v[236:239], v[12:15], 0
    v_cvt_pk_bf16_f32 v144, v16, v17
    v_cvt_pk_bf16_f32 v145, v18, v19
    v_cvt_pk_bf16_f32 v146, v20, v21
    v_cvt_pk_bf16_f32 v147, v22, v23
    v_cvt_pk_bf16_f32 v160, v48, v49
    v_cvt_pk_bf16_f32 v161, v50, v51
    v_cvt_pk_bf16_f32 v162, v52, v53
    v_cvt_pk_bf16_f32 v163, v54, v55
    v_cvt_pk_bf16_f32 v148, v24, v25
    v_cvt_pk_bf16_f32 v149, v26, v27
    v_cvt_pk_bf16_f32 v150, v28, v29
    v_cvt_pk_bf16_f32 v151, v30, v31
    v_cvt_pk_bf16_f32 v164, v56, v57
    v_cvt_pk_bf16_f32 v165, v58, v59
    v_cvt_pk_bf16_f32 v166, v60, v61
    v_cvt_pk_bf16_f32 v167, v62, v63
    v_cvt_pk_bf16_f32 v152, v32, v33
    v_cvt_pk_bf16_f32 v153, v34, v35
    v_cvt_pk_bf16_f32 v154, v36, v37
    v_cvt_pk_bf16_f32 v155, v38, v39
    v_cvt_pk_bf16_f32 v168, v64, v65
    v_cvt_pk_bf16_f32 v169, v66, v67
    v_cvt_pk_bf16_f32 v170, v68, v69
    v_cvt_pk_bf16_f32 v171, v70, v71
    v_subrev_u32 v0, 0x2000, v0
    v_subrev_u32 v4, 0x2000, v4
    v_subrev_u32 v5, 0x2000, v5
    v_subrev_u32 v2, 0x200, v2
    v_mov_b32 v200, 1.0
    v_mov_b32 v201, 1.0
    v_mov_b32 v202, 1.0
    v_mov_b32 v203, 1.0
    v_mov_b32 v204, 1.0
    v_mov_b32 v205, 1.0
    v_mov_b32 v206, 1.0
    v_mov_b32 v207, 1.0
    s_nop 7
    ds_read_b128 v[176:179], v0 offset:0
    ds_read_b128 v[180:183], v0 offset:4096
    ds_read_b128 v[184:187], v0 offset:1024
    ds_read_b128 v[188:191], v0 offset:5120
    ds_read_b128 v[192:195], v0 offset:2048
    ds_read_b128 v[196:199], v0 offset:6144
    ds_read_b64_tr_b16 v[208:209], v4 offset:0
    ds_read_b64_tr_b16 v[210:211], v4 offset:4096
    ds_read_b64_tr_b16 v[212:213], v5 offset:0
    ds_read_b64_tr_b16 v[214:215], v5 offset:4096
    ds_read_b64_tr_b16 v[216:217], v4 offset:1024
    ds_read_b64_tr_b16 v[218:219], v4 offset:5120
    ds_read_b64_tr_b16 v[220:221], v5 offset:1024
    ds_read_b64_tr_b16 v[222:223], v5 offset:5120
    ds_read_b64_tr_b16 v[224:225], v4 offset:2048
    ds_read_b64_tr_b16 v[226:227], v4 offset:6144
    ds_read_b64_tr_b16 v[228:229], v5 offset:2048
    ds_read_b64_tr_b16 v[230:231], v5 offset:6144
    ds_read_b64_tr_b16 v[232:233], v4 offset:3072
    ds_read_b64_tr_b16 v[234:235], v4 offset:7168
    ds_read_b64_tr_b16 v[236:237], v5 offset:3072
    ds_read_b64_tr_b16 v[238:239], v5 offset:7168
    s_waitcnt lgkmcnt(0)
    s_branch L_first_done
.section .rodata,"a"
.p2align 6
.amdhsa_kernel standalone__gated_linear_recurrence__prompt_kernel
  .amdhsa_next_free_vgpr 256
  .amdhsa_next_free_sgpr 102
  .amdhsa_accum_offset 256
  .amdhsa_group_segment_fixed_size 0
  .amdhsa_kernarg_size 56
  .amdhsa_user_sgpr_count 2
  .amdhsa_user_sgpr_kernarg_segment_ptr 1
  .amdhsa_system_sgpr_workgroup_id_x 1
.end_amdhsa_kernel
```
